```python
import torch

def _softmax(x, axis=-1):
    return torch.softmax(x, dim=axis)
def _gelu(x):
    return torch.nn.functional.gelu(x, approximate="tanh")
def _silu(x):
    return torch.nn.functional.silu(x)
def _sigmoid(x):
    return torch.sigmoid(x)
def _layernorm(x, axis=-1, eps=1e-5):
    m = x.mean(dim=axis, keepdim=True)
    v = x.var(dim=axis, keepdim=True, unbiased=False)
    return (x - m) / torch.sqrt(v + eps)
def _scatter_add(tgt, idx, src, axis=0):
    return tgt.clone().index_add_(axis, idx, src)
def _segment_sum(src, seg, n):
    out = torch.zeros((n,) + src.shape[1:], dtype=src.dtype)
    return out.index_add_(0, seg, src)
def _pad(x, pw):
    flat = tuple(v for pair in reversed(pw) for v in pair)
    return torch.nn.functional.pad(x, flat)

kernel_name = 'recurrent_scan__linear_kernel_hedgehog__dense_activation_gelu__prompt'

def setup_inputs():

    _w = (lambda a: (lambda t: t.to(torch.bfloat16) if t.is_floating_point() else t)(torch.as_tensor(a)))
    def _A_setup():
        B, S, D, H = 1, 2048, 1024, 32
        Dh = D // H
        return {
            "x": _w((lambda *s: torch.randn(*s, dtype=torch.bfloat16) * 0.05)(B, S, D)),
            "wqkv": _w((lambda *s: torch.randn(*s, dtype=torch.bfloat16) * 0.4)(D, 3 * D)),
            "w_phi": _w((lambda *s: torch.randn(*s, dtype=torch.bfloat16) * 0.4)(H, Dh, Dh) * (Dh ** -0.5)),
            "wo": _w((lambda *s: torch.randn(*s, dtype=torch.bfloat16) * 0.2)(D, D)),
        }
    _A_in = _A_setup()

    def _B_setup():
        B, S, D, F = 1, 2048, 1024, 3584
        return {
            "x": _w((lambda *s: torch.randn(*s, dtype=torch.bfloat16) * 0.05)(B, S, D)),
            "w1": _w((lambda *s: torch.randn(*s, dtype=torch.bfloat16) * 0.4)(D, F) * (D ** -0.5)),
            "b1": _w((lambda *s: torch.randn(*s, dtype=torch.bfloat16) * 12.8)(F) * 0.01),
            "w2": _w((lambda *s: torch.randn(*s, dtype=torch.bfloat16) * 0.1)(F, D) * (F ** -0.5)),
            "b2": _w((lambda *s: torch.randn(*s, dtype=torch.bfloat16) * 0.8)(D) * 0.01),
        }
    _B_in = _B_setup()

    return {
        "A_x": _A_in["x"],
        "A_wqkv": _A_in["wqkv"],
        "A_w_phi": _A_in["w_phi"],
        "A_wo": _A_in["wo"],
        "B_x": _B_in["x"],
        "B_w1": _B_in["w1"],
        "B_b1": _B_in["b1"],
        "B_w2": _B_in["w2"],
        "B_b2": _B_in["b2"],
    }

def reference(A_x, A_wqkv, A_w_phi, A_wo, B_x, B_w1, B_b1, B_w2, B_b2):
    def _A_ref(x, wqkv, w_phi, wo):
        B, S, D = x.shape
        H = 32; Dh = D // H
        qkv = (lambda x, *d: x.permute(*d))((x @ wqkv).reshape(B, S, 3, H, Dh), 2, 0, 3, 1, 4)
        q, k, v = qkv[0], qkv[1], qkv[2]
        pq = torch.einsum("bhsd,hdf->bhsf", q, w_phi)
        pk = torch.einsum("bhsd,hdf->bhsf", k, w_phi)
        phi_q = torch.concatenate([_softmax(pq, axis=-1), _softmax(-pq, axis=-1)], axis=-1)
        phi_k = torch.concatenate([_softmax(pk, axis=-1), _softmax(-pk, axis=-1)], axis=-1)
        kv = torch.einsum("bhsf,bhsd->bhfd", phi_k, v)
        z  = torch.einsum("bhsf->bhf", phi_k)
        num = torch.einsum("bhqf,bhfd->bhqd", phi_q, kv)
        den = torch.einsum("bhqf,bhf->bhq", phi_q, z)[..., None] + 1e-6
        o = num / den
        return (lambda x, *d: x.permute(*d))(o, 0, 2, 1, 3).reshape(B, S, D) @ wo

    def _B_ref(x, w1, b1, w2, b2):
        h = torch.einsum("bsd,df->bsf", x, w1) + b1
        h = _gelu(h)
        return torch.einsum("bsf,fd->bsd", h, w2) + b2

    x = A_x
    xn = _layernorm(x, axis=-1)
    s = _A_ref(xn, A_wqkv, A_w_phi, A_wo)
    g = _silu(_B_ref(xn, B_w1, B_b1, B_w2, B_b2))
    return x + s * g
```

```asm
; @launch kernel=g1_kernel grid=(256,1,1) block=(512,1,1) lds=163840
.amdgcn_target "amdgcn-amd-amdhsa--gfx950"
.text
.globl g1_kernel
.p2align 8
.type g1_kernel,@function
g1_kernel:
    s_load_dwordx4 s[4:7], s[0:1], 8
    s_load_dwordx4 s[8:11], s[0:1], 40
    s_load_dwordx4 s[72:75], s[0:1], 80
    s_load_dwordx2 s[66:67], s[0:1], 0
    s_load_dwordx2 s[62:63], s[0:1], 24
    s_load_dwordx2 s[64:65], s[0:1], 56
    s_cmp_ge_u32 s2, 256
    s_cbranch_scc1 .g1_end
    v_lshrrev_b32 v2, 6, v0
    v_and_b32 v1, 63, v0
    s_and_b32 s44, s2, 7
    s_lshr_b32 s45, s2, 3
    v_readfirstlane_b32 s14, v2
    s_lshr_b32 s19, s45, 4
    s_and_b32 s17, s45, 7
    s_bfe_u32 s18, s45, 0x10003
    s_lshl_b32 s44, s44, 1
    s_add_u32 s18, s18, s44
    s_and_b32 s15, s14, 3
    s_lshr_b32 s16, s14, 2
    v_lshrrev_b32 v7, 5, v1
    v_bfe_u32 v8, v1, 2, 2
    v_bfe_u32 v9, v1, 4, 1
    v_lshlrev_b32 v9, 5, v9
    v_and_b32 v10, 3, v1
    v_lshl_add_u32 v9, v10, 3, v9
    v_cmp_le_u32 vcc, 28, v1
    v_lshlrev_b32 v2, 4, v1
    s_mul_i32 s39, s14, 3840
    s_mul_i32 s44, s15, 7680
    v_cndmask_b32 v10, 0, 1, vcc
    v_mul_u32_u24 v11, 28, v10
    v_sub_u32 v11, v1, v11
    v_and_b32 v12, 31, v1
    v_bfe_u32 v13, v1, 2, 2
    v_xor_b32 v13, v13, v7
    v_lshlrev_b32 v13, 4, v13
    v_lshl_add_u32 v13, v12, 6, v13
    v_add_u32 v5, s44, v13
    v_xor_b32 v243, 32, v5
    v_lshrrev_b32 v12, 2, v1
    v_lshrrev_b32 v13, 4, v1
    v_xor_b32 v13, v13, v1
    v_and_b32 v13, 3, v13
    v_lshlrev_b32 v13, 4, v13
    v_lshl_add_u32 v244, v12, 11, v13
    v_add_u32 v245, 31744, v244
    v_mov_b32 v248, 0
    v_mov_b32 v254, 0
    v_lshlrev_b32 v246, 5, v1
    s_mov_b32 s56, 0x3f803f80
    v_mul_u32_u24 v6, 7680, v7
    v_mul_u32_u24 v12, 448, v8
    v_add3_u32 v6, v6, v12, v9
    s_lshl_b32 s44, s14, 2
    v_add_u32 v10, s44, v10
    s_waitcnt lgkmcnt(0)
    s_lshl_b32 s44, s17, 3
    s_add_u32 s44, s44, s14
    s_lshl_b32 s44, s44, 16
    s_add_u32 s24, s66, s44
    s_addc_u32 s25, s67, 0
    s_mov_b32 s26, 65536
    s_mov_b32 s27, 0x20000
    s_mov_b32 s32, s66
    s_mov_b32 s33, s67
    s_mov_b32 s34, 4194304
    s_mov_b32 s35, 0x20000
    s_lshl_b32 s44, s2, 3
    s_add_u32 s57, s44, s14
    s_lshl_b32 s44, s57, 11
    buffer_load_dwordx4 v[192:195], v246, s[32:35], s44 offen
    buffer_load_dwordx4 v[196:199], v246, s[32:35], s44 offen offset:16
    s_mov_b32 s28, s74
    s_mov_b32 s29, s75
    s_mov_b32 s30, 268435456
    s_mov_b32 s31, 0x20000
    s_mov_b32 s68, s72
    s_mov_b32 s69, s73
    s_mov_b32 s70, 256
    s_mov_b32 s71, 0x20000
    s_or_b32 s44, s14, s2
    s_cmp_eq_u32 s44, 0
    s_cbranch_scc0 .g1_nz
    s_memrealtime s[44:45]
    s_waitcnt lgkmcnt(0)
    v_mov_b32 v12, s44
    v_mov_b32 v13, s45
    s_mov_b64 exec, 1
    buffer_store_dwordx2 v[12:13], v254, s[68:71], 0 offen sc1
    s_mov_b64 exec, -1
.g1_nz:
    s_cmp_eq_u32 s17, 0
    s_cselect_b32 s36, 256, 0
    s_mov_b32 s59, -1
    s_mov_b32 s78, 0
    s_mov_b32 s79, 0
    s_mov_b32 s40, 4
    s_mov_b32 s58, 0
    s_mov_b32 s46, 0
    s_mov_b32 s47, 0xffff0000
    s_lshl_b32 s44, s19, 4
    s_add_u32 s44, s44, s18
    s_mul_i32 s60, s44, 7168
    s_lshl_b32 s45, s16, 12
    s_add_u32 s60, s60, s45
    s_add_u32 s60, s60, 29425664
    s_lshl_b32 s61, s17, 11
    s_lshl_b32 s45, s15, 9
    s_add_u32 s61, s61, s45
    s_add_u32 s61, s61, 29360128
    s_lshl_b32 s44, s17, 3
    s_lshl_b32 s45, s15, 1
    s_add_u32 s44, s44, s45
    s_mul_i32 s48, s44, 294912
    s_add_u32 s48, s48, 5242880
    s_cmp_eq_u32 s19, 0
    s_cbranch_scc1 .g1_qkv
    s_mov_b32 s20, s8
    s_mov_b32 s21, s9
    s_mov_b32 s22, 7340032
    s_mov_b32 s23, 0x20000
    s_mov_b32 s38, 229376
    s_mul_i32 s37, s36, 3584
    s_mov_b32 s42, -1
    s_mov_b32 s43, 0x00ffffff
    s_mul_i32 s44, s18, 448
    v_mul_u32_u24 v3, 7168, v10
    v_lshl_add_u32 v3, v11, 4, v3
    v_add_u32 v3, s44, v3
    v_add_u32 v4, 13440, v3
    s_lshl_b32 s45, s16, 8
    s_add_u32 s44, s44, s45
    v_add_u32 v6, s45, v6
    v_and_b32 v12, 31, v1
    v_lshl_add_u32 v12, v12, 1, s44
    s_mov_b32 s49, 30720
    s_mov_b32 s12, s39
    s_add_u32 s13, s39, 153600
    s_mov_b32 m0, s39
    s_mov_b64 exec, s[42:43]
    buffer_load_dwordx4 v3, s[20:23], s37 offen lds
    s_mov_b64 exec, -1
    v_mov_b32 v64, 0
    v_mov_b32 v65, 0
    v_mov_b32 v66, 0
    v_mov_b32 v67, 0
    v_mov_b32 v68, 0
    v_mov_b32 v69, 0
    v_mov_b32 v70, 0
    v_mov_b32 v71, 0
    s_mov_b64 exec, s[42:43]
    buffer_load_dwordx4 v4, s[20:23], s37 offen offset:896 lds
    s_mov_b64 exec, -1
    s_add_u32 m0, s39, 1792
    s_add_u32 s37, s37, s38
    v_mov_b32 v72, 0
    v_mov_b32 v73, 0
    v_mov_b32 v74, 0
    v_mov_b32 v75, 0
    v_mov_b32 v76, 0
    v_mov_b32 v77, 0
    v_mov_b32 v78, 0
    v_mov_b32 v79, 0
    buffer_load_dwordx4 v244, s[24:27], s36 offen lds
    s_add_u32 s39, s39, 30720
    s_cmp_eq_u32 s39, s13
    s_cselect_b32 s39, s12, s39
    v_mov_b32 v80, 0
    v_mov_b32 v81, 0
    v_mov_b32 v82, 0
    v_mov_b32 v83, 0
    v_mov_b32 v84, 0
    v_mov_b32 v85, 0
    v_mov_b32 v86, 0
    v_mov_b32 v87, 0
    buffer_load_dwordx4 v245, s[24:27], s36 offen offset:1024 lds
    s_add_u32 s36, s36, 64
    s_cmp_eq_u32 s36, s59
    s_cselect_b32 s36, s78, s36
    s_cselect_b32 s37, s79, s37
    s_cmp_eq_u32 s36, 2048
    s_cselect_b32 s36, 0x100000, s36
    s_cselect_b32 s37, 0x10000000, s37
    v_mov_b32 v88, 0
    v_mov_b32 v89, 0
    v_mov_b32 v90, 0
    v_mov_b32 v91, 0
    v_mov_b32 v92, 0
    v_mov_b32 v93, 0
    v_mov_b32 v94, 0
    v_mov_b32 v95, 0
    s_mov_b32 m0, s39
    s_mov_b64 exec, s[42:43]
    buffer_load_dwordx4 v3, s[20:23], s37 offen lds
    s_mov_b64 exec, -1
    v_mov_b32 v96, 0
    v_mov_b32 v97, 0
    v_mov_b32 v98, 0
    v_mov_b32 v99, 0
    v_mov_b32 v100, 0
    v_mov_b32 v101, 0
    v_mov_b32 v102, 0
    v_mov_b32 v103, 0
    s_mov_b64 exec, s[42:43]
    buffer_load_dwordx4 v4, s[20:23], s37 offen offset:896 lds
    s_mov_b64 exec, -1
    s_add_u32 m0, s39, 1792
    s_add_u32 s37, s37, s38
    v_mov_b32 v104, 0
    v_mov_b32 v105, 0
    v_mov_b32 v106, 0
    v_mov_b32 v107, 0
    v_mov_b32 v108, 0
    v_mov_b32 v109, 0
    v_mov_b32 v110, 0
    v_mov_b32 v111, 0
    buffer_load_dwordx4 v244, s[24:27], s36 offen lds
    s_add_u32 s39, s39, 30720
    s_cmp_eq_u32 s39, s13
    s_cselect_b32 s39, s12, s39
    v_mov_b32 v112, 0
    v_mov_b32 v113, 0
    v_mov_b32 v114, 0
    v_mov_b32 v115, 0
    v_mov_b32 v116, 0
    v_mov_b32 v117, 0
    v_mov_b32 v118, 0
    v_mov_b32 v119, 0
    buffer_load_dwordx4 v245, s[24:27], s36 offen offset:1024 lds
    s_add_u32 s36, s36, 64
    s_cmp_eq_u32 s36, s59
    s_cselect_b32 s36, s78, s36
    s_cselect_b32 s37, s79, s37
    s_cmp_eq_u32 s36, 2048
    s_cselect_b32 s36, 0x100000, s36
    s_cselect_b32 s37, 0x10000000, s37
    v_mov_b32 v120, 0
    v_mov_b32 v121, 0
    v_mov_b32 v122, 0
    v_mov_b32 v123, 0
    v_mov_b32 v124, 0
    v_mov_b32 v125, 0
    v_mov_b32 v126, 0
    v_mov_b32 v127, 0
    s_mov_b32 m0, s39
    s_mov_b64 exec, s[42:43]
    buffer_load_dwordx4 v3, s[20:23], s37 offen lds
    s_mov_b64 exec, -1
    v_mov_b32 v128, 0
    v_mov_b32 v129, 0
    v_mov_b32 v130, 0
    v_mov_b32 v131, 0
    v_mov_b32 v132, 0
    v_mov_b32 v133, 0
    v_mov_b32 v134, 0
    v_mov_b32 v135, 0
    s_mov_b64 exec, s[42:43]
    buffer_load_dwordx4 v4, s[20:23], s37 offen offset:896 lds
    s_mov_b64 exec, -1
    s_add_u32 m0, s39, 1792
    s_add_u32 s37, s37, s38
    v_mov_b32 v136, 0
    v_mov_b32 v137, 0
    v_mov_b32 v138, 0
    v_mov_b32 v139, 0
    v_mov_b32 v140, 0
    v_mov_b32 v141, 0
    v_mov_b32 v142, 0
    v_mov_b32 v143, 0
    buffer_load_dwordx4 v244, s[24:27], s36 offen lds
    s_add_u32 s39, s39, 30720
    s_cmp_eq_u32 s39, s13
    s_cselect_b32 s39, s12, s39
    v_mov_b32 v144, 0
    v_mov_b32 v145, 0
    v_mov_b32 v146, 0
    v_mov_b32 v147, 0
    v_mov_b32 v148, 0
    v_mov_b32 v149, 0
    v_mov_b32 v150, 0
    v_mov_b32 v151, 0
    buffer_load_dwordx4 v245, s[24:27], s36 offen offset:1024 lds
    s_add_u32 s36, s36, 64
    s_cmp_eq_u32 s36, s59
    s_cselect_b32 s36, s78, s36
    s_cselect_b32 s37, s79, s37
    s_cmp_eq_u32 s36, 2048
    s_cselect_b32 s36, 0x100000, s36
    s_cselect_b32 s37, 0x10000000, s37
    v_mov_b32 v152, 0
    v_mov_b32 v153, 0
    v_mov_b32 v154, 0
    v_mov_b32 v155, 0
    v_mov_b32 v156, 0
    v_mov_b32 v157, 0
    v_mov_b32 v158, 0
    v_mov_b32 v159, 0
    s_mov_b32 m0, s39
    s_mov_b64 exec, s[42:43]
    buffer_load_dwordx4 v3, s[20:23], s37 offen lds
    s_mov_b64 exec, -1
    v_mov_b32 v160, 0
    v_mov_b32 v161, 0
    v_mov_b32 v162, 0
    v_mov_b32 v163, 0
    v_mov_b32 v164, 0
    v_mov_b32 v165, 0
    v_mov_b32 v166, 0
    v_mov_b32 v167, 0
    s_mov_b64 exec, s[42:43]
    buffer_load_dwordx4 v4, s[20:23], s37 offen offset:896 lds
    s_mov_b64 exec, -1
    s_add_u32 m0, s39, 1792
    s_add_u32 s37, s37, s38
    v_mov_b32 v168, 0
    v_mov_b32 v169, 0
    v_mov_b32 v170, 0
    v_mov_b32 v171, 0
    v_mov_b32 v172, 0
    v_mov_b32 v173, 0
    v_mov_b32 v174, 0
    v_mov_b32 v175, 0
    buffer_load_dwordx4 v244, s[24:27], s36 offen lds
    s_add_u32 s39, s39, 30720
    s_cmp_eq_u32 s39, s13
    s_cselect_b32 s39, s12, s39
    v_mov_b32 v176, 0
    v_mov_b32 v177, 0
    v_mov_b32 v178, 0
    v_mov_b32 v179, 0
    v_mov_b32 v180, 0
    v_mov_b32 v181, 0
    v_mov_b32 v182, 0
    v_mov_b32 v183, 0
    buffer_load_dwordx4 v245, s[24:27], s36 offen offset:1024 lds
    s_add_u32 s36, s36, 64
    s_cmp_eq_u32 s36, s59
    s_cselect_b32 s36, s78, s36
    s_cselect_b32 s37, s79, s37
    s_cmp_eq_u32 s36, 2048
    s_cselect_b32 s36, 0x100000, s36
    s_cselect_b32 s37, 0x10000000, s37
    v_mov_b32 v184, 0
    v_mov_b32 v185, 0
    v_mov_b32 v186, 0
    v_mov_b32 v187, 0
    v_mov_b32 v188, 0
    v_mov_b32 v189, 0
    v_mov_b32 v190, 0
    v_mov_b32 v191, 0
    s_waitcnt vmcnt(16)
    v_lshlrev_b32 v200, 16, v192
    v_and_b32 v201, s47, v192
    v_lshlrev_b32 v202, 16, v193
    v_and_b32 v203, s47, v193
    v_lshlrev_b32 v204, 16, v194
    v_and_b32 v205, s47, v194
    v_lshlrev_b32 v206, 16, v195
    v_and_b32 v207, s47, v195
    v_lshlrev_b32 v208, 16, v196
    v_and_b32 v209, s47, v196
    v_lshlrev_b32 v210, 16, v197
    v_and_b32 v211, s47, v197
    v_lshlrev_b32 v212, 16, v198
    v_and_b32 v213, s47, v198
    v_lshlrev_b32 v214, 16, v199
    v_and_b32 v215, s47, v199
    v_add_f32 v216, v200, v201
    v_add_f32 v220, v202, v203
    v_add_f32 v217, v204, v205
    v_add_f32 v221, v206, v207
    v_add_f32 v218, v208, v209
    v_add_f32 v222, v210, v211
    v_add_f32 v219, v212, v213
    v_add_f32 v223, v214, v215
    v_add_f32 v216, v216, v220
    v_add_f32 v217, v217, v221
    v_add_f32 v218, v218, v222
    v_add_f32 v219, v219, v223
    v_add_f32 v216, v216, v217
    v_add_f32 v218, v218, v219
    v_add_f32 v216, v216, v218
    s_nop 1
    v_add_f32_dpp v216, v216, v216 row_ror:8 row_mask:0xf bank_mask:0xf
    s_nop 1
    v_add_f32_dpp v216, v216, v216 row_ror:4 row_mask:0xf bank_mask:0xf
    s_nop 1
    v_add_f32_dpp v216, v216, v216 row_ror:2 row_mask:0xf bank_mask:0xf
    s_nop 1
    v_add_f32_dpp v216, v216, v216 row_ror:1 row_mask:0xf bank_mask:0xf
    v_mov_b32 v217, v216
    s_nop 1
    v_permlane16_swap_b32 v216, v217
    v_add_f32 v216, v216, v217
    v_mov_b32 v217, v216
    s_nop 1
    v_permlane32_swap_b32 v216, v217
    v_add_f32 v216, v216, v217
    v_mul_f32 v216, 0x3a800000, v216
    v_sub_f32 v200, v200, v216
    v_sub_f32 v201, v201, v216
    v_sub_f32 v202, v202, v216
    v_sub_f32 v203, v203, v216
    v_sub_f32 v204, v204, v216
    v_sub_f32 v205, v205, v216
    v_sub_f32 v206, v206, v216
    v_sub_f32 v207, v207, v216
    v_sub_f32 v208, v208, v216
    v_sub_f32 v209, v209, v216
    v_sub_f32 v210, v210, v216
    v_sub_f32 v211, v211, v216
    v_sub_f32 v212, v212, v216
    v_sub_f32 v213, v213, v216
    v_sub_f32 v214, v214, v216
    v_sub_f32 v215, v215, v216
    v_mul_f32 v220, v200, v200
    v_mul_f32 v221, v201, v201
    v_mul_f32 v222, v202, v202
    v_mul_f32 v223, v203, v203
    v_fmac_f32 v220, v204, v204
    v_fmac_f32 v221, v205, v205
    v_fmac_f32 v222, v206, v206
    v_fmac_f32 v223, v207, v207
    v_fmac_f32 v220, v208, v208
    v_fmac_f32 v221, v209, v209
    v_fmac_f32 v222, v210, v210
    v_fmac_f32 v223, v211, v211
    v_fmac_f32 v220, v212, v212
    v_fmac_f32 v221, v213, v213
    v_fmac_f32 v222, v214, v214
    v_fmac_f32 v223, v215, v215
    v_add_f32 v220, v220, v221
    v_add_f32 v222, v222, v223
    v_add_f32 v217, v220, v222
    s_nop 1
    v_add_f32_dpp v217, v217, v217 row_ror:8 row_mask:0xf bank_mask:0xf
    s_nop 1
    v_add_f32_dpp v217, v217, v217 row_ror:4 row_mask:0xf bank_mask:0xf
    s_nop 1
    v_add_f32_dpp v217, v217, v217 row_ror:2 row_mask:0xf bank_mask:0xf
    s_nop 1
    v_add_f32_dpp v217, v217, v217 row_ror:1 row_mask:0xf bank_mask:0xf
    v_mov_b32 v218, v217
    s_nop 1
    v_permlane16_swap_b32 v217, v218
    v_add_f32 v217, v217, v218
    v_mov_b32 v218, v217
    s_nop 1
    v_permlane32_swap_b32 v217, v218
    v_add_f32 v217, v217, v218
    v_mul_f32 v217, 0x3a800000, v217
    v_cvt_pk_bf16_f32 v217, v217, v217
    v_lshlrev_b32 v217, 16, v217
    v_add_f32 v217, 0x3727c5ac, v217
    v_sub_f32 v216, 0, v216
    v_cvt_pk_bf16_f32 v217, v217, v217
    v_lshlrev_b32 v217, 16, v217
    v_sqrt_f32 v217, v217
    s_lshl_b32 s57, s57, 3
    s_add_u32 s57, s57, 29360128
    v_cvt_pk_bf16_f32 v216, v216, v217
    v_and_b32 v217, s47, v216
    s_lshl_b32 s36, s17, 8
    s_lshr_b32 s44, s38, 6
    s_mul_i32 s37, s36, s44
    s_add_u32 s59, s36, 256
    s_cmp_le_u32 s17, 1
    s_cselect_b32 s78, 2, 1
    s_lshl_b32 s78, s78, 8
    s_mul_i32 s79, s78, s44
    v_rcp_f32 v217, v217
    s_mov_b64 exec, 1
    buffer_store_dwordx2 v[216:217], v254, s[28:31], s57 offen sc1
    s_mov_b64 exec, -1
    s_mov_b32 s32, s10
    s_mov_b32 s33, s11
    s_mov_b32 s34, 7168
    s_mov_b32 s35, 0x20000
    s_mul_i32 s44, s18, 14
    s_lshl_b32 s45, s16, 3
    s_add_u32 s44, s44, s45
    s_add_u32 s44, s44, 64
    s_lshl_b32 s44, s44, 10
    s_add_u32 s48, s48, s44
    s_add_u32 s50, s48, 294912
    s_mov_b32 s51, 0xc0135761
    s_mov_b32 s52, 0xbdd2d3e8
    s_waitcnt vmcnt(13)
    s_barrier
    s_cmp_eq_u32 s16, 0
    s_cbranch_scc0 .g1_f3
    ds_read_b128 v[16:19], v5 offset:1792
    ds_read_b64_tr_b16 v[24:25], v6 offset:0
    ds_read_b64_tr_b16 v[26:27], v6 offset:3840
    ds_read_b128 v[20:23], v5 offset:5632
    ds_read_b64_tr_b16 v[28:29], v6 offset:64
    ds_read_b64_tr_b16 v[30:31], v6 offset:3904
    ds_read_b64_tr_b16 v[32:33], v6 offset:128
    ds_read_b64_tr_b16 v[34:35], v6 offset:3968
    ds_read_b64_tr_b16 v[36:37], v6 offset:192
    ds_read_b64_tr_b16 v[38:39], v6 offset:4032
    s_mov_b32 m0, s39
    s_mov_b64 exec, s[42:43]
    buffer_load_dwordx4 v3, s[20:23], s37 offen lds
    s_mov_b64 exec, -1
    s_mov_b64 exec, s[42:43]
    buffer_load_dwordx4 v4, s[20:23], s37 offen offset:896 lds
    s_mov_b64 exec, -1
    s_add_u32 m0, s39, 1792
    s_add_u32 s37, s37, s38
    buffer_load_dwordx4 v244, s[24:27], s36 offen lds
    s_add_u32 s39, s39, 30720
    s_cmp_eq_u32 s39, s13
    s_cselect_b32 s39, s12, s39
    buffer_load_dwordx4 v245, s[24:27], s36 offen offset:1024 lds
    s_add_u32 s36, s36, 64
    s_cmp_eq_u32 s36, s59
    s_cselect_b32 s36, s78, s36
    s_cselect_b32 s37, s79, s37
    s_cmp_eq_u32 s36, 2048
    s_cselect_b32 s36, 0x100000, s36
    s_cselect_b32 s37, 0x10000000, s37
    s_branch .g1_loopf4
.g1_loopf4d0:
    s_waitcnt lgkmcnt(0)
    v_mfma_f32_32x32x16_bf16 v[64:79], v[24:27], v[16:19], v[64:79]
    ds_read_b128 v[40:43], v243 offset:1792
    ds_read_b64_tr_b16 v[48:49], v6 offset:15360
    v_mfma_f32_32x32x16_bf16 v[80:95], v[24:27], v[20:23], v[80:95]
    ds_read_b64_tr_b16 v[50:51], v6 offset:19200
    ds_read_b128 v[44:47], v243 offset:5632
    v_mfma_f32_32x32x16_bf16 v[96:111], v[28:31], v[16:19], v[96:111]
    ds_read_b64_tr_b16 v[52:53], v6 offset:15424
    ds_read_b64_tr_b16 v[54:55], v6 offset:19264
    v_mfma_f32_32x32x16_bf16 v[112:127], v[28:31], v[20:23], v[112:127]
    ds_read_b64_tr_b16 v[56:57], v6 offset:15488
    ds_read_b64_tr_b16 v[58:59], v6 offset:19328
    v_mfma_f32_32x32x16_bf16 v[128:143], v[32:35], v[16:19], v[128:143]
    ds_read_b64_tr_b16 v[60:61], v6 offset:15552
    ds_read_b64_tr_b16 v[62:63], v6 offset:19392
    v_dot2c_f32_bf16 v248, s56, v24
    v_mfma_f32_32x32x16_bf16 v[144:159], v[32:35], v[20:23], v[144:159]
    s_add_u32 s46, s46, 1
    s_cmp_eq_u32 s46, 5
    s_cselect_b32 s41, -122880, s49
    s_cselect_b32 s46, 0, s46
    v_add_u32 v5, s41, v5
    v_add_u32 v6, s41, v6
    v_add_u32 v243, s41, v243
    v_dot2c_f32_bf16 v248, s56, v25
    v_mfma_f32_32x32x16_bf16 v[160:175], v[36:39], v[16:19], v[160:175]
    v_dot2c_f32_bf16 v248, s56, v26
    v_mfma_f32_32x32x16_bf16 v[176:191], v[36:39], v[20:23], v[176:191]
    v_dot2c_f32_bf16 v248, s56, v27
    s_sub_u32 s40, s40, 1
    s_waitcnt vmcnt(12) lgkmcnt(0)
    s_barrier
    v_mfma_f32_32x32x16_bf16 v[64:79], v[48:51], v[40:43], v[64:79]
    ds_read_b128 v[16:19], v5 offset:1792
    ds_read_b64_tr_b16 v[24:25], v6 offset:0
    v_mfma_f32_32x32x16_bf16 v[80:95], v[48:51], v[44:47], v[80:95]
    ds_read_b64_tr_b16 v[26:27], v6 offset:3840
    ds_read_b128 v[20:23], v5 offset:5632
    v_mfma_f32_32x32x16_bf16 v[96:111], v[52:55], v[40:43], v[96:111]
    ds_read_b64_tr_b16 v[28:29], v6 offset:64
    ds_read_b64_tr_b16 v[30:31], v6 offset:3904
    v_mfma_f32_32x32x16_bf16 v[112:127], v[52:55], v[44:47], v[112:127]
    ds_read_b64_tr_b16 v[32:33], v6 offset:128
    ds_read_b64_tr_b16 v[34:35], v6 offset:3968
    v_mfma_f32_32x32x16_bf16 v[128:143], v[56:59], v[40:43], v[128:143]
    ds_read_b64_tr_b16 v[36:37], v6 offset:192
    ds_read_b64_tr_b16 v[38:39], v6 offset:4032
    s_mov_b32 m0, s39
    s_mov_b64 exec, s[42:43]
    buffer_load_dwordx4 v3, s[20:23], s37 offen lds
    s_mov_b64 exec, -1
    v_dot2c_f32_bf16 v248, s56, v48
    v_mfma_f32_32x32x16_bf16 v[144:159], v[56:59], v[44:47], v[144:159]
    s_mov_b64 exec, s[42:43]
    buffer_load_dwordx4 v4, s[20:23], s37 offen offset:896 lds
    s_mov_b64 exec, -1
    s_add_u32 m0, s39, 1792
    s_add_u32 s37, s37, s38
    v_dot2c_f32_bf16 v248, s56, v49
    v_mfma_f32_32x32x16_bf16 v[160:175], v[60:63], v[40:43], v[160:175]
    buffer_load_dwordx4 v244, s[24:27], s36 offen lds
    s_add_u32 s39, s39, 30720
    s_cmp_eq_u32 s39, s13
    s_cselect_b32 s39, s12, s39
    v_dot2c_f32_bf16 v248, s56, v50
    v_mfma_f32_32x32x16_bf16 v[176:191], v[60:63], v[44:47], v[176:191]
    buffer_load_dwordx4 v245, s[24:27], s36 offen offset:1024 lds
    s_add_u32 s36, s36, 64
    s_cmp_eq_u32 s36, s59
    s_cselect_b32 s36, s78, s36
    s_cselect_b32 s37, s79, s37
    s_cmp_eq_u32 s36, 2048
    s_cselect_b32 s36, 0x100000, s36
    s_cselect_b32 s37, 0x10000000, s37
    v_dot2c_f32_bf16 v248, s56, v51
    s_cmp_lg_u32 s40, 0
    s_cbranch_scc1 .g1_loopf4d0
    s_branch .g1_pubf4
.g1_loopf4d1:
    s_waitcnt lgkmcnt(0)
    v_mfma_f32_32x32x16_bf16 v[64:79], v[24:27], v[16:19], v[64:79]
    ds_read_b128 v[40:43], v243 offset:1792
    ds_read_b64_tr_b16 v[48:49], v6 offset:15360
    v_mfma_f32_32x32x16_bf16 v[80:95], v[24:27], v[20:23], v[80:95]
    ds_read_b64_tr_b16 v[50:51], v6 offset:19200
    ds_read_b128 v[44:47], v243 offset:5632
    v_mfma_f32_32x32x16_bf16 v[96:111], v[28:31], v[16:19], v[96:111]
    ds_read_b64_tr_b16 v[52:53], v6 offset:15424
    ds_read_b64_tr_b16 v[54:55], v6 offset:19264
    v_mfma_f32_32x32x16_bf16 v[112:127], v[28:31], v[20:23], v[112:127]
    ds_read_b64_tr_b16 v[56:57], v6 offset:15488
    ds_read_b64_tr_b16 v[58:59], v6 offset:19328
    v_mfma_f32_32x32x16_bf16 v[128:143], v[32:35], v[16:19], v[128:143]
    ds_read_b64_tr_b16 v[60:61], v6 offset:15552
    ds_read_b64_tr_b16 v[62:63], v6 offset:19392
    v_dot2c_f32_bf16 v248, s56, v28
    v_mfma_f32_32x32x16_bf16 v[144:159], v[32:35], v[20:23], v[144:159]
    s_add_u32 s46, s46, 1
    s_cmp_eq_u32 s46, 5
    s_cselect_b32 s41, -122880, s49
    s_cselect_b32 s46, 0, s46
    v_add_u32 v5, s41, v5
    v_add_u32 v6, s41, v6
    v_add_u32 v243, s41, v243
    v_dot2c_f32_bf16 v248, s56, v29
    v_mfma_f32_32x32x16_bf16 v[160:175], v[36:39], v[16:19], v[160:175]
    v_dot2c_f32_bf16 v248, s56, v30
    v_mfma_f32_32x32x16_bf16 v[176:191], v[36:39], v[20:23], v[176:191]
    v_dot2c_f32_bf16 v248, s56, v31
    s_sub_u32 s40, s40, 1
    s_waitcnt vmcnt(12) lgkmcnt(0)
    s_barrier
    v_mfma_f32_32x32x16_bf16 v[64:79], v[48:51], v[40:43], v[64:79]
    ds_read_b128 v[16:19], v5 offset:1792
    ds_read_b64_tr_b16 v[24:25], v6 offset:0
    v_mfma_f32_32x32x16_bf16 v[80:95], v[48:51], v[44:47], v[80:95]
    ds_read_b64_tr_b16 v[26:27], v6 offset:3840
    ds_read_b128 v[20:23], v5 offset:5632
    v_mfma_f32_32x32x16_bf16 v[96:111], v[52:55], v[40:43], v[96:111]
    ds_read_b64_tr_b16 v[28:29], v6 offset:64
    ds_read_b64_tr_b16 v[30:31], v6 offset:3904
    v_mfma_f32_32x32x16_bf16 v[112:127], v[52:55], v[44:47], v[112:127]
    ds_read_b64_tr_b16 v[32:33], v6 offset:128
    ds_read_b64_tr_b16 v[34:35], v6 offset:3968
    v_mfma_f32_32x32x16_bf16 v[128:143], v[56:59], v[40:43], v[128:143]
    ds_read_b64_tr_b16 v[36:37], v6 offset:192
    ds_read_b64_tr_b16 v[38:39], v6 offset:4032
    s_mov_b32 m0, s39
    s_mov_b64 exec, s[42:43]
    buffer_load_dwordx4 v3, s[20:23], s37 offen lds
    s_mov_b64 exec, -1
    v_dot2c_f32_bf16 v248, s56, v52
    v_mfma_f32_32x32x16_bf16 v[144:159], v[56:59], v[44:47], v[144:159]
    s_mov_b64 exec, s[42:43]
    buffer_load_dwordx4 v4, s[20:23], s37 offen offset:896 lds
    s_mov_b64 exec, -1
    s_add_u32 m0, s39, 1792
    s_add_u32 s37, s37, s38
    v_dot2c_f32_bf16 v248, s56, v53
    v_mfma_f32_32x32x16_bf16 v[160:175], v[60:63], v[40:43], v[160:175]
    buffer_load_dwordx4 v244, s[24:27], s36 offen lds
    s_add_u32 s39, s39, 30720
    s_cmp_eq_u32 s39, s13
    s_cselect_b32 s39, s12, s39
    v_dot2c_f32_bf16 v248, s56, v54
    v_mfma_f32_32x32x16_bf16 v[176:191], v[60:63], v[44:47], v[176:191]
    buffer_load_dwordx4 v245, s[24:27], s36 offen offset:1024 lds
    s_add_u32 s36, s36, 64
    s_cmp_eq_u32 s36, s59
    s_cselect_b32 s36, s78, s36
    s_cselect_b32 s37, s79, s37
    s_cmp_eq_u32 s36, 2048
    s_cselect_b32 s36, 0x100000, s36
    s_cselect_b32 s37, 0x10000000, s37
    v_dot2c_f32_bf16 v248, s56, v55
    s_cmp_lg_u32 s40, 0
    s_cbranch_scc1 .g1_loopf4d1
    s_branch .g1_pubf4
.g1_loopf4d2:
    s_waitcnt lgkmcnt(0)
    v_mfma_f32_32x32x16_bf16 v[64:79], v[24:27], v[16:19], v[64:79]
    ds_read_b128 v[40:43], v243 offset:1792
    ds_read_b64_tr_b16 v[48:49], v6 offset:15360
    v_mfma_f32_32x32x16_bf16 v[80:95], v[24:27], v[20:23], v[80:95]
    ds_read_b64_tr_b16 v[50:51], v6 offset:19200
    ds_read_b128 v[44:47], v243 offset:5632
    v_mfma_f32_32x32x16_bf16 v[96:111], v[28:31], v[16:19], v[96:111]
    ds_read_b64_tr_b16 v[52:53], v6 offset:15424
    ds_read_b64_tr_b16 v[54:55], v6 offset:19264
    v_mfma_f32_32x32x16_bf16 v[112:127], v[28:31], v[20:23], v[112:127]
    ds_read_b64_tr_b16 v[56:57], v6 offset:15488
    ds_read_b64_tr_b16 v[58:59], v6 offset:19328
    v_mfma_f32_32x32x16_bf16 v[128:143], v[32:35], v[16:19], v[128:143]
    ds_read_b64_tr_b16 v[60:61], v6 offset:15552
    ds_read_b64_tr_b16 v[62:63], v6 offset:19392
    v_dot2c_f32_bf16 v248, s56, v32
    v_mfma_f32_32x32x16_bf16 v[144:159], v[32:35], v[20:23], v[144:159]
    s_add_u32 s46, s46, 1
    s_cmp_eq_u32 s46, 5
    s_cselect_b32 s41, -122880, s49
    s_cselect_b32 s46, 0, s46
    v_add_u32 v5, s41, v5
    v_add_u32 v6, s41, v6
    v_add_u32 v243, s41, v243
    v_dot2c_f32_bf16 v248, s56, v33
    v_mfma_f32_32x32x16_bf16 v[160:175], v[36:39], v[16:19], v[160:175]
    v_dot2c_f32_bf16 v248, s56, v34
    v_mfma_f32_32x32x16_bf16 v[176:191], v[36:39], v[20:23], v[176:191]
    v_dot2c_f32_bf16 v248, s56, v35
    s_sub_u32 s40, s40, 1
    s_waitcnt vmcnt(12) lgkmcnt(0)
    s_barrier
    v_mfma_f32_32x32x16_bf16 v[64:79], v[48:51], v[40:43], v[64:79]
    ds_read_b128 v[16:19], v5 offset:1792
    ds_read_b64_tr_b16 v[24:25], v6 offset:0
    v_mfma_f32_32x32x16_bf16 v[80:95], v[48:51], v[44:47], v[80:95]
    ds_read_b64_tr_b16 v[26:27], v6 offset:3840
    ds_read_b128 v[20:23], v5 offset:5632
    v_mfma_f32_32x32x16_bf16 v[96:111], v[52:55], v[40:43], v[96:111]
    ds_read_b64_tr_b16 v[28:29], v6 offset:64
    ds_read_b64_tr_b16 v[30:31], v6 offset:3904
    v_mfma_f32_32x32x16_bf16 v[112:127], v[52:55], v[44:47], v[112:127]
    ds_read_b64_tr_b16 v[32:33], v6 offset:128
    ds_read_b64_tr_b16 v[34:35], v6 offset:3968
    v_mfma_f32_32x32x16_bf16 v[128:143], v[56:59], v[40:43], v[128:143]
    ds_read_b64_tr_b16 v[36:37], v6 offset:192
    ds_read_b64_tr_b16 v[38:39], v6 offset:4032
    s_mov_b32 m0, s39
    s_mov_b64 exec, s[42:43]
    buffer_load_dwordx4 v3, s[20:23], s37 offen lds
    s_mov_b64 exec, -1
    v_dot2c_f32_bf16 v248, s56, v56
    v_mfma_f32_32x32x16_bf16 v[144:159], v[56:59], v[44:47], v[144:159]
    s_mov_b64 exec, s[42:43]
    buffer_load_dwordx4 v4, s[20:23], s37 offen offset:896 lds
    s_mov_b64 exec, -1
    s_add_u32 m0, s39, 1792
    s_add_u32 s37, s37, s38
    v_dot2c_f32_bf16 v248, s56, v57
    v_mfma_f32_32x32x16_bf16 v[160:175], v[60:63], v[40:43], v[160:175]
    buffer_load_dwordx4 v244, s[24:27], s36 offen lds
    s_add_u32 s39, s39, 30720
    s_cmp_eq_u32 s39, s13
    s_cselect_b32 s39, s12, s39
    v_dot2c_f32_bf16 v248, s56, v58
    v_mfma_f32_32x32x16_bf16 v[176:191], v[60:63], v[44:47], v[176:191]
    buffer_load_dwordx4 v245, s[24:27], s36 offen offset:1024 lds
    s_add_u32 s36, s36, 64
    s_cmp_eq_u32 s36, s59
    s_cselect_b32 s36, s78, s36
    s_cselect_b32 s37, s79, s37
    s_cmp_eq_u32 s36, 2048
    s_cselect_b32 s36, 0x100000, s36
    s_cselect_b32 s37, 0x10000000, s37
    v_dot2c_f32_bf16 v248, s56, v59
    s_cmp_lg_u32 s40, 0
    s_cbranch_scc1 .g1_loopf4d2
    s_branch .g1_pubf4
.g1_loopf4d3:
    s_waitcnt lgkmcnt(0)
    v_mfma_f32_32x32x16_bf16 v[64:79], v[24:27], v[16:19], v[64:79]
    ds_read_b128 v[40:43], v243 offset:1792
    ds_read_b64_tr_b16 v[48:49], v6 offset:15360
    v_mfma_f32_32x32x16_bf16 v[80:95], v[24:27], v[20:23], v[80:95]
    ds_read_b64_tr_b16 v[50:51], v6 offset:19200
    ds_read_b128 v[44:47], v243 offset:5632
    v_mfma_f32_32x32x16_bf16 v[96:111], v[28:31], v[16:19], v[96:111]
    ds_read_b64_tr_b16 v[52:53], v6 offset:15424
    ds_read_b64_tr_b16 v[54:55], v6 offset:19264
    v_mfma_f32_32x32x16_bf16 v[112:127], v[28:31], v[20:23], v[112:127]
    ds_read_b64_tr_b16 v[56:57], v6 offset:15488
    ds_read_b64_tr_b16 v[58:59], v6 offset:19328
    v_mfma_f32_32x32x16_bf16 v[128:143], v[32:35], v[16:19], v[128:143]
    ds_read_b64_tr_b16 v[60:61], v6 offset:15552
    ds_read_b64_tr_b16 v[62:63], v6 offset:19392
    v_dot2c_f32_bf16 v248, s56, v36
    v_mfma_f32_32x32x16_bf16 v[144:159], v[32:35], v[20:23], v[144:159]
    s_add_u32 s46, s46, 1
    s_cmp_eq_u32 s46, 5
    s_cselect_b32 s41, -122880, s49
    s_cselect_b32 s46, 0, s46
    v_add_u32 v5, s41, v5
    v_add_u32 v6, s41, v6
    v_add_u32 v243, s41, v243
    v_dot2c_f32_bf16 v248, s56, v37
    v_mfma_f32_32x32x16_bf16 v[160:175], v[36:39], v[16:19], v[160:175]
    v_dot2c_f32_bf16 v248, s56, v38
    v_mfma_f32_32x32x16_bf16 v[176:191], v[36:39], v[20:23], v[176:191]
    v_dot2c_f32_bf16 v248, s56, v39
    s_sub_u32 s40, s40, 1
    s_waitcnt vmcnt(12) lgkmcnt(0)
    s_barrier
    v_mfma_f32_32x32x16_bf16 v[64:79], v[48:51], v[40:43], v[64:79]
    ds_read_b128 v[16:19], v5 offset:1792
    ds_read_b64_tr_b16 v[24:25], v6 offset:0
    v_mfma_f32_32x32x16_bf16 v[80:95], v[48:51], v[44:47], v[80:95]
    ds_read_b64_tr_b16 v[26:27], v6 offset:3840
    ds_read_b128 v[20:23], v5 offset:5632
    v_mfma_f32_32x32x16_bf16 v[96:111], v[52:55], v[40:43], v[96:111]
    ds_read_b64_tr_b16 v[28:29], v6 offset:64
    ds_read_b64_tr_b16 v[30:31], v6 offset:3904
    v_mfma_f32_32x32x16_bf16 v[112:127], v[52:55], v[44:47], v[112:127]
    ds_read_b64_tr_b16 v[32:33], v6 offset:128
    ds_read_b64_tr_b16 v[34:35], v6 offset:3968
    v_mfma_f32_32x32x16_bf16 v[128:143], v[56:59], v[40:43], v[128:143]
    ds_read_b64_tr_b16 v[36:37], v6 offset:192
    ds_read_b64_tr_b16 v[38:39], v6 offset:4032
    s_mov_b32 m0, s39
    s_mov_b64 exec, s[42:43]
    buffer_load_dwordx4 v3, s[20:23], s37 offen lds
    s_mov_b64 exec, -1
    v_dot2c_f32_bf16 v248, s56, v60
    v_mfma_f32_32x32x16_bf16 v[144:159], v[56:59], v[44:47], v[144:159]
    s_mov_b64 exec, s[42:43]
    buffer_load_dwordx4 v4, s[20:23], s37 offen offset:896 lds
    s_mov_b64 exec, -1
    s_add_u32 m0, s39, 1792
    s_add_u32 s37, s37, s38
    v_dot2c_f32_bf16 v248, s56, v61
    v_mfma_f32_32x32x16_bf16 v[160:175], v[60:63], v[40:43], v[160:175]
    buffer_load_dwordx4 v244, s[24:27], s36 offen lds
    s_add_u32 s39, s39, 30720
    s_cmp_eq_u32 s39, s13
    s_cselect_b32 s39, s12, s39
    v_dot2c_f32_bf16 v248, s56, v62
    v_mfma_f32_32x32x16_bf16 v[176:191], v[60:63], v[44:47], v[176:191]
    buffer_load_dwordx4 v245, s[24:27], s36 offen offset:1024 lds
    s_add_u32 s36, s36, 64
    s_cmp_eq_u32 s36, s59
    s_cselect_b32 s36, s78, s36
    s_cselect_b32 s37, s79, s37
    s_cmp_eq_u32 s36, 2048
    s_cselect_b32 s36, 0x100000, s36
    s_cselect_b32 s37, 0x10000000, s37
    v_dot2c_f32_bf16 v248, s56, v63
    s_cmp_lg_u32 s40, 0
    s_cbranch_scc1 .g1_loopf4d3
    s_branch .g1_pubf4
.g1_loopf4:
    s_waitcnt lgkmcnt(0)
    v_mfma_f32_32x32x16_bf16 v[64:79], v[24:27], v[16:19], v[64:79]
    ds_read_b128 v[40:43], v243 offset:1792
    ds_read_b64_tr_b16 v[48:49], v6 offset:15360
    v_mfma_f32_32x32x16_bf16 v[80:95], v[24:27], v[20:23], v[80:95]
    ds_read_b64_tr_b16 v[50:51], v6 offset:19200
    ds_read_b128 v[44:47], v243 offset:5632
    v_mfma_f32_32x32x16_bf16 v[96:111], v[28:31], v[16:19], v[96:111]
    ds_read_b64_tr_b16 v[52:53], v6 offset:15424
    ds_read_b64_tr_b16 v[54:55], v6 offset:19264
    v_mfma_f32_32x32x16_bf16 v[112:127], v[28:31], v[20:23], v[112:127]
    ds_read_b64_tr_b16 v[56:57], v6 offset:15488
    ds_read_b64_tr_b16 v[58:59], v6 offset:19328
    v_mfma_f32_32x32x16_bf16 v[128:143], v[32:35], v[16:19], v[128:143]
    ds_read_b64_tr_b16 v[60:61], v6 offset:15552
    ds_read_b64_tr_b16 v[62:63], v6 offset:19392
    v_mfma_f32_32x32x16_bf16 v[144:159], v[32:35], v[20:23], v[144:159]
    s_add_u32 s46, s46, 1
    s_cmp_eq_u32 s46, 5
    s_cselect_b32 s41, -122880, s49
    s_cselect_b32 s46, 0, s46
    v_add_u32 v5, s41, v5
    v_add_u32 v6, s41, v6
    v_add_u32 v243, s41, v243
    v_mfma_f32_32x32x16_bf16 v[160:175], v[36:39], v[16:19], v[160:175]
    v_mfma_f32_32x32x16_bf16 v[176:191], v[36:39], v[20:23], v[176:191]
    s_sub_u32 s40, s40, 1
    s_waitcnt vmcnt(12) lgkmcnt(0)
    s_barrier
    v_mfma_f32_32x32x16_bf16 v[64:79], v[48:51], v[40:43], v[64:79]
    ds_read_b128 v[16:19], v5 offset:1792
    ds_read_b64_tr_b16 v[24:25], v6 offset:0
    v_mfma_f32_32x32x16_bf16 v[80:95], v[48:51], v[44:47], v[80:95]
    ds_read_b64_tr_b16 v[26:27], v6 offset:3840
    ds_read_b128 v[20:23], v5 offset:5632
    v_mfma_f32_32x32x16_bf16 v[96:111], v[52:55], v[40:43], v[96:111]
    ds_read_b64_tr_b16 v[28:29], v6 offset:64
    ds_read_b64_tr_b16 v[30:31], v6 offset:3904
    v_mfma_f32_32x32x16_bf16 v[112:127], v[52:55], v[44:47], v[112:127]
    ds_read_b64_tr_b16 v[32:33], v6 offset:128
    ds_read_b64_tr_b16 v[34:35], v6 offset:3968
    v_mfma_f32_32x32x16_bf16 v[128:143], v[56:59], v[40:43], v[128:143]
    ds_read_b64_tr_b16 v[36:37], v6 offset:192
    ds_read_b64_tr_b16 v[38:39], v6 offset:4032
    s_mov_b32 m0, s39
    s_mov_b64 exec, s[42:43]
    buffer_load_dwordx4 v3, s[20:23], s37 offen lds
    s_mov_b64 exec, -1
    v_mfma_f32_32x32x16_bf16 v[144:159], v[56:59], v[44:47], v[144:159]
    s_mov_b64 exec, s[42:43]
    buffer_load_dwordx4 v4, s[20:23], s37 offen offset:896 lds
    s_mov_b64 exec, -1
    s_add_u32 m0, s39, 1792
    s_add_u32 s37, s37, s38
    v_mfma_f32_32x32x16_bf16 v[160:175], v[60:63], v[40:43], v[160:175]
    buffer_load_dwordx4 v244, s[24:27], s36 offen lds
    s_add_u32 s39, s39, 30720
    s_cmp_eq_u32 s39, s13
    s_cselect_b32 s39, s12, s39
    v_mfma_f32_32x32x16_bf16 v[176:191], v[60:63], v[44:47], v[176:191]
    buffer_load_dwordx4 v245, s[24:27], s36 offen offset:1024 lds
    s_add_u32 s36, s36, 64
    s_cmp_eq_u32 s36, s59
    s_cselect_b32 s36, s78, s36
    s_cselect_b32 s37, s79, s37
    s_cmp_eq_u32 s36, 2048
    s_cselect_b32 s36, 0x100000, s36
    s_cselect_b32 s37, 0x10000000, s37
    s_cmp_lg_u32 s40, 0
    s_cbranch_scc1 .g1_loopf4
    s_add_u32 s58, s58, 1
    s_mov_b32 s40, 4
    s_cmp_eq_u32 s58, 2
    s_cbranch_scc1 .g1_loopf4
    s_cmp_eq_u32 s58, 3
    s_cbranch_scc1 .g1_p2f4
    s_cmp_eq_u32 s58, 4
    s_cbranch_scc1 .g1_p3f4
    s_cmp_eq_u32 s58, 5
    s_cbranch_scc1 .g1_p4f4
    s_sub_u32 s78, s59, 0
    s_sub_u32 s59, s59, 256
    s_lshr_b32 s44, s38, 6
    s_mul_i32 s79, s78, s44
    s_cmp_eq_u32 s15, 0
    s_cbranch_scc1 .g1_loopf4d0
    s_cmp_eq_u32 s15, 1
    s_cbranch_scc1 .g1_loopf4d1
    s_cmp_eq_u32 s15, 2
    s_cbranch_scc1 .g1_loopf4d2
    s_cmp_eq_u32 s15, 3
    s_cbranch_scc1 .g1_loopf4d3
    s_branch .g1_loopf4
.g1_p2f4:
    s_mov_b32 s40, 12
    s_mov_b32 s72, s64
    s_mov_b32 s73, s65
    s_mov_b32 s74, 7340032
    s_mov_b32 s75, 0x20000
    s_sub_u32 s44, s2, 128
    s_lshl_b32 s44, s44, 3
    s_add_u32 s44, s44, s14
    s_mul_i32 s45, s44, 7168
    s_lshl_b32 s44, s44, 11
    v_lshlrev_b32 v13, 7, v1
    s_mov_b64 exec, s[42:43]
    buffer_load_dword v220, v13, s[72:75], s45 offen
    s_mov_b32 s72, s62
    s_mov_b32 s73, s63
    s_mov_b32 s74, 2097152
    s_mov_b32 s75, 0x20000
    s_mov_b64 exec, 0xffff
    buffer_load_dword v221, v13, s[72:75], s44 offen
    s_mov_b64 exec, -1
    s_cmp_eq_u32 s14, 0
    s_cbranch_scc0 .g1_loopf4
    v_mov_b32 v248, 1
    s_mov_b64 exec, 1
    buffer_atomic_add v248, v254, s[68:71], 0 offen offset:8 sc1
    s_mov_b64 exec, -1
    s_branch .g1_loopf4
.g1_pubf4:
    v_mov_b32 v249, v248
    s_nop 1
    v_permlane32_swap_b32 v248, v249
    v_add_f32 v248, v248, v249
    v_and_b32 v249, 31, v1
    v_lshlrev_b32 v249, 5, v249
    s_lshl_b32 s44, s15, 10
    s_lshl_b32 s45, s17, 2
    s_add_u32 s44, s44, s45
    s_add_u32 s44, s44, s60
    s_mov_b32 exec_hi, 0
    buffer_store_dword v248, v249, s[28:31], s44 offen sc1
    s_mov_b64 exec, -1
    s_mov_b32 s58, 2
    s_mov_b32 s40, 4
    s_branch .g1_loopf4
.g1_p3f4:
    buffer_load_dwordx4 v[216:219], v254, s[68:71], 0 offen
    s_branch .g1_loopf4
.g1_p4f4:
    s_mov_b32 s44, 16384
.g1_p4lf4:
    v_readfirstlane_b32 s45, v218
    v_readfirstlane_b32 s76, v216
    v_readfirstlane_b32 s77, v217
    s_cmp_eq_u32 s45, 256
    s_cbranch_scc1 .g1_p4okf4
    buffer_load_dwordx4 v[216:219], v254, s[68:71], 0 offen sc1
    s_sub_u32 s44, s44, 1
    s_waitcnt vmcnt(0)
    s_cmp_lg_u32 s44, 0
    s_cbranch_scc1 .g1_p4lf4
.g1_p4okf4:
    v_and_b32 v249, 31, v1
    v_lshlrev_b32 v248, 3, v249
    v_lshlrev_b32 v249, 5, v249
    v_lshl_add_u32 v249, v7, 4, v249
    buffer_load_dwordx2 v[240:241], v248, s[28:31], s61 offen sc1
    buffer_load_dwordx2 v[246:247], v248, s[28:31], s61 offen offset:256 sc1
    buffer_load_dwordx4 v[224:227], v249, s[28:31], s60 offen offset:0 sc1
    buffer_load_dwordx4 v[228:231], v249, s[28:31], s60 offen offset:1024 sc1
    buffer_load_dwordx4 v[232:235], v249, s[28:31], s60 offen offset:2048 sc1
    buffer_load_dwordx4 v[236:239], v249, s[28:31], s60 offen offset:3072 sc1
    buffer_load_ushort v250, v12, s[32:35], 0 offen offset:0
    buffer_load_ushort v251, v12, s[32:35], 0 offen offset:64
    buffer_load_ushort v252, v12, s[32:35], 0 offen offset:128
    buffer_load_ushort v253, v12, s[32:35], 0 offen offset:192
    s_waitcnt lgkmcnt(0)
    v_mfma_f32_32x32x16_bf16 v[64:79], v[24:27], v[16:19], v[64:79]
    ds_read_b128 v[40:43], v243 offset:1792
    ds_read_b64_tr_b16 v[48:49], v6 offset:15360
    v_mfma_f32_32x32x16_bf16 v[80:95], v[24:27], v[20:23], v[80:95]
    ds_read_b64_tr_b16 v[50:51], v6 offset:19200
    ds_read_b128 v[44:47], v243 offset:5632
    v_mfma_f32_32x32x16_bf16 v[96:111], v[28:31], v[16:19], v[96:111]
    ds_read_b64_tr_b16 v[52:53], v6 offset:15424
    ds_read_b64_tr_b16 v[54:55], v6 offset:19264
    v_mfma_f32_32x32x16_bf16 v[112:127], v[28:31], v[20:23], v[112:127]
    ds_read_b64_tr_b16 v[56:57], v6 offset:15488
    ds_read_b64_tr_b16 v[58:59], v6 offset:19328
    v_mfma_f32_32x32x16_bf16 v[128:143], v[32:35], v[16:19], v[128:143]
    ds_read_b64_tr_b16 v[60:61], v6 offset:15552
    ds_read_b64_tr_b16 v[62:63], v6 offset:19392
    v_mfma_f32_32x32x16_bf16 v[144:159], v[32:35], v[20:23], v[144:159]
    s_add_u32 s46, s46, 1
    s_cmp_eq_u32 s46, 5
    s_cselect_b32 s41, -122880, s49
    s_cselect_b32 s46, 0, s46
    v_add_u32 v5, s41, v5
    v_add_u32 v6, s41, v6
    v_add_u32 v243, s41, v243
    v_mfma_f32_32x32x16_bf16 v[160:175], v[36:39], v[16:19], v[160:175]
    v_mfma_f32_32x32x16_bf16 v[176:191], v[36:39], v[20:23], v[176:191]
    s_waitcnt vmcnt(22) lgkmcnt(0)
    s_barrier
    v_mfma_f32_32x32x16_bf16 v[64:79], v[48:51], v[40:43], v[64:79]
    ds_read_b128 v[16:19], v5 offset:1792
    ds_read_b64_tr_b16 v[24:25], v6 offset:0
    v_mfma_f32_32x32x16_bf16 v[80:95], v[48:51], v[44:47], v[80:95]
    ds_read_b64_tr_b16 v[26:27], v6 offset:3840
    ds_read_b128 v[20:23], v5 offset:5632
    v_mfma_f32_32x32x16_bf16 v[96:111], v[52:55], v[40:43], v[96:111]
    ds_read_b64_tr_b16 v[28:29], v6 offset:64
    ds_read_b64_tr_b16 v[30:31], v6 offset:3904
    v_mfma_f32_32x32x16_bf16 v[112:127], v[52:55], v[44:47], v[112:127]
    ds_read_b64_tr_b16 v[32:33], v6 offset:128
    ds_read_b64_tr_b16 v[34:35], v6 offset:3968
    v_mfma_f32_32x32x16_bf16 v[128:143], v[56:59], v[40:43], v[128:143]
    ds_read_b64_tr_b16 v[36:37], v6 offset:192
    ds_read_b64_tr_b16 v[38:39], v6 offset:4032
    v_mfma_f32_32x32x16_bf16 v[144:159], v[56:59], v[44:47], v[144:159]
    v_mfma_f32_32x32x16_bf16 v[160:175], v[60:63], v[40:43], v[160:175]
    v_mfma_f32_32x32x16_bf16 v[176:191], v[60:63], v[44:47], v[176:191]
    s_waitcnt lgkmcnt(0)
    v_mfma_f32_32x32x16_bf16 v[64:79], v[24:27], v[16:19], v[64:79]
    ds_read_b128 v[40:43], v243 offset:1792
    ds_read_b64_tr_b16 v[48:49], v6 offset:15360
    v_mfma_f32_32x32x16_bf16 v[80:95], v[24:27], v[20:23], v[80:95]
    ds_read_b64_tr_b16 v[50:51], v6 offset:19200
    ds_read_b128 v[44:47], v243 offset:5632
    v_mfma_f32_32x32x16_bf16 v[96:111], v[28:31], v[16:19], v[96:111]
    ds_read_b64_tr_b16 v[52:53], v6 offset:15424
    ds_read_b64_tr_b16 v[54:55], v6 offset:19264
    v_mfma_f32_32x32x16_bf16 v[112:127], v[28:31], v[20:23], v[112:127]
    ds_read_b64_tr_b16 v[56:57], v6 offset:15488
    ds_read_b64_tr_b16 v[58:59], v6 offset:19328
    v_mfma_f32_32x32x16_bf16 v[128:143], v[32:35], v[16:19], v[128:143]
    ds_read_b64_tr_b16 v[60:61], v6 offset:15552
    ds_read_b64_tr_b16 v[62:63], v6 offset:19392
    v_mfma_f32_32x32x16_bf16 v[144:159], v[32:35], v[20:23], v[144:159]
    s_add_u32 s46, s46, 1
    s_cmp_eq_u32 s46, 5
    s_cselect_b32 s41, -122880, s49
    s_cselect_b32 s46, 0, s46
    v_add_u32 v5, s41, v5
    v_add_u32 v6, s41, v6
    v_add_u32 v243, s41, v243
    v_mfma_f32_32x32x16_bf16 v[160:175], v[36:39], v[16:19], v[160:175]
    v_mfma_f32_32x32x16_bf16 v[176:191], v[36:39], v[20:23], v[176:191]
    s_waitcnt vmcnt(18) lgkmcnt(0)
    s_barrier
    v_mfma_f32_32x32x16_bf16 v[64:79], v[48:51], v[40:43], v[64:79]
    ds_read_b128 v[16:19], v5 offset:1792
    ds_read_b64_tr_b16 v[24:25], v6 offset:0
    v_mfma_f32_32x32x16_bf16 v[80:95], v[48:51], v[44:47], v[80:95]
    ds_read_b64_tr_b16 v[26:27], v6 offset:3840
    ds_read_b128 v[20:23], v5 offset:5632
    v_mfma_f32_32x32x16_bf16 v[96:111], v[52:55], v[40:43], v[96:111]
    ds_read_b64_tr_b16 v[28:29], v6 offset:64
    ds_read_b64_tr_b16 v[30:31], v6 offset:3904
    v_mfma_f32_32x32x16_bf16 v[112:127], v[52:55], v[44:47], v[112:127]
    ds_read_b64_tr_b16 v[32:33], v6 offset:128
    ds_read_b64_tr_b16 v[34:35], v6 offset:3968
    v_mfma_f32_32x32x16_bf16 v[128:143], v[56:59], v[40:43], v[128:143]
    ds_read_b64_tr_b16 v[36:37], v6 offset:192
    ds_read_b64_tr_b16 v[38:39], v6 offset:4032
    v_mfma_f32_32x32x16_bf16 v[144:159], v[56:59], v[44:47], v[144:159]
    v_mfma_f32_32x32x16_bf16 v[160:175], v[60:63], v[40:43], v[160:175]
    v_mfma_f32_32x32x16_bf16 v[176:191], v[60:63], v[44:47], v[176:191]
    s_waitcnt lgkmcnt(0)
    v_mfma_f32_32x32x16_bf16 v[64:79], v[24:27], v[16:19], v[64:79]
    ds_read_b128 v[40:43], v243 offset:1792
    ds_read_b64_tr_b16 v[48:49], v6 offset:15360
    v_mfma_f32_32x32x16_bf16 v[80:95], v[24:27], v[20:23], v[80:95]
    ds_read_b64_tr_b16 v[50:51], v6 offset:19200
    ds_read_b128 v[44:47], v243 offset:5632
    v_mfma_f32_32x32x16_bf16 v[96:111], v[28:31], v[16:19], v[96:111]
    ds_read_b64_tr_b16 v[52:53], v6 offset:15424
    ds_read_b64_tr_b16 v[54:55], v6 offset:19264
    v_mfma_f32_32x32x16_bf16 v[112:127], v[28:31], v[20:23], v[112:127]
    ds_read_b64_tr_b16 v[56:57], v6 offset:15488
    ds_read_b64_tr_b16 v[58:59], v6 offset:19328
    v_mfma_f32_32x32x16_bf16 v[128:143], v[32:35], v[16:19], v[128:143]
    ds_read_b64_tr_b16 v[60:61], v6 offset:15552
    ds_read_b64_tr_b16 v[62:63], v6 offset:19392
    v_mfma_f32_32x32x16_bf16 v[144:159], v[32:35], v[20:23], v[144:159]
    s_add_u32 s46, s46, 1
    s_cmp_eq_u32 s46, 5
    s_cselect_b32 s41, -122880, s49
    s_cselect_b32 s46, 0, s46
    v_add_u32 v5, s41, v5
    v_add_u32 v6, s41, v6
    v_add_u32 v243, s41, v243
    v_mfma_f32_32x32x16_bf16 v[160:175], v[36:39], v[16:19], v[160:175]
    v_mfma_f32_32x32x16_bf16 v[176:191], v[36:39], v[20:23], v[176:191]
    s_waitcnt vmcnt(14) lgkmcnt(0)
    s_barrier
    v_mfma_f32_32x32x16_bf16 v[64:79], v[48:51], v[40:43], v[64:79]
    ds_read_b128 v[16:19], v5 offset:1792
    ds_read_b64_tr_b16 v[24:25], v6 offset:0
    v_mfma_f32_32x32x16_bf16 v[80:95], v[48:51], v[44:47], v[80:95]
    ds_read_b64_tr_b16 v[26:27], v6 offset:3840
    ds_read_b128 v[20:23], v5 offset:5632
    v_mfma_f32_32x32x16_bf16 v[96:111], v[52:55], v[40:43], v[96:111]
    ds_read_b64_tr_b16 v[28:29], v6 offset:64
    ds_read_b64_tr_b16 v[30:31], v6 offset:3904
    v_mfma_f32_32x32x16_bf16 v[112:127], v[52:55], v[44:47], v[112:127]
    ds_read_b64_tr_b16 v[32:33], v6 offset:128
    ds_read_b64_tr_b16 v[34:35], v6 offset:3968
    v_mfma_f32_32x32x16_bf16 v[128:143], v[56:59], v[40:43], v[128:143]
    ds_read_b64_tr_b16 v[36:37], v6 offset:192
    ds_read_b64_tr_b16 v[38:39], v6 offset:4032
    v_mfma_f32_32x32x16_bf16 v[144:159], v[56:59], v[44:47], v[144:159]
    v_mfma_f32_32x32x16_bf16 v[160:175], v[60:63], v[40:43], v[160:175]
    v_mfma_f32_32x32x16_bf16 v[176:191], v[60:63], v[44:47], v[176:191]
    s_waitcnt lgkmcnt(0)
    v_mfma_f32_32x32x16_bf16 v[64:79], v[24:27], v[16:19], v[64:79]
    ds_read_b128 v[40:43], v243 offset:1792
    ds_read_b64_tr_b16 v[48:49], v6 offset:15360
    v_mfma_f32_32x32x16_bf16 v[80:95], v[24:27], v[20:23], v[80:95]
    ds_read_b64_tr_b16 v[50:51], v6 offset:19200
    ds_read_b128 v[44:47], v243 offset:5632
    v_mfma_f32_32x32x16_bf16 v[96:111], v[28:31], v[16:19], v[96:111]
    ds_read_b64_tr_b16 v[52:53], v6 offset:15424
    ds_read_b64_tr_b16 v[54:55], v6 offset:19264
    v_mfma_f32_32x32x16_bf16 v[112:127], v[28:31], v[20:23], v[112:127]
    ds_read_b64_tr_b16 v[56:57], v6 offset:15488
    ds_read_b64_tr_b16 v[58:59], v6 offset:19328
    v_mfma_f32_32x32x16_bf16 v[128:143], v[32:35], v[16:19], v[128:143]
    ds_read_b64_tr_b16 v[60:61], v6 offset:15552
    ds_read_b64_tr_b16 v[62:63], v6 offset:19392
    v_mfma_f32_32x32x16_bf16 v[144:159], v[32:35], v[20:23], v[144:159]
    s_add_u32 s46, s46, 1
    s_cmp_eq_u32 s46, 5
    s_cselect_b32 s41, -122880, s49
    s_cselect_b32 s46, 0, s46
    v_add_u32 v5, s41, v5
    v_add_u32 v6, s41, v6
    v_add_u32 v243, s41, v243
    v_mfma_f32_32x32x16_bf16 v[160:175], v[36:39], v[16:19], v[160:175]
    v_mfma_f32_32x32x16_bf16 v[176:191], v[36:39], v[20:23], v[176:191]
    s_waitcnt lgkmcnt(0)
    s_barrier
    v_mfma_f32_32x32x16_bf16 v[64:79], v[48:51], v[40:43], v[64:79]
    v_mfma_f32_32x32x16_bf16 v[80:95], v[48:51], v[44:47], v[80:95]
    v_mfma_f32_32x32x16_bf16 v[96:111], v[52:55], v[40:43], v[96:111]
    v_mfma_f32_32x32x16_bf16 v[112:127], v[52:55], v[44:47], v[112:127]
    v_mfma_f32_32x32x16_bf16 v[128:143], v[56:59], v[40:43], v[128:143]
    v_mfma_f32_32x32x16_bf16 v[144:159], v[56:59], v[44:47], v[144:159]
    v_mfma_f32_32x32x16_bf16 v[160:175], v[60:63], v[40:43], v[160:175]
    v_mfma_f32_32x32x16_bf16 v[176:191], v[60:63], v[44:47], v[176:191]
.g1_donef4:
    v_mov_b32 v60, s51
    v_mov_b32 v61, s51
    v_add_u32 v14, 4096, v2
    s_mov_b32 s53, s52
    s_mov_b32 s54, 1.0
    s_mov_b32 s55, 1.0
    s_waitcnt vmcnt(0) lgkmcnt(0)
    s_barrier
    v_mov_b32 v18, 0
    v_mov_b32 v19, 0
    v_mov_b32 v22, 0
    v_mov_b32 v23, 0
    v_mov_b32 v56, v241
    v_mov_b32 v57, v241
    v_mov_b32 v58, v247
    v_mov_b32 v59, v247
    v_cmp_gt_u32 vcc, 32, v1
    s_mov_b32 s44, 0x01000100
    v_perm_b32 v16, v240, v240, s44
    v_perm_b32 v20, v246, v246, s44
    v_cndmask_b32 v17, 0, v240, vcc
    v_cndmask_b32 v21, 0, v246, vcc
    v_cndmask_b32 v16, 0, v16, vcc
    v_cndmask_b32 v20, 0, v20, vcc
    v_add_f32 v224, v224, v225
    v_add_f32 v226, v226, v227
    v_mov_b32 v26, 0
    v_add_f32 v224, v224, v226
    v_mov_b32 v27, 0
    v_add_f32 v228, v228, v229
    v_add_f32 v230, v230, v231
    v_mov_b32 v30, 0
    v_add_f32 v228, v228, v230
    v_mov_b32 v31, 0
    v_add_f32 v232, v232, v233
    v_add_f32 v234, v234, v235
    v_mov_b32 v34, 0
    v_add_f32 v232, v232, v234
    v_mov_b32 v35, 0
    v_add_f32 v236, v236, v237
    v_add_f32 v238, v238, v239
    v_mov_b32 v38, 0
    v_add_f32 v236, v236, v238
    v_mov_b32 v39, 0
    v_mov_b32 v225, v224
    v_mov_b32 v229, v228
    v_mov_b32 v233, v232
    v_mov_b32 v237, v236
    v_permlane32_swap_b32 v224, v225
    v_permlane32_swap_b32 v228, v229
    v_permlane32_swap_b32 v232, v233
    v_permlane32_swap_b32 v236, v237
    v_add_f32 v224, v224, v225
    v_add_f32 v228, v228, v229
    v_add_f32 v232, v232, v233
    v_add_f32 v236, v236, v237
    v_cvt_pk_bf16_f32 v225, v224, v224
    v_cvt_pk_bf16_f32 v229, v228, v228
    v_cvt_pk_bf16_f32 v233, v232, v232
    v_cvt_pk_bf16_f32 v237, v236, v236
    v_lshlrev_b32 v225, 16, v225
    v_lshlrev_b32 v229, 16, v229
    v_lshlrev_b32 v233, 16, v233
    v_lshlrev_b32 v237, 16, v237
    v_sub_f32 v224, v224, v225
    v_sub_f32 v228, v228, v229
    v_sub_f32 v232, v232, v233
    v_sub_f32 v236, v236, v237
    v_cvt_pk_bf16_f32 v226, v224, v224
    v_cvt_pk_bf16_f32 v230, v228, v228
    v_cvt_pk_bf16_f32 v234, v232, v232
    v_cvt_pk_bf16_f32 v238, v236, v236
    v_lshlrev_b32 v226, 16, v226
    v_lshlrev_b32 v230, 16, v230
    v_lshlrev_b32 v234, 16, v234
    v_lshlrev_b32 v238, 16, v238
    v_sub_f32 v224, v224, v226
    v_sub_f32 v228, v228, v230
    v_sub_f32 v232, v232, v234
    v_sub_f32 v236, v236, v238
    v_cvt_pk_bf16_f32 v24, v225, v226
    v_lshlrev_b32 v250, 16, v250
    v_cvt_pk_bf16_f32 v25, v224, v250
    v_cvt_pk_bf16_f32 v28, v229, v230
    v_lshlrev_b32 v251, 16, v251
    v_cvt_pk_bf16_f32 v29, v228, v251
    v_cvt_pk_bf16_f32 v32, v233, v234
    v_lshlrev_b32 v252, 16, v252
    v_cvt_pk_bf16_f32 v33, v232, v252
    v_cvt_pk_bf16_f32 v36, v237, v238
    v_lshlrev_b32 v253, 16, v253
    v_cvt_pk_bf16_f32 v37, v236, v253
    v_mfma_f32_32x32x16_bf16 v[64:79], v[24:27], v[16:19], v[64:79]
    v_mfma_f32_32x32x16_bf16 v[80:95], v[24:27], v[20:23], v[80:95]
    v_mfma_f32_32x32x16_bf16 v[96:111], v[28:31], v[16:19], v[96:111]
    v_mfma_f32_32x32x16_bf16 v[112:127], v[28:31], v[20:23], v[112:127]
    v_mfma_f32_32x32x16_bf16 v[128:143], v[32:35], v[16:19], v[128:143]
    v_mfma_f32_32x32x16_bf16 v[144:159], v[32:35], v[20:23], v[144:159]
    v_mfma_f32_32x32x16_bf16 v[160:175], v[36:39], v[16:19], v[160:175]
    v_mfma_f32_32x32x16_bf16 v[176:191], v[36:39], v[20:23], v[176:191]
    s_nop 4
    v_pk_mul_f32 v[64:65], v[64:65], v[56:57]
    v_pk_mul_f32 v[66:67], v[66:67], v[56:57]
    v_pk_mul_f32 v[68:69], v[68:69], v[56:57]
    v_pk_mul_f32 v[70:71], v[70:71], v[56:57]
    v_pk_mul_f32 v[72:73], v[72:73], v[56:57]
    v_pk_mul_f32 v[74:75], v[74:75], v[56:57]
    v_pk_mul_f32 v[76:77], v[76:77], v[56:57]
    v_pk_mul_f32 v[78:79], v[78:79], v[56:57]
    v_pk_mul_f32 v[192:193], v[64:65], v[64:65]
    v_pk_mul_f32 v[194:195], v[66:67], v[66:67]
    v_pk_mul_f32 v[196:197], v[68:69], v[68:69]
    v_pk_mul_f32 v[198:199], v[70:71], v[70:71]
    v_pk_mul_f32 v[200:201], v[72:73], v[72:73]
    v_pk_mul_f32 v[202:203], v[74:75], v[74:75]
    v_pk_mul_f32 v[204:205], v[76:77], v[76:77]
    v_pk_mul_f32 v[206:207], v[78:79], v[78:79]
    v_pk_fma_f32 v[192:193], v[192:193], s[52:53], v[60:61]
    v_pk_fma_f32 v[194:195], v[194:195], s[52:53], v[60:61]
    v_pk_fma_f32 v[196:197], v[196:197], s[52:53], v[60:61]
    v_pk_fma_f32 v[198:199], v[198:199], s[52:53], v[60:61]
    v_pk_fma_f32 v[200:201], v[200:201], s[52:53], v[60:61]
    v_pk_fma_f32 v[202:203], v[202:203], s[52:53], v[60:61]
    v_pk_fma_f32 v[204:205], v[204:205], s[52:53], v[60:61]
    v_pk_fma_f32 v[206:207], v[206:207], s[52:53], v[60:61]
    v_pk_mul_f32 v[192:193], v[192:193], v[64:65]
    v_pk_mul_f32 v[194:195], v[194:195], v[66:67]
    v_pk_mul_f32 v[196:197], v[196:197], v[68:69]
    v_pk_mul_f32 v[198:199], v[198:199], v[70:71]
    v_pk_mul_f32 v[200:201], v[200:201], v[72:73]
    v_pk_mul_f32 v[202:203], v[202:203], v[74:75]
    v_pk_mul_f32 v[204:205], v[204:205], v[76:77]
    v_pk_mul_f32 v[206:207], v[206:207], v[78:79]
    v_exp_f32 v192, v192
    v_exp_f32 v193, v193
    v_exp_f32 v194, v194
    v_exp_f32 v195, v195
    v_exp_f32 v196, v196
    v_exp_f32 v197, v197
    v_exp_f32 v198, v198
    v_exp_f32 v199, v199
    v_exp_f32 v200, v200
    v_exp_f32 v201, v201
    v_exp_f32 v202, v202
    v_exp_f32 v203, v203
    v_exp_f32 v204, v204
    v_exp_f32 v205, v205
    v_exp_f32 v206, v206
    v_exp_f32 v207, v207
    v_pk_add_f32 v[192:193], v[192:193], s[54:55]
    v_pk_add_f32 v[194:195], v[194:195], s[54:55]
    v_pk_add_f32 v[196:197], v[196:197], s[54:55]
    v_pk_add_f32 v[198:199], v[198:199], s[54:55]
    v_pk_add_f32 v[200:201], v[200:201], s[54:55]
    v_pk_add_f32 v[202:203], v[202:203], s[54:55]
    v_pk_add_f32 v[204:205], v[204:205], s[54:55]
    v_pk_add_f32 v[206:207], v[206:207], s[54:55]
    v_rcp_f32 v192, v192
    v_rcp_f32 v193, v193
    v_rcp_f32 v194, v194
    v_rcp_f32 v195, v195
    v_rcp_f32 v196, v196
    v_rcp_f32 v197, v197
    v_rcp_f32 v198, v198
    v_rcp_f32 v199, v199
    v_rcp_f32 v200, v200
    v_rcp_f32 v201, v201
    v_rcp_f32 v202, v202
    v_rcp_f32 v203, v203
    v_rcp_f32 v204, v204
    v_rcp_f32 v205, v205
    v_rcp_f32 v206, v206
    v_rcp_f32 v207, v207
    v_pk_mul_f32 v[192:193], v[192:193], v[64:65]
    v_pk_mul_f32 v[194:195], v[194:195], v[66:67]
    v_pk_mul_f32 v[196:197], v[196:197], v[68:69]
    v_pk_mul_f32 v[198:199], v[198:199], v[70:71]
    v_pk_mul_f32 v[200:201], v[200:201], v[72:73]
    v_pk_mul_f32 v[202:203], v[202:203], v[74:75]
    v_pk_mul_f32 v[204:205], v[204:205], v[76:77]
    v_pk_mul_f32 v[206:207], v[206:207], v[78:79]
    v_cvt_pk_bf16_f32 v224, v192, v193
    v_cvt_pk_bf16_f32 v225, v194, v195
    v_cvt_pk_bf16_f32 v226, v196, v197
    v_cvt_pk_bf16_f32 v227, v198, v199
    v_cvt_pk_bf16_f32 v228, v200, v201
    v_cvt_pk_bf16_f32 v229, v202, v203
    v_cvt_pk_bf16_f32 v230, v204, v205
    v_cvt_pk_bf16_f32 v231, v206, v207
    buffer_store_dwordx4 v[224:227], v2, s[28:31], s48 offen offset:0 sc1
    buffer_store_dwordx4 v[228:231], v2, s[28:31], s48 offen offset:1024 sc1
    v_pk_mul_f32 v[80:81], v[80:81], v[58:59]
    v_pk_mul_f32 v[82:83], v[82:83], v[58:59]
    v_pk_mul_f32 v[84:85], v[84:85], v[58:59]
    v_pk_mul_f32 v[86:87], v[86:87], v[58:59]
    v_pk_mul_f32 v[88:89], v[88:89], v[58:59]
    v_pk_mul_f32 v[90:91], v[90:91], v[58:59]
    v_pk_mul_f32 v[92:93], v[92:93], v[58:59]
    v_pk_mul_f32 v[94:95], v[94:95], v[58:59]
    v_pk_mul_f32 v[208:209], v[80:81], v[80:81]
    v_pk_mul_f32 v[210:211], v[82:83], v[82:83]
    v_pk_mul_f32 v[212:213], v[84:85], v[84:85]
    v_pk_mul_f32 v[214:215], v[86:87], v[86:87]
    v_pk_mul_f32 v[216:217], v[88:89], v[88:89]
    v_pk_mul_f32 v[218:219], v[90:91], v[90:91]
    v_pk_mul_f32 v[220:221], v[92:93], v[92:93]
    v_pk_mul_f32 v[222:223], v[94:95], v[94:95]
    v_pk_fma_f32 v[208:209], v[208:209], s[52:53], v[60:61]
    v_pk_fma_f32 v[210:211], v[210:211], s[52:53], v[60:61]
    v_pk_fma_f32 v[212:213], v[212:213], s[52:53], v[60:61]
    v_pk_fma_f32 v[214:215], v[214:215], s[52:53], v[60:61]
    v_pk_fma_f32 v[216:217], v[216:217], s[52:53], v[60:61]
    v_pk_fma_f32 v[218:219], v[218:219], s[52:53], v[60:61]
    v_pk_fma_f32 v[220:221], v[220:221], s[52:53], v[60:61]
    v_pk_fma_f32 v[222:223], v[222:223], s[52:53], v[60:61]
    v_pk_mul_f32 v[208:209], v[208:209], v[80:81]
    v_pk_mul_f32 v[210:211], v[210:211], v[82:83]
    v_pk_mul_f32 v[212:213], v[212:213], v[84:85]
    v_pk_mul_f32 v[214:215], v[214:215], v[86:87]
    v_pk_mul_f32 v[216:217], v[216:217], v[88:89]
    v_pk_mul_f32 v[218:219], v[218:219], v[90:91]
    v_pk_mul_f32 v[220:221], v[220:221], v[92:93]
    v_pk_mul_f32 v[222:223], v[222:223], v[94:95]
    v_exp_f32 v208, v208
    v_exp_f32 v209, v209
    v_exp_f32 v210, v210
    v_exp_f32 v211, v211
    v_exp_f32 v212, v212
    v_exp_f32 v213, v213
    v_exp_f32 v214, v214
    v_exp_f32 v215, v215
    v_exp_f32 v216, v216
    v_exp_f32 v217, v217
    v_exp_f32 v218, v218
    v_exp_f32 v219, v219
    v_exp_f32 v220, v220
    v_exp_f32 v221, v221
    v_exp_f32 v222, v222
    v_exp_f32 v223, v223
    v_pk_add_f32 v[208:209], v[208:209], s[54:55]
    v_pk_add_f32 v[210:211], v[210:211], s[54:55]
    v_pk_add_f32 v[212:213], v[212:213], s[54:55]
    v_pk_add_f32 v[214:215], v[214:215], s[54:55]
    v_pk_add_f32 v[216:217], v[216:217], s[54:55]
    v_pk_add_f32 v[218:219], v[218:219], s[54:55]
    v_pk_add_f32 v[220:221], v[220:221], s[54:55]
    v_pk_add_f32 v[222:223], v[222:223], s[54:55]
    v_rcp_f32 v208, v208
    v_rcp_f32 v209, v209
    v_rcp_f32 v210, v210
    v_rcp_f32 v211, v211
    v_rcp_f32 v212, v212
    v_rcp_f32 v213, v213
    v_rcp_f32 v214, v214
    v_rcp_f32 v215, v215
    v_rcp_f32 v216, v216
    v_rcp_f32 v217, v217
    v_rcp_f32 v218, v218
    v_rcp_f32 v219, v219
    v_rcp_f32 v220, v220
    v_rcp_f32 v221, v221
    v_rcp_f32 v222, v222
    v_rcp_f32 v223, v223
    v_pk_mul_f32 v[208:209], v[208:209], v[80:81]
    v_pk_mul_f32 v[210:211], v[210:211], v[82:83]
    v_pk_mul_f32 v[212:213], v[212:213], v[84:85]
    v_pk_mul_f32 v[214:215], v[214:215], v[86:87]
    v_pk_mul_f32 v[216:217], v[216:217], v[88:89]
    v_pk_mul_f32 v[218:219], v[218:219], v[90:91]
    v_pk_mul_f32 v[220:221], v[220:221], v[92:93]
    v_pk_mul_f32 v[222:223], v[222:223], v[94:95]
    v_cvt_pk_bf16_f32 v232, v208, v209
    v_cvt_pk_bf16_f32 v233, v210, v211
    v_cvt_pk_bf16_f32 v234, v212, v213
    v_cvt_pk_bf16_f32 v235, v214, v215
    v_cvt_pk_bf16_f32 v236, v216, v217
    v_cvt_pk_bf16_f32 v237, v218, v219
    v_cvt_pk_bf16_f32 v238, v220, v221
    v_cvt_pk_bf16_f32 v239, v222, v223
    buffer_store_dwordx4 v[232:235], v2, s[28:31], s50 offen offset:0 sc1
    buffer_store_dwordx4 v[236:239], v2, s[28:31], s50 offen offset:1024 sc1
    v_pk_mul_f32 v[96:97], v[96:97], v[56:57]
    v_pk_mul_f32 v[98:99], v[98:99], v[56:57]
    v_pk_mul_f32 v[100:101], v[100:101], v[56:57]
    v_pk_mul_f32 v[102:103], v[102:103], v[56:57]
    v_pk_mul_f32 v[104:105], v[104:105], v[56:57]
    v_pk_mul_f32 v[106:107], v[106:107], v[56:57]
    v_pk_mul_f32 v[108:109], v[108:109], v[56:57]
    v_pk_mul_f32 v[110:111], v[110:111], v[56:57]
    v_pk_mul_f32 v[192:193], v[96:97], v[96:97]
    v_pk_mul_f32 v[194:195], v[98:99], v[98:99]
    v_pk_mul_f32 v[196:197], v[100:101], v[100:101]
    v_pk_mul_f32 v[198:199], v[102:103], v[102:103]
    v_pk_mul_f32 v[200:201], v[104:105], v[104:105]
    v_pk_mul_f32 v[202:203], v[106:107], v[106:107]
    v_pk_mul_f32 v[204:205], v[108:109], v[108:109]
    v_pk_mul_f32 v[206:207], v[110:111], v[110:111]
    v_pk_fma_f32 v[192:193], v[192:193], s[52:53], v[60:61]
    v_pk_fma_f32 v[194:195], v[194:195], s[52:53], v[60:61]
    v_pk_fma_f32 v[196:197], v[196:197], s[52:53], v[60:61]
    v_pk_fma_f32 v[198:199], v[198:199], s[52:53], v[60:61]
    v_pk_fma_f32 v[200:201], v[200:201], s[52:53], v[60:61]
    v_pk_fma_f32 v[202:203], v[202:203], s[52:53], v[60:61]
    v_pk_fma_f32 v[204:205], v[204:205], s[52:53], v[60:61]
    v_pk_fma_f32 v[206:207], v[206:207], s[52:53], v[60:61]
    v_pk_mul_f32 v[192:193], v[192:193], v[96:97]
    v_pk_mul_f32 v[194:195], v[194:195], v[98:99]
    v_pk_mul_f32 v[196:197], v[196:197], v[100:101]
    v_pk_mul_f32 v[198:199], v[198:199], v[102:103]
    v_pk_mul_f32 v[200:201], v[200:201], v[104:105]
    v_pk_mul_f32 v[202:203], v[202:203], v[106:107]
    v_pk_mul_f32 v[204:205], v[204:205], v[108:109]
    v_pk_mul_f32 v[206:207], v[206:207], v[110:111]
    v_exp_f32 v192, v192
    v_exp_f32 v193, v193
    v_exp_f32 v194, v194
    v_exp_f32 v195, v195
    v_exp_f32 v196, v196
    v_exp_f32 v197, v197
    v_exp_f32 v198, v198
    v_exp_f32 v199, v199
    v_exp_f32 v200, v200
    v_exp_f32 v201, v201
    v_exp_f32 v202, v202
    v_exp_f32 v203, v203
    v_exp_f32 v204, v204
    v_exp_f32 v205, v205
    v_exp_f32 v206, v206
    v_exp_f32 v207, v207
    v_pk_add_f32 v[192:193], v[192:193], s[54:55]
    v_pk_add_f32 v[194:195], v[194:195], s[54:55]
    v_pk_add_f32 v[196:197], v[196:197], s[54:55]
    v_pk_add_f32 v[198:199], v[198:199], s[54:55]
    v_pk_add_f32 v[200:201], v[200:201], s[54:55]
    v_pk_add_f32 v[202:203], v[202:203], s[54:55]
    v_pk_add_f32 v[204:205], v[204:205], s[54:55]
    v_pk_add_f32 v[206:207], v[206:207], s[54:55]
    v_rcp_f32 v192, v192
    v_rcp_f32 v193, v193
    v_rcp_f32 v194, v194
    v_rcp_f32 v195, v195
    v_rcp_f32 v196, v196
    v_rcp_f32 v197, v197
    v_rcp_f32 v198, v198
    v_rcp_f32 v199, v199
    v_rcp_f32 v200, v200
    v_rcp_f32 v201, v201
    v_rcp_f32 v202, v202
    v_rcp_f32 v203, v203
    v_rcp_f32 v204, v204
    v_rcp_f32 v205, v205
    v_rcp_f32 v206, v206
    v_rcp_f32 v207, v207
    v_pk_mul_f32 v[192:193], v[192:193], v[96:97]
    v_pk_mul_f32 v[194:195], v[194:195], v[98:99]
    v_pk_mul_f32 v[196:197], v[196:197], v[100:101]
    v_pk_mul_f32 v[198:199], v[198:199], v[102:103]
    v_pk_mul_f32 v[200:201], v[200:201], v[104:105]
    v_pk_mul_f32 v[202:203], v[202:203], v[106:107]
    v_pk_mul_f32 v[204:205], v[204:205], v[108:109]
    v_pk_mul_f32 v[206:207], v[206:207], v[110:111]
    v_cvt_pk_bf16_f32 v224, v192, v193
    v_cvt_pk_bf16_f32 v225, v194, v195
    v_cvt_pk_bf16_f32 v226, v196, v197
    v_cvt_pk_bf16_f32 v227, v198, v199
    v_cvt_pk_bf16_f32 v228, v200, v201
    v_cvt_pk_bf16_f32 v229, v202, v203
    v_cvt_pk_bf16_f32 v230, v204, v205
    v_cvt_pk_bf16_f32 v231, v206, v207
    buffer_store_dwordx4 v[224:227], v2, s[28:31], s48 offen offset:2048 sc1
    buffer_store_dwordx4 v[228:231], v2, s[28:31], s48 offen offset:3072 sc1
    v_pk_mul_f32 v[112:113], v[112:113], v[58:59]
    v_pk_mul_f32 v[114:115], v[114:115], v[58:59]
    v_pk_mul_f32 v[116:117], v[116:117], v[58:59]
    v_pk_mul_f32 v[118:119], v[118:119], v[58:59]
    v_pk_mul_f32 v[120:121], v[120:121], v[58:59]
    v_pk_mul_f32 v[122:123], v[122:123], v[58:59]
    v_pk_mul_f32 v[124:125], v[124:125], v[58:59]
    v_pk_mul_f32 v[126:127], v[126:127], v[58:59]
    v_pk_mul_f32 v[208:209], v[112:113], v[112:113]
    v_pk_mul_f32 v[210:211], v[114:115], v[114:115]
    v_pk_mul_f32 v[212:213], v[116:117], v[116:117]
    v_pk_mul_f32 v[214:215], v[118:119], v[118:119]
    v_pk_mul_f32 v[216:217], v[120:121], v[120:121]
    v_pk_mul_f32 v[218:219], v[122:123], v[122:123]
    v_pk_mul_f32 v[220:221], v[124:125], v[124:125]
    v_pk_mul_f32 v[222:223], v[126:127], v[126:127]
    v_pk_fma_f32 v[208:209], v[208:209], s[52:53], v[60:61]
    v_pk_fma_f32 v[210:211], v[210:211], s[52:53], v[60:61]
    v_pk_fma_f32 v[212:213], v[212:213], s[52:53], v[60:61]
    v_pk_fma_f32 v[214:215], v[214:215], s[52:53], v[60:61]
    v_pk_fma_f32 v[216:217], v[216:217], s[52:53], v[60:61]
    v_pk_fma_f32 v[218:219], v[218:219], s[52:53], v[60:61]
    v_pk_fma_f32 v[220:221], v[220:221], s[52:53], v[60:61]
    v_pk_fma_f32 v[222:223], v[222:223], s[52:53], v[60:61]
    v_pk_mul_f32 v[208:209], v[208:209], v[112:113]
    v_pk_mul_f32 v[210:211], v[210:211], v[114:115]
    v_pk_mul_f32 v[212:213], v[212:213], v[116:117]
    v_pk_mul_f32 v[214:215], v[214:215], v[118:119]
    v_pk_mul_f32 v[216:217], v[216:217], v[120:121]
    v_pk_mul_f32 v[218:219], v[218:219], v[122:123]
    v_pk_mul_f32 v[220:221], v[220:221], v[124:125]
    v_pk_mul_f32 v[222:223], v[222:223], v[126:127]
    v_exp_f32 v208, v208
    v_exp_f32 v209, v209
    v_exp_f32 v210, v210
    v_exp_f32 v211, v211
    v_exp_f32 v212, v212
    v_exp_f32 v213, v213
    v_exp_f32 v214, v214
    v_exp_f32 v215, v215
    v_exp_f32 v216, v216
    v_exp_f32 v217, v217
    v_exp_f32 v218, v218
    v_exp_f32 v219, v219
    v_exp_f32 v220, v220
    v_exp_f32 v221, v221
    v_exp_f32 v222, v222
    v_exp_f32 v223, v223
    v_pk_add_f32 v[208:209], v[208:209], s[54:55]
    v_pk_add_f32 v[210:211], v[210:211], s[54:55]
    v_pk_add_f32 v[212:213], v[212:213], s[54:55]
    v_pk_add_f32 v[214:215], v[214:215], s[54:55]
    v_pk_add_f32 v[216:217], v[216:217], s[54:55]
    v_pk_add_f32 v[218:219], v[218:219], s[54:55]
    v_pk_add_f32 v[220:221], v[220:221], s[54:55]
    v_pk_add_f32 v[222:223], v[222:223], s[54:55]
    v_rcp_f32 v208, v208
    v_rcp_f32 v209, v209
    v_rcp_f32 v210, v210
    v_rcp_f32 v211, v211
    v_rcp_f32 v212, v212
    v_rcp_f32 v213, v213
    v_rcp_f32 v214, v214
    v_rcp_f32 v215, v215
    v_rcp_f32 v216, v216
    v_rcp_f32 v217, v217
    v_rcp_f32 v218, v218
    v_rcp_f32 v219, v219
    v_rcp_f32 v220, v220
    v_rcp_f32 v221, v221
    v_rcp_f32 v222, v222
    v_rcp_f32 v223, v223
    v_pk_mul_f32 v[208:209], v[208:209], v[112:113]
    v_pk_mul_f32 v[210:211], v[210:211], v[114:115]
    v_pk_mul_f32 v[212:213], v[212:213], v[116:117]
    v_pk_mul_f32 v[214:215], v[214:215], v[118:119]
    v_pk_mul_f32 v[216:217], v[216:217], v[120:121]
    v_pk_mul_f32 v[218:219], v[218:219], v[122:123]
    v_pk_mul_f32 v[220:221], v[220:221], v[124:125]
    v_pk_mul_f32 v[222:223], v[222:223], v[126:127]
    v_cvt_pk_bf16_f32 v232, v208, v209
    v_cvt_pk_bf16_f32 v233, v210, v211
    v_cvt_pk_bf16_f32 v234, v212, v213
    v_cvt_pk_bf16_f32 v235, v214, v215
    v_cvt_pk_bf16_f32 v236, v216, v217
    v_cvt_pk_bf16_f32 v237, v218, v219
    v_cvt_pk_bf16_f32 v238, v220, v221
    v_cvt_pk_bf16_f32 v239, v222, v223
    buffer_store_dwordx4 v[232:235], v2, s[28:31], s50 offen offset:2048 sc1
    buffer_store_dwordx4 v[236:239], v2, s[28:31], s50 offen offset:3072 sc1
    v_pk_mul_f32 v[128:129], v[128:129], v[56:57]
    v_pk_mul_f32 v[130:131], v[130:131], v[56:57]
    v_pk_mul_f32 v[132:133], v[132:133], v[56:57]
    v_pk_mul_f32 v[134:135], v[134:135], v[56:57]
    v_pk_mul_f32 v[136:137], v[136:137], v[56:57]
    v_pk_mul_f32 v[138:139], v[138:139], v[56:57]
    v_pk_mul_f32 v[140:141], v[140:141], v[56:57]
    v_pk_mul_f32 v[142:143], v[142:143], v[56:57]
    v_pk_mul_f32 v[192:193], v[128:129], v[128:129]
    v_pk_mul_f32 v[194:195], v[130:131], v[130:131]
    v_pk_mul_f32 v[196:197], v[132:133], v[132:133]
    v_pk_mul_f32 v[198:199], v[134:135], v[134:135]
    v_pk_mul_f32 v[200:201], v[136:137], v[136:137]
    v_pk_mul_f32 v[202:203], v[138:139], v[138:139]
    v_pk_mul_f32 v[204:205], v[140:141], v[140:141]
    v_pk_mul_f32 v[206:207], v[142:143], v[142:143]
    v_pk_fma_f32 v[192:193], v[192:193], s[52:53], v[60:61]
    v_pk_fma_f32 v[194:195], v[194:195], s[52:53], v[60:61]
    v_pk_fma_f32 v[196:197], v[196:197], s[52:53], v[60:61]
    v_pk_fma_f32 v[198:199], v[198:199], s[52:53], v[60:61]
    v_pk_fma_f32 v[200:201], v[200:201], s[52:53], v[60:61]
    v_pk_fma_f32 v[202:203], v[202:203], s[52:53], v[60:61]
    v_pk_fma_f32 v[204:205], v[204:205], s[52:53], v[60:61]
    v_pk_fma_f32 v[206:207], v[206:207], s[52:53], v[60:61]
    v_pk_mul_f32 v[192:193], v[192:193], v[128:129]
    v_pk_mul_f32 v[194:195], v[194:195], v[130:131]
    v_pk_mul_f32 v[196:197], v[196:197], v[132:133]
    v_pk_mul_f32 v[198:199], v[198:199], v[134:135]
    v_pk_mul_f32 v[200:201], v[200:201], v[136:137]
    v_pk_mul_f32 v[202:203], v[202:203], v[138:139]
    v_pk_mul_f32 v[204:205], v[204:205], v[140:141]
    v_pk_mul_f32 v[206:207], v[206:207], v[142:143]
    v_exp_f32 v192, v192
    v_exp_f32 v193, v193
    v_exp_f32 v194, v194
    v_exp_f32 v195, v195
    v_exp_f32 v196, v196
    v_exp_f32 v197, v197
    v_exp_f32 v198, v198
    v_exp_f32 v199, v199
    v_exp_f32 v200, v200
    v_exp_f32 v201, v201
    v_exp_f32 v202, v202
    v_exp_f32 v203, v203
    v_exp_f32 v204, v204
    v_exp_f32 v205, v205
    v_exp_f32 v206, v206
    v_exp_f32 v207, v207
    v_pk_add_f32 v[192:193], v[192:193], s[54:55]
    v_pk_add_f32 v[194:195], v[194:195], s[54:55]
    v_pk_add_f32 v[196:197], v[196:197], s[54:55]
    v_pk_add_f32 v[198:199], v[198:199], s[54:55]
    v_pk_add_f32 v[200:201], v[200:201], s[54:55]
    v_pk_add_f32 v[202:203], v[202:203], s[54:55]
    v_pk_add_f32 v[204:205], v[204:205], s[54:55]
    v_pk_add_f32 v[206:207], v[206:207], s[54:55]
    v_rcp_f32 v192, v192
    v_rcp_f32 v193, v193
    v_rcp_f32 v194, v194
    v_rcp_f32 v195, v195
    v_rcp_f32 v196, v196
    v_rcp_f32 v197, v197
    v_rcp_f32 v198, v198
    v_rcp_f32 v199, v199
    v_rcp_f32 v200, v200
    v_rcp_f32 v201, v201
    v_rcp_f32 v202, v202
    v_rcp_f32 v203, v203
    v_rcp_f32 v204, v204
    v_rcp_f32 v205, v205
    v_rcp_f32 v206, v206
    v_rcp_f32 v207, v207
    v_pk_mul_f32 v[192:193], v[192:193], v[128:129]
    v_pk_mul_f32 v[194:195], v[194:195], v[130:131]
    v_pk_mul_f32 v[196:197], v[196:197], v[132:133]
    v_pk_mul_f32 v[198:199], v[198:199], v[134:135]
    v_pk_mul_f32 v[200:201], v[200:201], v[136:137]
    v_pk_mul_f32 v[202:203], v[202:203], v[138:139]
    v_pk_mul_f32 v[204:205], v[204:205], v[140:141]
    v_pk_mul_f32 v[206:207], v[206:207], v[142:143]
    v_cvt_pk_bf16_f32 v224, v192, v193
    v_cvt_pk_bf16_f32 v225, v194, v195
    v_cvt_pk_bf16_f32 v226, v196, v197
    v_cvt_pk_bf16_f32 v227, v198, v199
    v_cvt_pk_bf16_f32 v228, v200, v201
    v_cvt_pk_bf16_f32 v229, v202, v203
    v_cvt_pk_bf16_f32 v230, v204, v205
    v_cvt_pk_bf16_f32 v231, v206, v207
    buffer_store_dwordx4 v[224:227], v14, s[28:31], s48 offen offset:0 sc1
    buffer_store_dwordx4 v[228:231], v14, s[28:31], s48 offen offset:1024 sc1
    v_pk_mul_f32 v[144:145], v[144:145], v[58:59]
    v_pk_mul_f32 v[146:147], v[146:147], v[58:59]
    v_pk_mul_f32 v[148:149], v[148:149], v[58:59]
    v_pk_mul_f32 v[150:151], v[150:151], v[58:59]
    v_pk_mul_f32 v[152:153], v[152:153], v[58:59]
    v_pk_mul_f32 v[154:155], v[154:155], v[58:59]
    v_pk_mul_f32 v[156:157], v[156:157], v[58:59]
    v_pk_mul_f32 v[158:159], v[158:159], v[58:59]
    v_pk_mul_f32 v[208:209], v[144:145], v[144:145]
    v_pk_mul_f32 v[210:211], v[146:147], v[146:147]
    v_pk_mul_f32 v[212:213], v[148:149], v[148:149]
    v_pk_mul_f32 v[214:215], v[150:151], v[150:151]
    v_pk_mul_f32 v[216:217], v[152:153], v[152:153]
    v_pk_mul_f32 v[218:219], v[154:155], v[154:155]
    v_pk_mul_f32 v[220:221], v[156:157], v[156:157]
    v_pk_mul_f32 v[222:223], v[158:159], v[158:159]
    v_pk_fma_f32 v[208:209], v[208:209], s[52:53], v[60:61]
    v_pk_fma_f32 v[210:211], v[210:211], s[52:53], v[60:61]
    v_pk_fma_f32 v[212:213], v[212:213], s[52:53], v[60:61]
    v_pk_fma_f32 v[214:215], v[214:215], s[52:53], v[60:61]
    v_pk_fma_f32 v[216:217], v[216:217], s[52:53], v[60:61]
    v_pk_fma_f32 v[218:219], v[218:219], s[52:53], v[60:61]
    v_pk_fma_f32 v[220:221], v[220:221], s[52:53], v[60:61]
    v_pk_fma_f32 v[222:223], v[222:223], s[52:53], v[60:61]
    v_pk_mul_f32 v[208:209], v[208:209], v[144:145]
    v_pk_mul_f32 v[210:211], v[210:211], v[146:147]
    v_pk_mul_f32 v[212:213], v[212:213], v[148:149]
    v_pk_mul_f32 v[214:215], v[214:215], v[150:151]
    v_pk_mul_f32 v[216:217], v[216:217], v[152:153]
    v_pk_mul_f32 v[218:219], v[218:219], v[154:155]
    v_pk_mul_f32 v[220:221], v[220:221], v[156:157]
    v_pk_mul_f32 v[222:223], v[222:223], v[158:159]
    v_exp_f32 v208, v208
    v_exp_f32 v209, v209
    v_exp_f32 v210, v210
    v_exp_f32 v211, v211
    v_exp_f32 v212, v212
    v_exp_f32 v213, v213
    v_exp_f32 v214, v214
    v_exp_f32 v215, v215
    v_exp_f32 v216, v216
    v_exp_f32 v217, v217
    v_exp_f32 v218, v218
    v_exp_f32 v219, v219
    v_exp_f32 v220, v220
    v_exp_f32 v221, v221
    v_exp_f32 v222, v222
    v_exp_f32 v223, v223
    v_pk_add_f32 v[208:209], v[208:209], s[54:55]
    v_pk_add_f32 v[210:211], v[210:211], s[54:55]
    v_pk_add_f32 v[212:213], v[212:213], s[54:55]
    v_pk_add_f32 v[214:215], v[214:215], s[54:55]
    v_pk_add_f32 v[216:217], v[216:217], s[54:55]
    v_pk_add_f32 v[218:219], v[218:219], s[54:55]
    v_pk_add_f32 v[220:221], v[220:221], s[54:55]
    v_pk_add_f32 v[222:223], v[222:223], s[54:55]
    v_rcp_f32 v208, v208
    v_rcp_f32 v209, v209
    v_rcp_f32 v210, v210
    v_rcp_f32 v211, v211
    v_rcp_f32 v212, v212
    v_rcp_f32 v213, v213
    v_rcp_f32 v214, v214
    v_rcp_f32 v215, v215
    v_rcp_f32 v216, v216
    v_rcp_f32 v217, v217
    v_rcp_f32 v218, v218
    v_rcp_f32 v219, v219
    v_rcp_f32 v220, v220
    v_rcp_f32 v221, v221
    v_rcp_f32 v222, v222
    v_rcp_f32 v223, v223
    v_pk_mul_f32 v[208:209], v[208:209], v[144:145]
    v_pk_mul_f32 v[210:211], v[210:211], v[146:147]
    v_pk_mul_f32 v[212:213], v[212:213], v[148:149]
    v_pk_mul_f32 v[214:215], v[214:215], v[150:151]
    v_pk_mul_f32 v[216:217], v[216:217], v[152:153]
    v_pk_mul_f32 v[218:219], v[218:219], v[154:155]
    v_pk_mul_f32 v[220:221], v[220:221], v[156:157]
    v_pk_mul_f32 v[222:223], v[222:223], v[158:159]
    v_cvt_pk_bf16_f32 v232, v208, v209
    v_cvt_pk_bf16_f32 v233, v210, v211
    v_cvt_pk_bf16_f32 v234, v212, v213
    v_cvt_pk_bf16_f32 v235, v214, v215
    v_cvt_pk_bf16_f32 v236, v216, v217
    v_cvt_pk_bf16_f32 v237, v218, v219
    v_cvt_pk_bf16_f32 v238, v220, v221
    v_cvt_pk_bf16_f32 v239, v222, v223
    buffer_store_dwordx4 v[232:235], v14, s[28:31], s50 offen offset:0 sc1
    buffer_store_dwordx4 v[236:239], v14, s[28:31], s50 offen offset:1024 sc1
    v_pk_mul_f32 v[160:161], v[160:161], v[56:57]
    v_pk_mul_f32 v[162:163], v[162:163], v[56:57]
    v_pk_mul_f32 v[164:165], v[164:165], v[56:57]
    v_pk_mul_f32 v[166:167], v[166:167], v[56:57]
    v_pk_mul_f32 v[168:169], v[168:169], v[56:57]
    v_pk_mul_f32 v[170:171], v[170:171], v[56:57]
    v_pk_mul_f32 v[172:173], v[172:173], v[56:57]
    v_pk_mul_f32 v[174:175], v[174:175], v[56:57]
    v_pk_mul_f32 v[192:193], v[160:161], v[160:161]
    v_pk_mul_f32 v[194:195], v[162:163], v[162:163]
    v_pk_mul_f32 v[196:197], v[164:165], v[164:165]
    v_pk_mul_f32 v[198:199], v[166:167], v[166:167]
    v_pk_mul_f32 v[200:201], v[168:169], v[168:169]
    v_pk_mul_f32 v[202:203], v[170:171], v[170:171]
    v_pk_mul_f32 v[204:205], v[172:173], v[172:173]
    v_pk_mul_f32 v[206:207], v[174:175], v[174:175]
    v_pk_fma_f32 v[192:193], v[192:193], s[52:53], v[60:61]
    v_pk_fma_f32 v[194:195], v[194:195], s[52:53], v[60:61]
    v_pk_fma_f32 v[196:197], v[196:197], s[52:53], v[60:61]
    v_pk_fma_f32 v[198:199], v[198:199], s[52:53], v[60:61]
    v_pk_fma_f32 v[200:201], v[200:201], s[52:53], v[60:61]
    v_pk_fma_f32 v[202:203], v[202:203], s[52:53], v[60:61]
    v_pk_fma_f32 v[204:205], v[204:205], s[52:53], v[60:61]
    v_pk_fma_f32 v[206:207], v[206:207], s[52:53], v[60:61]
    v_pk_mul_f32 v[192:193], v[192:193], v[160:161]
    v_pk_mul_f32 v[194:195], v[194:195], v[162:163]
    v_pk_mul_f32 v[196:197], v[196:197], v[164:165]
    v_pk_mul_f32 v[198:199], v[198:199], v[166:167]
    v_pk_mul_f32 v[200:201], v[200:201], v[168:169]
    v_pk_mul_f32 v[202:203], v[202:203], v[170:171]
    v_pk_mul_f32 v[204:205], v[204:205], v[172:173]
    v_pk_mul_f32 v[206:207], v[206:207], v[174:175]
    v_exp_f32 v192, v192
    v_exp_f32 v193, v193
    v_exp_f32 v194, v194
    v_exp_f32 v195, v195
    v_exp_f32 v196, v196
    v_exp_f32 v197, v197
    v_exp_f32 v198, v198
    v_exp_f32 v199, v199
    v_exp_f32 v200, v200
    v_exp_f32 v201, v201
    v_exp_f32 v202, v202
    v_exp_f32 v203, v203
    v_exp_f32 v204, v204
    v_exp_f32 v205, v205
    v_exp_f32 v206, v206
    v_exp_f32 v207, v207
    v_pk_add_f32 v[192:193], v[192:193], s[54:55]
    v_pk_add_f32 v[194:195], v[194:195], s[54:55]
    v_pk_add_f32 v[196:197], v[196:197], s[54:55]
    v_pk_add_f32 v[198:199], v[198:199], s[54:55]
    v_pk_add_f32 v[200:201], v[200:201], s[54:55]
    v_pk_add_f32 v[202:203], v[202:203], s[54:55]
    v_pk_add_f32 v[204:205], v[204:205], s[54:55]
    v_pk_add_f32 v[206:207], v[206:207], s[54:55]
    v_rcp_f32 v192, v192
    v_rcp_f32 v193, v193
    v_rcp_f32 v194, v194
    v_rcp_f32 v195, v195
    v_rcp_f32 v196, v196
    v_rcp_f32 v197, v197
    v_rcp_f32 v198, v198
    v_rcp_f32 v199, v199
    v_rcp_f32 v200, v200
    v_rcp_f32 v201, v201
    v_rcp_f32 v202, v202
    v_rcp_f32 v203, v203
    v_rcp_f32 v204, v204
    v_rcp_f32 v205, v205
    v_rcp_f32 v206, v206
    v_rcp_f32 v207, v207
    v_pk_mul_f32 v[192:193], v[192:193], v[160:161]
    v_pk_mul_f32 v[194:195], v[194:195], v[162:163]
    v_pk_mul_f32 v[196:197], v[196:197], v[164:165]
    v_pk_mul_f32 v[198:199], v[198:199], v[166:167]
    v_pk_mul_f32 v[200:201], v[200:201], v[168:169]
    v_pk_mul_f32 v[202:203], v[202:203], v[170:171]
    v_pk_mul_f32 v[204:205], v[204:205], v[172:173]
    v_pk_mul_f32 v[206:207], v[206:207], v[174:175]
    v_cvt_pk_bf16_f32 v224, v192, v193
    v_cvt_pk_bf16_f32 v225, v194, v195
    v_cvt_pk_bf16_f32 v226, v196, v197
    v_cvt_pk_bf16_f32 v227, v198, v199
    v_cvt_pk_bf16_f32 v228, v200, v201
    v_cvt_pk_bf16_f32 v229, v202, v203
    v_cvt_pk_bf16_f32 v230, v204, v205
    v_cvt_pk_bf16_f32 v231, v206, v207
    buffer_store_dwordx4 v[224:227], v14, s[28:31], s48 offen offset:2048 sc1
    buffer_store_dwordx4 v[228:231], v14, s[28:31], s48 offen offset:3072 sc1
    v_pk_mul_f32 v[176:177], v[176:177], v[58:59]
    v_pk_mul_f32 v[178:179], v[178:179], v[58:59]
    v_pk_mul_f32 v[180:181], v[180:181], v[58:59]
    v_pk_mul_f32 v[182:183], v[182:183], v[58:59]
    v_pk_mul_f32 v[184:185], v[184:185], v[58:59]
    v_pk_mul_f32 v[186:187], v[186:187], v[58:59]
    v_pk_mul_f32 v[188:189], v[188:189], v[58:59]
    v_pk_mul_f32 v[190:191], v[190:191], v[58:59]
    v_pk_mul_f32 v[208:209], v[176:177], v[176:177]
    v_pk_mul_f32 v[210:211], v[178:179], v[178:179]
    v_pk_mul_f32 v[212:213], v[180:181], v[180:181]
    v_pk_mul_f32 v[214:215], v[182:183], v[182:183]
    v_pk_mul_f32 v[216:217], v[184:185], v[184:185]
    v_pk_mul_f32 v[218:219], v[186:187], v[186:187]
    v_pk_mul_f32 v[220:221], v[188:189], v[188:189]
    v_pk_mul_f32 v[222:223], v[190:191], v[190:191]
    v_pk_fma_f32 v[208:209], v[208:209], s[52:53], v[60:61]
    v_pk_fma_f32 v[210:211], v[210:211], s[52:53], v[60:61]
    v_pk_fma_f32 v[212:213], v[212:213], s[52:53], v[60:61]
    v_pk_fma_f32 v[214:215], v[214:215], s[52:53], v[60:61]
    v_pk_fma_f32 v[216:217], v[216:217], s[52:53], v[60:61]
    v_pk_fma_f32 v[218:219], v[218:219], s[52:53], v[60:61]
    v_pk_fma_f32 v[220:221], v[220:221], s[52:53], v[60:61]
    v_pk_fma_f32 v[222:223], v[222:223], s[52:53], v[60:61]
    v_pk_mul_f32 v[208:209], v[208:209], v[176:177]
    v_pk_mul_f32 v[210:211], v[210:211], v[178:179]
    v_pk_mul_f32 v[212:213], v[212:213], v[180:181]
    v_pk_mul_f32 v[214:215], v[214:215], v[182:183]
    v_pk_mul_f32 v[216:217], v[216:217], v[184:185]
    v_pk_mul_f32 v[218:219], v[218:219], v[186:187]
    v_pk_mul_f32 v[220:221], v[220:221], v[188:189]
    v_pk_mul_f32 v[222:223], v[222:223], v[190:191]
    v_exp_f32 v208, v208
    v_exp_f32 v209, v209
    v_exp_f32 v210, v210
    v_exp_f32 v211, v211
    v_exp_f32 v212, v212
    v_exp_f32 v213, v213
    v_exp_f32 v214, v214
    v_exp_f32 v215, v215
    v_exp_f32 v216, v216
    v_exp_f32 v217, v217
    v_exp_f32 v218, v218
    v_exp_f32 v219, v219
    v_exp_f32 v220, v220
    v_exp_f32 v221, v221
    v_exp_f32 v222, v222
    v_exp_f32 v223, v223
    v_pk_add_f32 v[208:209], v[208:209], s[54:55]
    v_pk_add_f32 v[210:211], v[210:211], s[54:55]
    v_pk_add_f32 v[212:213], v[212:213], s[54:55]
    v_pk_add_f32 v[214:215], v[214:215], s[54:55]
    v_pk_add_f32 v[216:217], v[216:217], s[54:55]
    v_pk_add_f32 v[218:219], v[218:219], s[54:55]
    v_pk_add_f32 v[220:221], v[220:221], s[54:55]
    v_pk_add_f32 v[222:223], v[222:223], s[54:55]
    v_rcp_f32 v208, v208
    v_rcp_f32 v209, v209
    v_rcp_f32 v210, v210
    v_rcp_f32 v211, v211
    v_rcp_f32 v212, v212
    v_rcp_f32 v213, v213
    v_rcp_f32 v214, v214
    v_rcp_f32 v215, v215
    v_rcp_f32 v216, v216
    v_rcp_f32 v217, v217
    v_rcp_f32 v218, v218
    v_rcp_f32 v219, v219
    v_rcp_f32 v220, v220
    v_rcp_f32 v221, v221
    v_rcp_f32 v222, v222
    v_rcp_f32 v223, v223
    v_pk_mul_f32 v[208:209], v[208:209], v[176:177]
    v_pk_mul_f32 v[210:211], v[210:211], v[178:179]
    v_pk_mul_f32 v[212:213], v[212:213], v[180:181]
    v_pk_mul_f32 v[214:215], v[214:215], v[182:183]
    v_pk_mul_f32 v[216:217], v[216:217], v[184:185]
    v_pk_mul_f32 v[218:219], v[218:219], v[186:187]
    v_pk_mul_f32 v[220:221], v[220:221], v[188:189]
    v_pk_mul_f32 v[222:223], v[222:223], v[190:191]
    v_cvt_pk_bf16_f32 v232, v208, v209
    v_cvt_pk_bf16_f32 v233, v210, v211
    v_cvt_pk_bf16_f32 v234, v212, v213
    v_cvt_pk_bf16_f32 v235, v214, v215
    v_cvt_pk_bf16_f32 v236, v216, v217
    v_cvt_pk_bf16_f32 v237, v218, v219
    v_cvt_pk_bf16_f32 v238, v220, v221
    v_cvt_pk_bf16_f32 v239, v222, v223
    buffer_store_dwordx4 v[232:235], v14, s[28:31], s50 offen offset:2048 sc1
    buffer_store_dwordx4 v[236:239], v14, s[28:31], s50 offen offset:3072 sc1
    s_branch .g2_entry
.g1_f3:
    ds_read_b128 v[16:19], v5 offset:1792
    ds_read_b64_tr_b16 v[24:25], v6 offset:0
    ds_read_b64_tr_b16 v[26:27], v6 offset:3840
    ds_read_b128 v[20:23], v5 offset:5632
    ds_read_b64_tr_b16 v[28:29], v6 offset:64
    ds_read_b64_tr_b16 v[30:31], v6 offset:3904
    ds_read_b64_tr_b16 v[32:33], v6 offset:128
    ds_read_b64_tr_b16 v[34:35], v6 offset:3968
    s_branch .g1_loopf3
.g1_loopf3d0:
    s_waitcnt lgkmcnt(0)
    v_mfma_f32_32x32x16_bf16 v[64:79], v[24:27], v[16:19], v[64:79]
    ds_read_b128 v[40:43], v243 offset:1792
    ds_read_b64_tr_b16 v[48:49], v6 offset:15360
    v_mfma_f32_32x32x16_bf16 v[80:95], v[24:27], v[20:23], v[80:95]
    ds_read_b64_tr_b16 v[50:51], v6 offset:19200
    ds_read_b128 v[44:47], v243 offset:5632
    v_mfma_f32_32x32x16_bf16 v[96:111], v[28:31], v[16:19], v[96:111]
    ds_read_b64_tr_b16 v[52:53], v6 offset:15424
    ds_read_b64_tr_b16 v[54:55], v6 offset:19264
    s_mov_b32 m0, s39
    s_mov_b64 exec, s[42:43]
    buffer_load_dwordx4 v3, s[20:23], s37 offen lds
    s_mov_b64 exec, -1
    v_dot2c_f32_bf16 v248, s56, v24
    v_mfma_f32_32x32x16_bf16 v[112:127], v[28:31], v[20:23], v[112:127]
    ds_read_b64_tr_b16 v[56:57], v6 offset:15488
    ds_read_b64_tr_b16 v[58:59], v6 offset:19328
    s_mov_b64 exec, s[42:43]
    buffer_load_dwordx4 v4, s[20:23], s37 offen offset:896 lds
    s_mov_b64 exec, -1
    s_add_u32 m0, s39, 1792
    s_add_u32 s37, s37, s38
    v_dot2c_f32_bf16 v248, s56, v25
    v_mfma_f32_32x32x16_bf16 v[128:143], v[32:35], v[16:19], v[128:143]
    s_add_u32 s46, s46, 1
    s_cmp_eq_u32 s46, 5
    s_cselect_b32 s41, -122880, s49
    s_cselect_b32 s46, 0, s46
    v_add_u32 v5, s41, v5
    v_add_u32 v6, s41, v6
    v_add_u32 v243, s41, v243
    buffer_load_dwordx4 v244, s[24:27], s36 offen lds
    s_add_u32 s39, s39, 30720
    s_cmp_eq_u32 s39, s13
    s_cselect_b32 s39, s12, s39
    v_dot2c_f32_bf16 v248, s56, v26
    v_mfma_f32_32x32x16_bf16 v[144:159], v[32:35], v[20:23], v[144:159]
    buffer_load_dwordx4 v245, s[24:27], s36 offen offset:1024 lds
    s_add_u32 s36, s36, 64
    s_cmp_eq_u32 s36, s59
    s_cselect_b32 s36, s78, s36
    s_cselect_b32 s37, s79, s37
    s_cmp_eq_u32 s36, 2048
    s_cselect_b32 s36, 0x100000, s36
    s_cselect_b32 s37, 0x10000000, s37
    v_dot2c_f32_bf16 v248, s56, v27
    s_sub_u32 s40, s40, 1
    s_waitcnt vmcnt(12) lgkmcnt(0)
    s_barrier
    v_mfma_f32_32x32x16_bf16 v[64:79], v[48:51], v[40:43], v[64:79]
    ds_read_b128 v[16:19], v5 offset:1792
    ds_read_b64_tr_b16 v[24:25], v6 offset:0
    v_mfma_f32_32x32x16_bf16 v[80:95], v[48:51], v[44:47], v[80:95]
    ds_read_b64_tr_b16 v[26:27], v6 offset:3840
    ds_read_b128 v[20:23], v5 offset:5632
    v_mfma_f32_32x32x16_bf16 v[96:111], v[52:55], v[40:43], v[96:111]
    ds_read_b64_tr_b16 v[28:29], v6 offset:64
    ds_read_b64_tr_b16 v[30:31], v6 offset:3904
    v_dot2c_f32_bf16 v248, s56, v48
    v_mfma_f32_32x32x16_bf16 v[112:127], v[52:55], v[44:47], v[112:127]
    ds_read_b64_tr_b16 v[32:33], v6 offset:128
    ds_read_b64_tr_b16 v[34:35], v6 offset:3968
    v_dot2c_f32_bf16 v248, s56, v49
    v_mfma_f32_32x32x16_bf16 v[128:143], v[56:59], v[40:43], v[128:143]
    v_dot2c_f32_bf16 v248, s56, v50
    v_mfma_f32_32x32x16_bf16 v[144:159], v[56:59], v[44:47], v[144:159]
    v_dot2c_f32_bf16 v248, s56, v51
    s_cmp_lg_u32 s40, 0
    s_cbranch_scc1 .g1_loopf3d0
    s_branch .g1_pubf3
.g1_loopf3d1:
    s_waitcnt lgkmcnt(0)
    v_mfma_f32_32x32x16_bf16 v[64:79], v[24:27], v[16:19], v[64:79]
    ds_read_b128 v[40:43], v243 offset:1792
    ds_read_b64_tr_b16 v[48:49], v6 offset:15360
    v_mfma_f32_32x32x16_bf16 v[80:95], v[24:27], v[20:23], v[80:95]
    ds_read_b64_tr_b16 v[50:51], v6 offset:19200
    ds_read_b128 v[44:47], v243 offset:5632
    v_mfma_f32_32x32x16_bf16 v[96:111], v[28:31], v[16:19], v[96:111]
    ds_read_b64_tr_b16 v[52:53], v6 offset:15424
    ds_read_b64_tr_b16 v[54:55], v6 offset:19264
    s_mov_b32 m0, s39
    s_mov_b64 exec, s[42:43]
    buffer_load_dwordx4 v3, s[20:23], s37 offen lds
    s_mov_b64 exec, -1
    v_dot2c_f32_bf16 v248, s56, v28
    v_mfma_f32_32x32x16_bf16 v[112:127], v[28:31], v[20:23], v[112:127]
    ds_read_b64_tr_b16 v[56:57], v6 offset:15488
    ds_read_b64_tr_b16 v[58:59], v6 offset:19328
    s_mov_b64 exec, s[42:43]
    buffer_load_dwordx4 v4, s[20:23], s37 offen offset:896 lds
    s_mov_b64 exec, -1
    s_add_u32 m0, s39, 1792
    s_add_u32 s37, s37, s38
    v_dot2c_f32_bf16 v248, s56, v29
    v_mfma_f32_32x32x16_bf16 v[128:143], v[32:35], v[16:19], v[128:143]
    s_add_u32 s46, s46, 1
    s_cmp_eq_u32 s46, 5
    s_cselect_b32 s41, -122880, s49
    s_cselect_b32 s46, 0, s46
    v_add_u32 v5, s41, v5
    v_add_u32 v6, s41, v6
    v_add_u32 v243, s41, v243
    buffer_load_dwordx4 v244, s[24:27], s36 offen lds
    s_add_u32 s39, s39, 30720
    s_cmp_eq_u32 s39, s13
    s_cselect_b32 s39, s12, s39
    v_dot2c_f32_bf16 v248, s56, v30
    v_mfma_f32_32x32x16_bf16 v[144:159], v[32:35], v[20:23], v[144:159]
    buffer_load_dwordx4 v245, s[24:27], s36 offen offset:1024 lds
    s_add_u32 s36, s36, 64
    s_cmp_eq_u32 s36, s59
    s_cselect_b32 s36, s78, s36
    s_cselect_b32 s37, s79, s37
    s_cmp_eq_u32 s36, 2048
    s_cselect_b32 s36, 0x100000, s36
    s_cselect_b32 s37, 0x10000000, s37
    v_dot2c_f32_bf16 v248, s56, v31
    s_sub_u32 s40, s40, 1
    s_waitcnt vmcnt(12) lgkmcnt(0)
    s_barrier
    v_mfma_f32_32x32x16_bf16 v[64:79], v[48:51], v[40:43], v[64:79]
    ds_read_b128 v[16:19], v5 offset:1792
    ds_read_b64_tr_b16 v[24:25], v6 offset:0
    v_mfma_f32_32x32x16_bf16 v[80:95], v[48:51], v[44:47], v[80:95]
    ds_read_b64_tr_b16 v[26:27], v6 offset:3840
    ds_read_b128 v[20:23], v5 offset:5632
    v_mfma_f32_32x32x16_bf16 v[96:111], v[52:55], v[40:43], v[96:111]
    ds_read_b64_tr_b16 v[28:29], v6 offset:64
    ds_read_b64_tr_b16 v[30:31], v6 offset:3904
    v_dot2c_f32_bf16 v248, s56, v52
    v_mfma_f32_32x32x16_bf16 v[112:127], v[52:55], v[44:47], v[112:127]
    ds_read_b64_tr_b16 v[32:33], v6 offset:128
    ds_read_b64_tr_b16 v[34:35], v6 offset:3968
    v_dot2c_f32_bf16 v248, s56, v53
    v_mfma_f32_32x32x16_bf16 v[128:143], v[56:59], v[40:43], v[128:143]
    v_dot2c_f32_bf16 v248, s56, v54
    v_mfma_f32_32x32x16_bf16 v[144:159], v[56:59], v[44:47], v[144:159]
    v_dot2c_f32_bf16 v248, s56, v55
    s_cmp_lg_u32 s40, 0
    s_cbranch_scc1 .g1_loopf3d1
    s_branch .g1_pubf3
.g1_loopf3d2:
    s_waitcnt lgkmcnt(0)
    v_mfma_f32_32x32x16_bf16 v[64:79], v[24:27], v[16:19], v[64:79]
    ds_read_b128 v[40:43], v243 offset:1792
    ds_read_b64_tr_b16 v[48:49], v6 offset:15360
    v_mfma_f32_32x32x16_bf16 v[80:95], v[24:27], v[20:23], v[80:95]
    ds_read_b64_tr_b16 v[50:51], v6 offset:19200
    ds_read_b128 v[44:47], v243 offset:5632
    v_mfma_f32_32x32x16_bf16 v[96:111], v[28:31], v[16:19], v[96:111]
    ds_read_b64_tr_b16 v[52:53], v6 offset:15424
    ds_read_b64_tr_b16 v[54:55], v6 offset:19264
    s_mov_b32 m0, s39
    s_mov_b64 exec, s[42:43]
    buffer_load_dwordx4 v3, s[20:23], s37 offen lds
    s_mov_b64 exec, -1
    v_dot2c_f32_bf16 v248, s56, v32
    v_mfma_f32_32x32x16_bf16 v[112:127], v[28:31], v[20:23], v[112:127]
    ds_read_b64_tr_b16 v[56:57], v6 offset:15488
    ds_read_b64_tr_b16 v[58:59], v6 offset:19328
    s_mov_b64 exec, s[42:43]
    buffer_load_dwordx4 v4, s[20:23], s37 offen offset:896 lds
    s_mov_b64 exec, -1
    s_add_u32 m0, s39, 1792
    s_add_u32 s37, s37, s38
    v_dot2c_f32_bf16 v248, s56, v33
    v_mfma_f32_32x32x16_bf16 v[128:143], v[32:35], v[16:19], v[128:143]
    s_add_u32 s46, s46, 1
    s_cmp_eq_u32 s46, 5
    s_cselect_b32 s41, -122880, s49
    s_cselect_b32 s46, 0, s46
    v_add_u32 v5, s41, v5
    v_add_u32 v6, s41, v6
    v_add_u32 v243, s41, v243
    buffer_load_dwordx4 v244, s[24:27], s36 offen lds
    s_add_u32 s39, s39, 30720
    s_cmp_eq_u32 s39, s13
    s_cselect_b32 s39, s12, s39
    v_dot2c_f32_bf16 v248, s56, v34
    v_mfma_f32_32x32x16_bf16 v[144:159], v[32:35], v[20:23], v[144:159]
    buffer_load_dwordx4 v245, s[24:27], s36 offen offset:1024 lds
    s_add_u32 s36, s36, 64
    s_cmp_eq_u32 s36, s59
    s_cselect_b32 s36, s78, s36
    s_cselect_b32 s37, s79, s37
    s_cmp_eq_u32 s36, 2048
    s_cselect_b32 s36, 0x100000, s36
    s_cselect_b32 s37, 0x10000000, s37
    v_dot2c_f32_bf16 v248, s56, v35
    s_sub_u32 s40, s40, 1
    s_waitcnt vmcnt(12) lgkmcnt(0)
    s_barrier
    v_mfma_f32_32x32x16_bf16 v[64:79], v[48:51], v[40:43], v[64:79]
    ds_read_b128 v[16:19], v5 offset:1792
    ds_read_b64_tr_b16 v[24:25], v6 offset:0
    v_mfma_f32_32x32x16_bf16 v[80:95], v[48:51], v[44:47], v[80:95]
    ds_read_b64_tr_b16 v[26:27], v6 offset:3840
    ds_read_b128 v[20:23], v5 offset:5632
    v_mfma_f32_32x32x16_bf16 v[96:111], v[52:55], v[40:43], v[96:111]
    ds_read_b64_tr_b16 v[28:29], v6 offset:64
    ds_read_b64_tr_b16 v[30:31], v6 offset:3904
    v_dot2c_f32_bf16 v248, s56, v56
    v_mfma_f32_32x32x16_bf16 v[112:127], v[52:55], v[44:47], v[112:127]
    ds_read_b64_tr_b16 v[32:33], v6 offset:128
    ds_read_b64_tr_b16 v[34:35], v6 offset:3968
    v_dot2c_f32_bf16 v248, s56, v57
    v_mfma_f32_32x32x16_bf16 v[128:143], v[56:59], v[40:43], v[128:143]
    v_dot2c_f32_bf16 v248, s56, v58
    v_mfma_f32_32x32x16_bf16 v[144:159], v[56:59], v[44:47], v[144:159]
    v_dot2c_f32_bf16 v248, s56, v59
    s_cmp_lg_u32 s40, 0
    s_cbranch_scc1 .g1_loopf3d2
    s_branch .g1_pubf3
.g1_loopf3:
    s_waitcnt lgkmcnt(0)
    v_mfma_f32_32x32x16_bf16 v[64:79], v[24:27], v[16:19], v[64:79]
    ds_read_b128 v[40:43], v243 offset:1792
    ds_read_b64_tr_b16 v[48:49], v6 offset:15360
    v_mfma_f32_32x32x16_bf16 v[80:95], v[24:27], v[20:23], v[80:95]
    ds_read_b64_tr_b16 v[50:51], v6 offset:19200
    ds_read_b128 v[44:47], v243 offset:5632
    v_mfma_f32_32x32x16_bf16 v[96:111], v[28:31], v[16:19], v[96:111]
    ds_read_b64_tr_b16 v[52:53], v6 offset:15424
    ds_read_b64_tr_b16 v[54:55], v6 offset:19264
    s_mov_b32 m0, s39
    s_mov_b64 exec, s[42:43]
    buffer_load_dwordx4 v3, s[20:23], s37 offen lds
    s_mov_b64 exec, -1
    v_mfma_f32_32x32x16_bf16 v[112:127], v[28:31], v[20:23], v[112:127]
    ds_read_b64_tr_b16 v[56:57], v6 offset:15488
    ds_read_b64_tr_b16 v[58:59], v6 offset:19328
    s_mov_b64 exec, s[42:43]
    buffer_load_dwordx4 v4, s[20:23], s37 offen offset:896 lds
    s_mov_b64 exec, -1
    s_add_u32 m0, s39, 1792
    s_add_u32 s37, s37, s38
    v_mfma_f32_32x32x16_bf16 v[128:143], v[32:35], v[16:19], v[128:143]
    s_add_u32 s46, s46, 1
    s_cmp_eq_u32 s46, 5
    s_cselect_b32 s41, -122880, s49
    s_cselect_b32 s46, 0, s46
    v_add_u32 v5, s41, v5
    v_add_u32 v6, s41, v6
    v_add_u32 v243, s41, v243
    buffer_load_dwordx4 v244, s[24:27], s36 offen lds
    s_add_u32 s39, s39, 30720
    s_cmp_eq_u32 s39, s13
    s_cselect_b32 s39, s12, s39
    v_mfma_f32_32x32x16_bf16 v[144:159], v[32:35], v[20:23], v[144:159]
    buffer_load_dwordx4 v245, s[24:27], s36 offen offset:1024 lds
    s_add_u32 s36, s36, 64
    s_cmp_eq_u32 s36, s59
    s_cselect_b32 s36, s78, s36
    s_cselect_b32 s37, s79, s37
    s_cmp_eq_u32 s36, 2048
    s_cselect_b32 s36, 0x100000, s36
    s_cselect_b32 s37, 0x10000000, s37
    s_sub_u32 s40, s40, 1
    s_waitcnt vmcnt(12) lgkmcnt(0)
    s_barrier
    v_mfma_f32_32x32x16_bf16 v[64:79], v[48:51], v[40:43], v[64:79]
    ds_read_b128 v[16:19], v5 offset:1792
    ds_read_b64_tr_b16 v[24:25], v6 offset:0
    v_mfma_f32_32x32x16_bf16 v[80:95], v[48:51], v[44:47], v[80:95]
    ds_read_b64_tr_b16 v[26:27], v6 offset:3840
    ds_read_b128 v[20:23], v5 offset:5632
    v_mfma_f32_32x32x16_bf16 v[96:111], v[52:55], v[40:43], v[96:111]
    ds_read_b64_tr_b16 v[28:29], v6 offset:64
    ds_read_b64_tr_b16 v[30:31], v6 offset:3904
    v_mfma_f32_32x32x16_bf16 v[112:127], v[52:55], v[44:47], v[112:127]
    ds_read_b64_tr_b16 v[32:33], v6 offset:128
    ds_read_b64_tr_b16 v[34:35], v6 offset:3968
    v_mfma_f32_32x32x16_bf16 v[128:143], v[56:59], v[40:43], v[128:143]
    v_mfma_f32_32x32x16_bf16 v[144:159], v[56:59], v[44:47], v[144:159]
    s_cmp_lg_u32 s40, 0
    s_cbranch_scc1 .g1_loopf3
    s_add_u32 s58, s58, 1
    s_mov_b32 s40, 4
    s_cmp_eq_u32 s58, 2
    s_cbranch_scc1 .g1_loopf3
    s_cmp_eq_u32 s58, 3
    s_cbranch_scc1 .g1_p2f3
    s_cmp_eq_u32 s58, 4
    s_cbranch_scc1 .g1_p3f3
    s_cmp_eq_u32 s58, 5
    s_cbranch_scc1 .g1_p4f3
    s_sub_u32 s78, s59, 0
    s_sub_u32 s59, s59, 256
    s_lshr_b32 s44, s38, 6
    s_mul_i32 s79, s78, s44
    s_cmp_eq_u32 s15, 0
    s_cbranch_scc1 .g1_loopf3d0
    s_cmp_eq_u32 s15, 1
    s_cbranch_scc1 .g1_loopf3d1
    s_cmp_eq_u32 s15, 2
    s_cbranch_scc1 .g1_loopf3d2
    s_branch .g1_loopf3
.g1_p2f3:
    s_mov_b32 s40, 12
    s_mov_b32 s72, s64
    s_mov_b32 s73, s65
    s_mov_b32 s74, 7340032
    s_mov_b32 s75, 0x20000
    s_sub_u32 s44, s2, 128
    s_lshl_b32 s44, s44, 3
    s_add_u32 s44, s44, s14
    s_mul_i32 s45, s44, 7168
    s_lshl_b32 s44, s44, 11
    v_lshlrev_b32 v13, 7, v1
    s_mov_b64 exec, s[42:43]
    buffer_load_dword v220, v13, s[72:75], s45 offen
    s_mov_b32 s72, s62
    s_mov_b32 s73, s63
    s_mov_b32 s74, 2097152
    s_mov_b32 s75, 0x20000
    s_mov_b64 exec, 0xffff
    buffer_load_dword v221, v13, s[72:75], s44 offen
    s_mov_b64 exec, -1
    s_cmp_eq_u32 s14, 0
    s_cbranch_scc0 .g1_loopf3
    v_mov_b32 v248, 1
    s_mov_b64 exec, 1
    buffer_atomic_add v248, v254, s[68:71], 0 offen offset:8 sc1
    s_mov_b64 exec, -1
    s_branch .g1_loopf3
.g1_pubf3:
    v_mov_b32 v249, v248
    s_nop 1
    v_permlane32_swap_b32 v248, v249
    v_add_f32 v248, v248, v249
    v_and_b32 v249, 31, v1
    v_lshlrev_b32 v249, 5, v249
    s_lshl_b32 s44, s15, 10
    s_lshl_b32 s45, s17, 2
    s_add_u32 s44, s44, s45
    s_add_u32 s44, s44, s60
    s_mov_b32 exec_hi, 0
    buffer_store_dword v248, v249, s[28:31], s44 offen sc1
    s_mov_b64 exec, -1
    s_mov_b32 s58, 2
    s_mov_b32 s40, 4
    s_branch .g1_loopf3
.g1_p3f3:
    buffer_load_dwordx4 v[216:219], v254, s[68:71], 0 offen
    s_branch .g1_loopf3
.g1_p4f3:
    s_mov_b32 s44, 16384
.g1_p4lf3:
    v_readfirstlane_b32 s45, v218
    v_readfirstlane_b32 s76, v216
    v_readfirstlane_b32 s77, v217
    s_cmp_eq_u32 s45, 256
    s_cbranch_scc1 .g1_p4okf3
    buffer_load_dwordx4 v[216:219], v254, s[68:71], 0 offen sc1
    s_sub_u32 s44, s44, 1
    s_waitcnt vmcnt(0)
    s_cmp_lg_u32 s44, 0
    s_cbranch_scc1 .g1_p4lf3
.g1_p4okf3:
    v_and_b32 v249, 31, v1
    v_lshlrev_b32 v248, 3, v249
    v_lshlrev_b32 v249, 5, v249
    v_lshl_add_u32 v249, v7, 4, v249
    buffer_load_dwordx2 v[240:241], v248, s[28:31], s61 offen sc1
    buffer_load_dwordx2 v[246:247], v248, s[28:31], s61 offen offset:256 sc1
    buffer_load_dwordx4 v[224:227], v249, s[28:31], s60 offen offset:0 sc1
    buffer_load_dwordx4 v[228:231], v249, s[28:31], s60 offen offset:1024 sc1
    buffer_load_dwordx4 v[232:235], v249, s[28:31], s60 offen offset:2048 sc1
    buffer_load_ushort v250, v12, s[32:35], 0 offen offset:0
    buffer_load_ushort v251, v12, s[32:35], 0 offen offset:64
    buffer_load_ushort v252, v12, s[32:35], 0 offen offset:128
    s_waitcnt lgkmcnt(0)
    v_mfma_f32_32x32x16_bf16 v[64:79], v[24:27], v[16:19], v[64:79]
    ds_read_b128 v[40:43], v243 offset:1792
    ds_read_b64_tr_b16 v[48:49], v6 offset:15360
    v_mfma_f32_32x32x16_bf16 v[80:95], v[24:27], v[20:23], v[80:95]
    ds_read_b64_tr_b16 v[50:51], v6 offset:19200
    ds_read_b128 v[44:47], v243 offset:5632
    v_mfma_f32_32x32x16_bf16 v[96:111], v[28:31], v[16:19], v[96:111]
    ds_read_b64_tr_b16 v[52:53], v6 offset:15424
    ds_read_b64_tr_b16 v[54:55], v6 offset:19264
    v_mfma_f32_32x32x16_bf16 v[112:127], v[28:31], v[20:23], v[112:127]
    ds_read_b64_tr_b16 v[56:57], v6 offset:15488
    ds_read_b64_tr_b16 v[58:59], v6 offset:19328
    v_mfma_f32_32x32x16_bf16 v[128:143], v[32:35], v[16:19], v[128:143]
    s_add_u32 s46, s46, 1
    s_cmp_eq_u32 s46, 5
    s_cselect_b32 s41, -122880, s49
    s_cselect_b32 s46, 0, s46
    v_add_u32 v5, s41, v5
    v_add_u32 v6, s41, v6
    v_add_u32 v243, s41, v243
    v_mfma_f32_32x32x16_bf16 v[144:159], v[32:35], v[20:23], v[144:159]
    s_waitcnt vmcnt(16) lgkmcnt(0)
    s_barrier
    v_mfma_f32_32x32x16_bf16 v[64:79], v[48:51], v[40:43], v[64:79]
    ds_read_b128 v[16:19], v5 offset:1792
    ds_read_b64_tr_b16 v[24:25], v6 offset:0
    v_mfma_f32_32x32x16_bf16 v[80:95], v[48:51], v[44:47], v[80:95]
    ds_read_b64_tr_b16 v[26:27], v6 offset:3840
    ds_read_b128 v[20:23], v5 offset:5632
    v_mfma_f32_32x32x16_bf16 v[96:111], v[52:55], v[40:43], v[96:111]
    ds_read_b64_tr_b16 v[28:29], v6 offset:64
    ds_read_b64_tr_b16 v[30:31], v6 offset:3904
    v_mfma_f32_32x32x16_bf16 v[112:127], v[52:55], v[44:47], v[112:127]
    ds_read_b64_tr_b16 v[32:33], v6 offset:128
    ds_read_b64_tr_b16 v[34:35], v6 offset:3968
    v_mfma_f32_32x32x16_bf16 v[128:143], v[56:59], v[40:43], v[128:143]
    v_mfma_f32_32x32x16_bf16 v[144:159], v[56:59], v[44:47], v[144:159]
    s_waitcnt lgkmcnt(0)
    v_mfma_f32_32x32x16_bf16 v[64:79], v[24:27], v[16:19], v[64:79]
    ds_read_b128 v[40:43], v243 offset:1792
    ds_read_b64_tr_b16 v[48:49], v6 offset:15360
    v_mfma_f32_32x32x16_bf16 v[80:95], v[24:27], v[20:23], v[80:95]
    ds_read_b64_tr_b16 v[50:51], v6 offset:19200
    ds_read_b128 v[44:47], v243 offset:5632
    v_mfma_f32_32x32x16_bf16 v[96:111], v[28:31], v[16:19], v[96:111]
    ds_read_b64_tr_b16 v[52:53], v6 offset:15424
    ds_read_b64_tr_b16 v[54:55], v6 offset:19264
    v_mfma_f32_32x32x16_bf16 v[112:127], v[28:31], v[20:23], v[112:127]
    ds_read_b64_tr_b16 v[56:57], v6 offset:15488
    ds_read_b64_tr_b16 v[58:59], v6 offset:19328
    v_mfma_f32_32x32x16_bf16 v[128:143], v[32:35], v[16:19], v[128:143]
    s_add_u32 s46, s46, 1
    s_cmp_eq_u32 s46, 5
    s_cselect_b32 s41, -122880, s49
    s_cselect_b32 s46, 0, s46
    v_add_u32 v5, s41, v5
    v_add_u32 v6, s41, v6
    v_add_u32 v243, s41, v243
    v_mfma_f32_32x32x16_bf16 v[144:159], v[32:35], v[20:23], v[144:159]
    s_waitcnt vmcnt(12) lgkmcnt(0)
    s_barrier
    v_mfma_f32_32x32x16_bf16 v[64:79], v[48:51], v[40:43], v[64:79]
    ds_read_b128 v[16:19], v5 offset:1792
    ds_read_b64_tr_b16 v[24:25], v6 offset:0
    v_mfma_f32_32x32x16_bf16 v[80:95], v[48:51], v[44:47], v[80:95]
    ds_read_b64_tr_b16 v[26:27], v6 offset:3840
    ds_read_b128 v[20:23], v5 offset:5632
    v_mfma_f32_32x32x16_bf16 v[96:111], v[52:55], v[40:43], v[96:111]
    ds_read_b64_tr_b16 v[28:29], v6 offset:64
    ds_read_b64_tr_b16 v[30:31], v6 offset:3904
    v_mfma_f32_32x32x16_bf16 v[112:127], v[52:55], v[44:47], v[112:127]
    ds_read_b64_tr_b16 v[32:33], v6 offset:128
    ds_read_b64_tr_b16 v[34:35], v6 offset:3968
    v_mfma_f32_32x32x16_bf16 v[128:143], v[56:59], v[40:43], v[128:143]
    v_mfma_f32_32x32x16_bf16 v[144:159], v[56:59], v[44:47], v[144:159]
    s_waitcnt lgkmcnt(0)
    v_mfma_f32_32x32x16_bf16 v[64:79], v[24:27], v[16:19], v[64:79]
    ds_read_b128 v[40:43], v243 offset:1792
    ds_read_b64_tr_b16 v[48:49], v6 offset:15360
    v_mfma_f32_32x32x16_bf16 v[80:95], v[24:27], v[20:23], v[80:95]
    ds_read_b64_tr_b16 v[50:51], v6 offset:19200
    ds_read_b128 v[44:47], v243 offset:5632
    v_mfma_f32_32x32x16_bf16 v[96:111], v[28:31], v[16:19], v[96:111]
    ds_read_b64_tr_b16 v[52:53], v6 offset:15424
    ds_read_b64_tr_b16 v[54:55], v6 offset:19264
    v_mfma_f32_32x32x16_bf16 v[112:127], v[28:31], v[20:23], v[112:127]
    ds_read_b64_tr_b16 v[56:57], v6 offset:15488
    ds_read_b64_tr_b16 v[58:59], v6 offset:19328
    v_mfma_f32_32x32x16_bf16 v[128:143], v[32:35], v[16:19], v[128:143]
    s_add_u32 s46, s46, 1
    s_cmp_eq_u32 s46, 5
    s_cselect_b32 s41, -122880, s49
    s_cselect_b32 s46, 0, s46
    v_add_u32 v5, s41, v5
    v_add_u32 v6, s41, v6
    v_add_u32 v243, s41, v243
    v_mfma_f32_32x32x16_bf16 v[144:159], v[32:35], v[20:23], v[144:159]
    s_waitcnt vmcnt(8) lgkmcnt(0)
    s_barrier
    v_mfma_f32_32x32x16_bf16 v[64:79], v[48:51], v[40:43], v[64:79]
    ds_read_b128 v[16:19], v5 offset:1792
    ds_read_b64_tr_b16 v[24:25], v6 offset:0
    v_mfma_f32_32x32x16_bf16 v[80:95], v[48:51], v[44:47], v[80:95]
    ds_read_b64_tr_b16 v[26:27], v6 offset:3840
    ds_read_b128 v[20:23], v5 offset:5632
    v_mfma_f32_32x32x16_bf16 v[96:111], v[52:55], v[40:43], v[96:111]
    ds_read_b64_tr_b16 v[28:29], v6 offset:64
    ds_read_b64_tr_b16 v[30:31], v6 offset:3904
    v_mfma_f32_32x32x16_bf16 v[112:127], v[52:55], v[44:47], v[112:127]
    ds_read_b64_tr_b16 v[32:33], v6 offset:128
    ds_read_b64_tr_b16 v[34:35], v6 offset:3968
    v_mfma_f32_32x32x16_bf16 v[128:143], v[56:59], v[40:43], v[128:143]
    v_mfma_f32_32x32x16_bf16 v[144:159], v[56:59], v[44:47], v[144:159]
    s_waitcnt lgkmcnt(0)
    v_mfma_f32_32x32x16_bf16 v[64:79], v[24:27], v[16:19], v[64:79]
    ds_read_b128 v[40:43], v243 offset:1792
    ds_read_b64_tr_b16 v[48:49], v6 offset:15360
    v_mfma_f32_32x32x16_bf16 v[80:95], v[24:27], v[20:23], v[80:95]
    ds_read_b64_tr_b16 v[50:51], v6 offset:19200
    ds_read_b128 v[44:47], v243 offset:5632
    v_mfma_f32_32x32x16_bf16 v[96:111], v[28:31], v[16:19], v[96:111]
    ds_read_b64_tr_b16 v[52:53], v6 offset:15424
    ds_read_b64_tr_b16 v[54:55], v6 offset:19264
    v_mfma_f32_32x32x16_bf16 v[112:127], v[28:31], v[20:23], v[112:127]
    ds_read_b64_tr_b16 v[56:57], v6 offset:15488
    ds_read_b64_tr_b16 v[58:59], v6 offset:19328
    v_mfma_f32_32x32x16_bf16 v[128:143], v[32:35], v[16:19], v[128:143]
    s_add_u32 s46, s46, 1
    s_cmp_eq_u32 s46, 5
    s_cselect_b32 s41, -122880, s49
    s_cselect_b32 s46, 0, s46
    v_add_u32 v5, s41, v5
    v_add_u32 v6, s41, v6
    v_add_u32 v243, s41, v243
    v_mfma_f32_32x32x16_bf16 v[144:159], v[32:35], v[20:23], v[144:159]
    s_waitcnt lgkmcnt(0)
    s_barrier
    v_mfma_f32_32x32x16_bf16 v[64:79], v[48:51], v[40:43], v[64:79]
    v_mfma_f32_32x32x16_bf16 v[80:95], v[48:51], v[44:47], v[80:95]
    v_mfma_f32_32x32x16_bf16 v[96:111], v[52:55], v[40:43], v[96:111]
    v_mfma_f32_32x32x16_bf16 v[112:127], v[52:55], v[44:47], v[112:127]
    v_mfma_f32_32x32x16_bf16 v[128:143], v[56:59], v[40:43], v[128:143]
    v_mfma_f32_32x32x16_bf16 v[144:159], v[56:59], v[44:47], v[144:159]
.g1_donef3:
    v_mov_b32 v60, s51
    v_mov_b32 v61, s51
    v_add_u32 v14, 4096, v2
    s_mov_b32 s53, s52
    s_mov_b32 s54, 1.0
    s_mov_b32 s55, 1.0
    s_waitcnt vmcnt(0) lgkmcnt(0)
    s_barrier
    v_mov_b32 v18, 0
    v_mov_b32 v19, 0
    v_mov_b32 v22, 0
    v_mov_b32 v23, 0
    v_mov_b32 v56, v241
    v_mov_b32 v57, v241
    v_mov_b32 v58, v247
    v_mov_b32 v59, v247
    v_cmp_gt_u32 vcc, 32, v1
    s_mov_b32 s44, 0x01000100
    v_perm_b32 v16, v240, v240, s44
    v_perm_b32 v20, v246, v246, s44
    v_cndmask_b32 v17, 0, v240, vcc
    v_cndmask_b32 v21, 0, v246, vcc
    v_cndmask_b32 v16, 0, v16, vcc
    v_cndmask_b32 v20, 0, v20, vcc
    v_add_f32 v224, v224, v225
    v_add_f32 v226, v226, v227
    v_mov_b32 v26, 0
    v_add_f32 v224, v224, v226
    v_mov_b32 v27, 0
    v_add_f32 v228, v228, v229
    v_add_f32 v230, v230, v231
    v_mov_b32 v30, 0
    v_add_f32 v228, v228, v230
    v_mov_b32 v31, 0
    v_add_f32 v232, v232, v233
    v_add_f32 v234, v234, v235
    v_mov_b32 v34, 0
    v_add_f32 v232, v232, v234
    v_mov_b32 v35, 0
    v_mov_b32 v225, v224
    v_mov_b32 v229, v228
    v_mov_b32 v233, v232
    v_permlane32_swap_b32 v224, v225
    v_permlane32_swap_b32 v228, v229
    v_permlane32_swap_b32 v232, v233
    v_add_f32 v224, v224, v225
    v_add_f32 v228, v228, v229
    v_add_f32 v232, v232, v233
    v_cvt_pk_bf16_f32 v225, v224, v224
    v_cvt_pk_bf16_f32 v229, v228, v228
    v_cvt_pk_bf16_f32 v233, v232, v232
    v_lshlrev_b32 v225, 16, v225
    v_lshlrev_b32 v229, 16, v229
    v_lshlrev_b32 v233, 16, v233
    v_sub_f32 v224, v224, v225
    v_sub_f32 v228, v228, v229
    v_sub_f32 v232, v232, v233
    v_cvt_pk_bf16_f32 v226, v224, v224
    v_cvt_pk_bf16_f32 v230, v228, v228
    v_cvt_pk_bf16_f32 v234, v232, v232
    v_lshlrev_b32 v226, 16, v226
    v_lshlrev_b32 v230, 16, v230
    v_lshlrev_b32 v234, 16, v234
    v_sub_f32 v224, v224, v226
    v_sub_f32 v228, v228, v230
    v_sub_f32 v232, v232, v234
    v_cvt_pk_bf16_f32 v24, v225, v226
    v_lshlrev_b32 v250, 16, v250
    v_cvt_pk_bf16_f32 v25, v224, v250
    v_cvt_pk_bf16_f32 v28, v229, v230
    v_lshlrev_b32 v251, 16, v251
    v_cvt_pk_bf16_f32 v29, v228, v251
    v_cvt_pk_bf16_f32 v32, v233, v234
    v_lshlrev_b32 v252, 16, v252
    v_cvt_pk_bf16_f32 v33, v232, v252
    v_mfma_f32_32x32x16_bf16 v[64:79], v[24:27], v[16:19], v[64:79]
    v_mfma_f32_32x32x16_bf16 v[80:95], v[24:27], v[20:23], v[80:95]
    v_mfma_f32_32x32x16_bf16 v[96:111], v[28:31], v[16:19], v[96:111]
    v_mfma_f32_32x32x16_bf16 v[112:127], v[28:31], v[20:23], v[112:127]
    v_mfma_f32_32x32x16_bf16 v[128:143], v[32:35], v[16:19], v[128:143]
    v_mfma_f32_32x32x16_bf16 v[144:159], v[32:35], v[20:23], v[144:159]
    s_and_b32 s39, s2, 3
    s_sub_u32 s36, s39, 1
    s_mul_i32 s36, s36, 2424832
    s_mov_b32 s24, s64
    s_mov_b32 s25, s65
    s_mov_b32 s26, 7340032
    s_mov_b32 s27, 0x20000
    s_mul_i32 s40, s39, 5
    s_lshl_b32 s40, 0x3f, s40
    s_lshr_b32 s40, s40, 5
    s_mov_b32 s41, 0
    s_mov_b32 s38, 28333056
    s_cmp_eq_u32 s39, 0
    s_cbranch_scc0 .g1_wff
    s_mov_b32 s36, 0
    s_mov_b32 s40, 0xffff
    s_mov_b32 s38, 28332032
    s_mov_b32 s24, s62
    s_mov_b32 s25, s63
    s_mov_b32 s26, 2097152
    s_mov_b32 s27, 0x20000
.g1_wff:
    v_lshrrev_b32 v5, 4, v1
    v_bfe_u32 v6, v1, 2, 2
    v_xor_b32 v6, v6, v5
    v_lshlrev_b32 v3, 11, v5
    v_lshl_add_u32 v3, v6, 6, v3
    v_and_b32 v6, 3, v1
    v_lshl_add_u32 v3, v6, 4, v3
    s_lshl_b32 s37, s15, 14
    s_lshr_b32 s39, s2, 5
    s_lshl_b32 s39, s39, 8
    s_add_u32 s37, s37, s39
    v_add_u32 v3, s37, v3
    v_add_u32 v4, 7168, v3
    s_mul_i32 s37, s15, 6144
    s_bfe_u32 s39, s2, 0x10002
    s_lshl_b32 s39, s39, 9
    s_add_u32 s38, s38, s39
    s_bfe_u32 s39, s2, 0x20003
    s_lshl_b32 s39, s39, 7
    s_add_u32 s38, s38, s39
    v_lshlrev_b32 v5, 3, v1
    v_mov_b32 v10, 0
    v_mov_b32 v11, 0
    s_add_u32 m0, s37, 0
    s_nop 0
    buffer_load_dwordx4 v3, s[24:27], s36 offen lds
    buffer_load_dwordx4 v4, s[24:27], s36 offen offset:1024 lds
    s_add_u32 s36, s36, 65536
    s_add_u32 m0, s37, 24576
    s_nop 0
    buffer_load_dwordx4 v3, s[24:27], s36 offen lds
    buffer_load_dwordx4 v4, s[24:27], s36 offen offset:1024 lds
    s_add_u32 s36, s36, 65536
    s_add_u32 m0, s37, 49152
    s_nop 0
    buffer_load_dwordx4 v3, s[24:27], s36 offen lds
    buffer_load_dwordx4 v4, s[24:27], s36 offen offset:1024 lds
    s_add_u32 s36, s36, 65536
    s_add_u32 m0, s37, 73728
    s_nop 0
    buffer_load_dwordx4 v3, s[24:27], s36 offen lds
    buffer_load_dwordx4 v4, s[24:27], s36 offen offset:1024 lds
    s_add_u32 s36, s36, 65536
    s_add_u32 m0, s37, 98304
    s_nop 0
    buffer_load_dwordx4 v3, s[24:27], s36 offen lds
    buffer_load_dwordx4 v4, s[24:27], s36 offen offset:1024 lds
    s_add_u32 s36, s36, 65536
    s_add_u32 m0, s37, 122880
    s_nop 0
    buffer_load_dwordx4 v3, s[24:27], s36 offen lds
    buffer_load_dwordx4 v4, s[24:27], s36 offen offset:1024 lds
    s_add_u32 s36, s36, 65536
    v_pk_mul_f32 v[64:65], v[64:65], v[56:57]
    v_pk_mul_f32 v[66:67], v[66:67], v[56:57]
    v_pk_mul_f32 v[68:69], v[68:69], v[56:57]
    v_pk_mul_f32 v[70:71], v[70:71], v[56:57]
    v_pk_mul_f32 v[72:73], v[72:73], v[56:57]
    v_pk_mul_f32 v[74:75], v[74:75], v[56:57]
    v_pk_mul_f32 v[76:77], v[76:77], v[56:57]
    v_pk_mul_f32 v[78:79], v[78:79], v[56:57]
    v_pk_mul_f32 v[192:193], v[64:65], v[64:65]
    v_pk_mul_f32 v[194:195], v[66:67], v[66:67]
    v_pk_mul_f32 v[196:197], v[68:69], v[68:69]
    v_pk_mul_f32 v[198:199], v[70:71], v[70:71]
    v_pk_mul_f32 v[200:201], v[72:73], v[72:73]
    v_pk_mul_f32 v[202:203], v[74:75], v[74:75]
    v_pk_mul_f32 v[204:205], v[76:77], v[76:77]
    v_pk_mul_f32 v[206:207], v[78:79], v[78:79]
    v_pk_fma_f32 v[192:193], v[192:193], s[52:53], v[60:61]
    v_pk_fma_f32 v[194:195], v[194:195], s[52:53], v[60:61]
    v_pk_fma_f32 v[196:197], v[196:197], s[52:53], v[60:61]
    v_pk_fma_f32 v[198:199], v[198:199], s[52:53], v[60:61]
    v_pk_fma_f32 v[200:201], v[200:201], s[52:53], v[60:61]
    v_pk_fma_f32 v[202:203], v[202:203], s[52:53], v[60:61]
    v_pk_fma_f32 v[204:205], v[204:205], s[52:53], v[60:61]
    v_pk_fma_f32 v[206:207], v[206:207], s[52:53], v[60:61]
    v_pk_mul_f32 v[192:193], v[192:193], v[64:65]
    v_pk_mul_f32 v[194:195], v[194:195], v[66:67]
    v_pk_mul_f32 v[196:197], v[196:197], v[68:69]
    v_pk_mul_f32 v[198:199], v[198:199], v[70:71]
    v_pk_mul_f32 v[200:201], v[200:201], v[72:73]
    v_pk_mul_f32 v[202:203], v[202:203], v[74:75]
    v_pk_mul_f32 v[204:205], v[204:205], v[76:77]
    v_pk_mul_f32 v[206:207], v[206:207], v[78:79]
    v_exp_f32 v192, v192
    v_exp_f32 v193, v193
    v_exp_f32 v194, v194
    v_exp_f32 v195, v195
    v_exp_f32 v196, v196
    v_exp_f32 v197, v197
    v_exp_f32 v198, v198
    v_exp_f32 v199, v199
    v_exp_f32 v200, v200
    v_exp_f32 v201, v201
    v_exp_f32 v202, v202
    v_exp_f32 v203, v203
    v_exp_f32 v204, v204
    v_exp_f32 v205, v205
    v_exp_f32 v206, v206
    v_exp_f32 v207, v207
    v_pk_add_f32 v[192:193], v[192:193], s[54:55]
    v_pk_add_f32 v[194:195], v[194:195], s[54:55]
    v_pk_add_f32 v[196:197], v[196:197], s[54:55]
    v_pk_add_f32 v[198:199], v[198:199], s[54:55]
    v_pk_add_f32 v[200:201], v[200:201], s[54:55]
    v_pk_add_f32 v[202:203], v[202:203], s[54:55]
    v_pk_add_f32 v[204:205], v[204:205], s[54:55]
    v_pk_add_f32 v[206:207], v[206:207], s[54:55]
    v_rcp_f32 v192, v192
    v_rcp_f32 v193, v193
    v_rcp_f32 v194, v194
    v_rcp_f32 v195, v195
    v_rcp_f32 v196, v196
    v_rcp_f32 v197, v197
    v_rcp_f32 v198, v198
    v_rcp_f32 v199, v199
    v_rcp_f32 v200, v200
    v_rcp_f32 v201, v201
    v_rcp_f32 v202, v202
    v_rcp_f32 v203, v203
    v_rcp_f32 v204, v204
    v_rcp_f32 v205, v205
    v_rcp_f32 v206, v206
    v_rcp_f32 v207, v207
    v_pk_mul_f32 v[192:193], v[192:193], v[64:65]
    v_pk_mul_f32 v[194:195], v[194:195], v[66:67]
    v_pk_mul_f32 v[196:197], v[196:197], v[68:69]
    v_pk_mul_f32 v[198:199], v[198:199], v[70:71]
    v_pk_mul_f32 v[200:201], v[200:201], v[72:73]
    v_pk_mul_f32 v[202:203], v[202:203], v[74:75]
    v_pk_mul_f32 v[204:205], v[204:205], v[76:77]
    v_pk_mul_f32 v[206:207], v[206:207], v[78:79]
    v_cvt_pk_bf16_f32 v224, v192, v193
    v_cvt_pk_bf16_f32 v225, v194, v195
    v_cvt_pk_bf16_f32 v226, v196, v197
    v_cvt_pk_bf16_f32 v227, v198, v199
    v_cvt_pk_bf16_f32 v228, v200, v201
    v_cvt_pk_bf16_f32 v229, v202, v203
    v_cvt_pk_bf16_f32 v230, v204, v205
    v_cvt_pk_bf16_f32 v231, v206, v207
    buffer_store_dwordx4 v[224:227], v2, s[28:31], s48 offen offset:0 sc1
    buffer_store_dwordx4 v[228:231], v2, s[28:31], s48 offen offset:1024 sc1
    v_pk_mul_f32 v[80:81], v[80:81], v[58:59]
    v_pk_mul_f32 v[82:83], v[82:83], v[58:59]
    v_pk_mul_f32 v[84:85], v[84:85], v[58:59]
    v_pk_mul_f32 v[86:87], v[86:87], v[58:59]
    v_pk_mul_f32 v[88:89], v[88:89], v[58:59]
    v_pk_mul_f32 v[90:91], v[90:91], v[58:59]
    v_pk_mul_f32 v[92:93], v[92:93], v[58:59]
    v_pk_mul_f32 v[94:95], v[94:95], v[58:59]
    v_pk_mul_f32 v[208:209], v[80:81], v[80:81]
    v_pk_mul_f32 v[210:211], v[82:83], v[82:83]
    v_pk_mul_f32 v[212:213], v[84:85], v[84:85]
    v_pk_mul_f32 v[214:215], v[86:87], v[86:87]
    v_pk_mul_f32 v[216:217], v[88:89], v[88:89]
    v_pk_mul_f32 v[218:219], v[90:91], v[90:91]
    v_pk_mul_f32 v[220:221], v[92:93], v[92:93]
    v_pk_mul_f32 v[222:223], v[94:95], v[94:95]
    v_pk_fma_f32 v[208:209], v[208:209], s[52:53], v[60:61]
    v_pk_fma_f32 v[210:211], v[210:211], s[52:53], v[60:61]
    v_pk_fma_f32 v[212:213], v[212:213], s[52:53], v[60:61]
    v_pk_fma_f32 v[214:215], v[214:215], s[52:53], v[60:61]
    v_pk_fma_f32 v[216:217], v[216:217], s[52:53], v[60:61]
    v_pk_fma_f32 v[218:219], v[218:219], s[52:53], v[60:61]
    v_pk_fma_f32 v[220:221], v[220:221], s[52:53], v[60:61]
    v_pk_fma_f32 v[222:223], v[222:223], s[52:53], v[60:61]
    v_pk_mul_f32 v[208:209], v[208:209], v[80:81]
    v_pk_mul_f32 v[210:211], v[210:211], v[82:83]
    v_pk_mul_f32 v[212:213], v[212:213], v[84:85]
    v_pk_mul_f32 v[214:215], v[214:215], v[86:87]
    v_pk_mul_f32 v[216:217], v[216:217], v[88:89]
    v_pk_mul_f32 v[218:219], v[218:219], v[90:91]
    v_pk_mul_f32 v[220:221], v[220:221], v[92:93]
    v_pk_mul_f32 v[222:223], v[222:223], v[94:95]
    v_exp_f32 v208, v208
    v_exp_f32 v209, v209
    v_exp_f32 v210, v210
    v_exp_f32 v211, v211
    v_exp_f32 v212, v212
    v_exp_f32 v213, v213
    v_exp_f32 v214, v214
    v_exp_f32 v215, v215
    v_exp_f32 v216, v216
    v_exp_f32 v217, v217
    v_exp_f32 v218, v218
    v_exp_f32 v219, v219
    v_exp_f32 v220, v220
    v_exp_f32 v221, v221
    v_exp_f32 v222, v222
    v_exp_f32 v223, v223
    v_pk_add_f32 v[208:209], v[208:209], s[54:55]
    v_pk_add_f32 v[210:211], v[210:211], s[54:55]
    v_pk_add_f32 v[212:213], v[212:213], s[54:55]
    v_pk_add_f32 v[214:215], v[214:215], s[54:55]
    v_pk_add_f32 v[216:217], v[216:217], s[54:55]
    v_pk_add_f32 v[218:219], v[218:219], s[54:55]
    v_pk_add_f32 v[220:221], v[220:221], s[54:55]
    v_pk_add_f32 v[222:223], v[222:223], s[54:55]
    v_rcp_f32 v208, v208
    v_rcp_f32 v209, v209
    v_rcp_f32 v210, v210
    v_rcp_f32 v211, v211
    v_rcp_f32 v212, v212
    v_rcp_f32 v213, v213
    v_rcp_f32 v214, v214
    v_rcp_f32 v215, v215
    v_rcp_f32 v216, v216
    v_rcp_f32 v217, v217
    v_rcp_f32 v218, v218
    v_rcp_f32 v219, v219
    v_rcp_f32 v220, v220
    v_rcp_f32 v221, v221
    v_rcp_f32 v222, v222
    v_rcp_f32 v223, v223
    v_pk_mul_f32 v[208:209], v[208:209], v[80:81]
    v_pk_mul_f32 v[210:211], v[210:211], v[82:83]
    v_pk_mul_f32 v[212:213], v[212:213], v[84:85]
    v_pk_mul_f32 v[214:215], v[214:215], v[86:87]
    v_pk_mul_f32 v[216:217], v[216:217], v[88:89]
    v_pk_mul_f32 v[218:219], v[218:219], v[90:91]
    v_pk_mul_f32 v[220:221], v[220:221], v[92:93]
    v_pk_mul_f32 v[222:223], v[222:223], v[94:95]
    v_cvt_pk_bf16_f32 v232, v208, v209
    v_cvt_pk_bf16_f32 v233, v210, v211
    v_cvt_pk_bf16_f32 v234, v212, v213
    v_cvt_pk_bf16_f32 v235, v214, v215
    v_cvt_pk_bf16_f32 v236, v216, v217
    v_cvt_pk_bf16_f32 v237, v218, v219
    v_cvt_pk_bf16_f32 v238, v220, v221
    v_cvt_pk_bf16_f32 v239, v222, v223
    buffer_store_dwordx4 v[232:235], v2, s[28:31], s50 offen offset:0 sc1
    buffer_store_dwordx4 v[236:239], v2, s[28:31], s50 offen offset:1024 sc1
    v_pk_mul_f32 v[96:97], v[96:97], v[56:57]
    v_pk_mul_f32 v[98:99], v[98:99], v[56:57]
    v_pk_mul_f32 v[100:101], v[100:101], v[56:57]
    v_pk_mul_f32 v[102:103], v[102:103], v[56:57]
    v_pk_mul_f32 v[104:105], v[104:105], v[56:57]
    v_pk_mul_f32 v[106:107], v[106:107], v[56:57]
    v_pk_mul_f32 v[108:109], v[108:109], v[56:57]
    v_pk_mul_f32 v[110:111], v[110:111], v[56:57]
    v_pk_mul_f32 v[192:193], v[96:97], v[96:97]
    v_pk_mul_f32 v[194:195], v[98:99], v[98:99]
    v_pk_mul_f32 v[196:197], v[100:101], v[100:101]
    v_pk_mul_f32 v[198:199], v[102:103], v[102:103]
    v_pk_mul_f32 v[200:201], v[104:105], v[104:105]
    v_pk_mul_f32 v[202:203], v[106:107], v[106:107]
    v_pk_mul_f32 v[204:205], v[108:109], v[108:109]
    v_pk_mul_f32 v[206:207], v[110:111], v[110:111]
    v_pk_fma_f32 v[192:193], v[192:193], s[52:53], v[60:61]
    v_pk_fma_f32 v[194:195], v[194:195], s[52:53], v[60:61]
    v_pk_fma_f32 v[196:197], v[196:197], s[52:53], v[60:61]
    v_pk_fma_f32 v[198:199], v[198:199], s[52:53], v[60:61]
    v_pk_fma_f32 v[200:201], v[200:201], s[52:53], v[60:61]
    v_pk_fma_f32 v[202:203], v[202:203], s[52:53], v[60:61]
    v_pk_fma_f32 v[204:205], v[204:205], s[52:53], v[60:61]
    v_pk_fma_f32 v[206:207], v[206:207], s[52:53], v[60:61]
    v_pk_mul_f32 v[192:193], v[192:193], v[96:97]
    v_pk_mul_f32 v[194:195], v[194:195], v[98:99]
    v_pk_mul_f32 v[196:197], v[196:197], v[100:101]
    v_pk_mul_f32 v[198:199], v[198:199], v[102:103]
    v_pk_mul_f32 v[200:201], v[200:201], v[104:105]
    v_pk_mul_f32 v[202:203], v[202:203], v[106:107]
    v_pk_mul_f32 v[204:205], v[204:205], v[108:109]
    v_pk_mul_f32 v[206:207], v[206:207], v[110:111]
    v_exp_f32 v192, v192
    v_exp_f32 v193, v193
    v_exp_f32 v194, v194
    v_exp_f32 v195, v195
    v_exp_f32 v196, v196
    v_exp_f32 v197, v197
    v_exp_f32 v198, v198
    v_exp_f32 v199, v199
    v_exp_f32 v200, v200
    v_exp_f32 v201, v201
    v_exp_f32 v202, v202
    v_exp_f32 v203, v203
    v_exp_f32 v204, v204
    v_exp_f32 v205, v205
    v_exp_f32 v206, v206
    v_exp_f32 v207, v207
    v_pk_add_f32 v[192:193], v[192:193], s[54:55]
    v_pk_add_f32 v[194:195], v[194:195], s[54:55]
    v_pk_add_f32 v[196:197], v[196:197], s[54:55]
    v_pk_add_f32 v[198:199], v[198:199], s[54:55]
    v_pk_add_f32 v[200:201], v[200:201], s[54:55]
    v_pk_add_f32 v[202:203], v[202:203], s[54:55]
    v_pk_add_f32 v[204:205], v[204:205], s[54:55]
    v_pk_add_f32 v[206:207], v[206:207], s[54:55]
    v_rcp_f32 v192, v192
    v_rcp_f32 v193, v193
    v_rcp_f32 v194, v194
    v_rcp_f32 v195, v195
    v_rcp_f32 v196, v196
    v_rcp_f32 v197, v197
    v_rcp_f32 v198, v198
    v_rcp_f32 v199, v199
    v_rcp_f32 v200, v200
    v_rcp_f32 v201, v201
    v_rcp_f32 v202, v202
    v_rcp_f32 v203, v203
    v_rcp_f32 v204, v204
    v_rcp_f32 v205, v205
    v_rcp_f32 v206, v206
    v_rcp_f32 v207, v207
    v_pk_mul_f32 v[192:193], v[192:193], v[96:97]
    v_pk_mul_f32 v[194:195], v[194:195], v[98:99]
    v_pk_mul_f32 v[196:197], v[196:197], v[100:101]
    v_pk_mul_f32 v[198:199], v[198:199], v[102:103]
    v_pk_mul_f32 v[200:201], v[200:201], v[104:105]
    v_pk_mul_f32 v[202:203], v[202:203], v[106:107]
    v_pk_mul_f32 v[204:205], v[204:205], v[108:109]
    v_pk_mul_f32 v[206:207], v[206:207], v[110:111]
    v_cvt_pk_bf16_f32 v224, v192, v193
    v_cvt_pk_bf16_f32 v225, v194, v195
    v_cvt_pk_bf16_f32 v226, v196, v197
    v_cvt_pk_bf16_f32 v227, v198, v199
    v_cvt_pk_bf16_f32 v228, v200, v201
    v_cvt_pk_bf16_f32 v229, v202, v203
    v_cvt_pk_bf16_f32 v230, v204, v205
    v_cvt_pk_bf16_f32 v231, v206, v207
    buffer_store_dwordx4 v[224:227], v2, s[28:31], s48 offen offset:2048 sc1
    buffer_store_dwordx4 v[228:231], v2, s[28:31], s48 offen offset:3072 sc1
    v_pk_mul_f32 v[112:113], v[112:113], v[58:59]
    v_pk_mul_f32 v[114:115], v[114:115], v[58:59]
    v_pk_mul_f32 v[116:117], v[116:117], v[58:59]
    v_pk_mul_f32 v[118:119], v[118:119], v[58:59]
    v_pk_mul_f32 v[120:121], v[120:121], v[58:59]
    v_pk_mul_f32 v[122:123], v[122:123], v[58:59]
    v_pk_mul_f32 v[124:125], v[124:125], v[58:59]
    v_pk_mul_f32 v[126:127], v[126:127], v[58:59]
    v_pk_mul_f32 v[208:209], v[112:113], v[112:113]
    v_pk_mul_f32 v[210:211], v[114:115], v[114:115]
    v_pk_mul_f32 v[212:213], v[116:117], v[116:117]
    v_pk_mul_f32 v[214:215], v[118:119], v[118:119]
    v_pk_mul_f32 v[216:217], v[120:121], v[120:121]
    v_pk_mul_f32 v[218:219], v[122:123], v[122:123]
    v_pk_mul_f32 v[220:221], v[124:125], v[124:125]
    v_pk_mul_f32 v[222:223], v[126:127], v[126:127]
    v_pk_fma_f32 v[208:209], v[208:209], s[52:53], v[60:61]
    v_pk_fma_f32 v[210:211], v[210:211], s[52:53], v[60:61]
    v_pk_fma_f32 v[212:213], v[212:213], s[52:53], v[60:61]
    v_pk_fma_f32 v[214:215], v[214:215], s[52:53], v[60:61]
    v_pk_fma_f32 v[216:217], v[216:217], s[52:53], v[60:61]
    v_pk_fma_f32 v[218:219], v[218:219], s[52:53], v[60:61]
    v_pk_fma_f32 v[220:221], v[220:221], s[52:53], v[60:61]
    v_pk_fma_f32 v[222:223], v[222:223], s[52:53], v[60:61]
    v_pk_mul_f32 v[208:209], v[208:209], v[112:113]
    v_pk_mul_f32 v[210:211], v[210:211], v[114:115]
    v_pk_mul_f32 v[212:213], v[212:213], v[116:117]
    v_pk_mul_f32 v[214:215], v[214:215], v[118:119]
    v_pk_mul_f32 v[216:217], v[216:217], v[120:121]
    v_pk_mul_f32 v[218:219], v[218:219], v[122:123]
    v_pk_mul_f32 v[220:221], v[220:221], v[124:125]
    v_pk_mul_f32 v[222:223], v[222:223], v[126:127]
    v_exp_f32 v208, v208
    v_exp_f32 v209, v209
    v_exp_f32 v210, v210
    v_exp_f32 v211, v211
    v_exp_f32 v212, v212
    v_exp_f32 v213, v213
    v_exp_f32 v214, v214
    v_exp_f32 v215, v215
    v_exp_f32 v216, v216
    v_exp_f32 v217, v217
    v_exp_f32 v218, v218
    v_exp_f32 v219, v219
    v_exp_f32 v220, v220
    v_exp_f32 v221, v221
    v_exp_f32 v222, v222
    v_exp_f32 v223, v223
    v_pk_add_f32 v[208:209], v[208:209], s[54:55]
    v_pk_add_f32 v[210:211], v[210:211], s[54:55]
    v_pk_add_f32 v[212:213], v[212:213], s[54:55]
    v_pk_add_f32 v[214:215], v[214:215], s[54:55]
    v_pk_add_f32 v[216:217], v[216:217], s[54:55]
    v_pk_add_f32 v[218:219], v[218:219], s[54:55]
    v_pk_add_f32 v[220:221], v[220:221], s[54:55]
    v_pk_add_f32 v[222:223], v[222:223], s[54:55]
    v_rcp_f32 v208, v208
    v_rcp_f32 v209, v209
    v_rcp_f32 v210, v210
    v_rcp_f32 v211, v211
    v_rcp_f32 v212, v212
    v_rcp_f32 v213, v213
    v_rcp_f32 v214, v214
    v_rcp_f32 v215, v215
    v_rcp_f32 v216, v216
    v_rcp_f32 v217, v217
    v_rcp_f32 v218, v218
    v_rcp_f32 v219, v219
    v_rcp_f32 v220, v220
    v_rcp_f32 v221, v221
    v_rcp_f32 v222, v222
    v_rcp_f32 v223, v223
    v_pk_mul_f32 v[208:209], v[208:209], v[112:113]
    v_pk_mul_f32 v[210:211], v[210:211], v[114:115]
    v_pk_mul_f32 v[212:213], v[212:213], v[116:117]
    v_pk_mul_f32 v[214:215], v[214:215], v[118:119]
    v_pk_mul_f32 v[216:217], v[216:217], v[120:121]
    v_pk_mul_f32 v[218:219], v[218:219], v[122:123]
    v_pk_mul_f32 v[220:221], v[220:221], v[124:125]
    v_pk_mul_f32 v[222:223], v[222:223], v[126:127]
    v_cvt_pk_bf16_f32 v232, v208, v209
    v_cvt_pk_bf16_f32 v233, v210, v211
    v_cvt_pk_bf16_f32 v234, v212, v213
    v_cvt_pk_bf16_f32 v235, v214, v215
    v_cvt_pk_bf16_f32 v236, v216, v217
    v_cvt_pk_bf16_f32 v237, v218, v219
    v_cvt_pk_bf16_f32 v238, v220, v221
    v_cvt_pk_bf16_f32 v239, v222, v223
    buffer_store_dwordx4 v[232:235], v2, s[28:31], s50 offen offset:2048 sc1
    buffer_store_dwordx4 v[236:239], v2, s[28:31], s50 offen offset:3072 sc1
    v_pk_mul_f32 v[128:129], v[128:129], v[56:57]
    v_pk_mul_f32 v[130:131], v[130:131], v[56:57]
    v_pk_mul_f32 v[132:133], v[132:133], v[56:57]
    v_pk_mul_f32 v[134:135], v[134:135], v[56:57]
    v_pk_mul_f32 v[136:137], v[136:137], v[56:57]
    v_pk_mul_f32 v[138:139], v[138:139], v[56:57]
    v_pk_mul_f32 v[140:141], v[140:141], v[56:57]
    v_pk_mul_f32 v[142:143], v[142:143], v[56:57]
    v_pk_mul_f32 v[192:193], v[128:129], v[128:129]
    v_pk_mul_f32 v[194:195], v[130:131], v[130:131]
    v_pk_mul_f32 v[196:197], v[132:133], v[132:133]
    v_pk_mul_f32 v[198:199], v[134:135], v[134:135]
    v_pk_mul_f32 v[200:201], v[136:137], v[136:137]
    v_pk_mul_f32 v[202:203], v[138:139], v[138:139]
    v_pk_mul_f32 v[204:205], v[140:141], v[140:141]
    v_pk_mul_f32 v[206:207], v[142:143], v[142:143]
    v_pk_fma_f32 v[192:193], v[192:193], s[52:53], v[60:61]
    v_pk_fma_f32 v[194:195], v[194:195], s[52:53], v[60:61]
    v_pk_fma_f32 v[196:197], v[196:197], s[52:53], v[60:61]
    v_pk_fma_f32 v[198:199], v[198:199], s[52:53], v[60:61]
    v_pk_fma_f32 v[200:201], v[200:201], s[52:53], v[60:61]
    v_pk_fma_f32 v[202:203], v[202:203], s[52:53], v[60:61]
    v_pk_fma_f32 v[204:205], v[204:205], s[52:53], v[60:61]
    v_pk_fma_f32 v[206:207], v[206:207], s[52:53], v[60:61]
    v_pk_mul_f32 v[192:193], v[192:193], v[128:129]
    v_pk_mul_f32 v[194:195], v[194:195], v[130:131]
    v_pk_mul_f32 v[196:197], v[196:197], v[132:133]
    v_pk_mul_f32 v[198:199], v[198:199], v[134:135]
    v_pk_mul_f32 v[200:201], v[200:201], v[136:137]
    v_pk_mul_f32 v[202:203], v[202:203], v[138:139]
    v_pk_mul_f32 v[204:205], v[204:205], v[140:141]
    v_pk_mul_f32 v[206:207], v[206:207], v[142:143]
    v_exp_f32 v192, v192
    v_exp_f32 v193, v193
    v_exp_f32 v194, v194
    v_exp_f32 v195, v195
    v_exp_f32 v196, v196
    v_exp_f32 v197, v197
    v_exp_f32 v198, v198
    v_exp_f32 v199, v199
    v_exp_f32 v200, v200
    v_exp_f32 v201, v201
    v_exp_f32 v202, v202
    v_exp_f32 v203, v203
    v_exp_f32 v204, v204
    v_exp_f32 v205, v205
    v_exp_f32 v206, v206
    v_exp_f32 v207, v207
    v_pk_add_f32 v[192:193], v[192:193], s[54:55]
    v_pk_add_f32 v[194:195], v[194:195], s[54:55]
    v_pk_add_f32 v[196:197], v[196:197], s[54:55]
    v_pk_add_f32 v[198:199], v[198:199], s[54:55]
    v_pk_add_f32 v[200:201], v[200:201], s[54:55]
    v_pk_add_f32 v[202:203], v[202:203], s[54:55]
    v_pk_add_f32 v[204:205], v[204:205], s[54:55]
    v_pk_add_f32 v[206:207], v[206:207], s[54:55]
    v_rcp_f32 v192, v192
    v_rcp_f32 v193, v193
    v_rcp_f32 v194, v194
    v_rcp_f32 v195, v195
    v_rcp_f32 v196, v196
    v_rcp_f32 v197, v197
    v_rcp_f32 v198, v198
    v_rcp_f32 v199, v199
    v_rcp_f32 v200, v200
    v_rcp_f32 v201, v201
    v_rcp_f32 v202, v202
    v_rcp_f32 v203, v203
    v_rcp_f32 v204, v204
    v_rcp_f32 v205, v205
    v_rcp_f32 v206, v206
    v_rcp_f32 v207, v207
    v_pk_mul_f32 v[192:193], v[192:193], v[128:129]
    v_pk_mul_f32 v[194:195], v[194:195], v[130:131]
    v_pk_mul_f32 v[196:197], v[196:197], v[132:133]
    v_pk_mul_f32 v[198:199], v[198:199], v[134:135]
    v_pk_mul_f32 v[200:201], v[200:201], v[136:137]
    v_pk_mul_f32 v[202:203], v[202:203], v[138:139]
    v_pk_mul_f32 v[204:205], v[204:205], v[140:141]
    v_pk_mul_f32 v[206:207], v[206:207], v[142:143]
    v_cvt_pk_bf16_f32 v224, v192, v193
    v_cvt_pk_bf16_f32 v225, v194, v195
    v_cvt_pk_bf16_f32 v226, v196, v197
    v_cvt_pk_bf16_f32 v227, v198, v199
    v_cvt_pk_bf16_f32 v228, v200, v201
    v_cvt_pk_bf16_f32 v229, v202, v203
    v_cvt_pk_bf16_f32 v230, v204, v205
    v_cvt_pk_bf16_f32 v231, v206, v207
    buffer_store_dwordx4 v[224:227], v14, s[28:31], s48 offen offset:0 sc1
    buffer_store_dwordx4 v[228:231], v14, s[28:31], s48 offen offset:1024 sc1
    v_pk_mul_f32 v[144:145], v[144:145], v[58:59]
    v_pk_mul_f32 v[146:147], v[146:147], v[58:59]
    v_pk_mul_f32 v[148:149], v[148:149], v[58:59]
    v_pk_mul_f32 v[150:151], v[150:151], v[58:59]
    v_pk_mul_f32 v[152:153], v[152:153], v[58:59]
    v_pk_mul_f32 v[154:155], v[154:155], v[58:59]
    v_pk_mul_f32 v[156:157], v[156:157], v[58:59]
    v_pk_mul_f32 v[158:159], v[158:159], v[58:59]
    v_pk_mul_f32 v[208:209], v[144:145], v[144:145]
    v_pk_mul_f32 v[210:211], v[146:147], v[146:147]
    v_pk_mul_f32 v[212:213], v[148:149], v[148:149]
    v_pk_mul_f32 v[214:215], v[150:151], v[150:151]
    v_pk_mul_f32 v[216:217], v[152:153], v[152:153]
    v_pk_mul_f32 v[218:219], v[154:155], v[154:155]
    v_pk_mul_f32 v[220:221], v[156:157], v[156:157]
    v_pk_mul_f32 v[222:223], v[158:159], v[158:159]
    v_pk_fma_f32 v[208:209], v[208:209], s[52:53], v[60:61]
    v_pk_fma_f32 v[210:211], v[210:211], s[52:53], v[60:61]
    v_pk_fma_f32 v[212:213], v[212:213], s[52:53], v[60:61]
    v_pk_fma_f32 v[214:215], v[214:215], s[52:53], v[60:61]
    v_pk_fma_f32 v[216:217], v[216:217], s[52:53], v[60:61]
    v_pk_fma_f32 v[218:219], v[218:219], s[52:53], v[60:61]
    v_pk_fma_f32 v[220:221], v[220:221], s[52:53], v[60:61]
    v_pk_fma_f32 v[222:223], v[222:223], s[52:53], v[60:61]
    v_pk_mul_f32 v[208:209], v[208:209], v[144:145]
    v_pk_mul_f32 v[210:211], v[210:211], v[146:147]
    v_pk_mul_f32 v[212:213], v[212:213], v[148:149]
    v_pk_mul_f32 v[214:215], v[214:215], v[150:151]
    v_pk_mul_f32 v[216:217], v[216:217], v[152:153]
    v_pk_mul_f32 v[218:219], v[218:219], v[154:155]
    v_pk_mul_f32 v[220:221], v[220:221], v[156:157]
    v_pk_mul_f32 v[222:223], v[222:223], v[158:159]
    v_exp_f32 v208, v208
    v_exp_f32 v209, v209
    v_exp_f32 v210, v210
    v_exp_f32 v211, v211
    v_exp_f32 v212, v212
    v_exp_f32 v213, v213
    v_exp_f32 v214, v214
    v_exp_f32 v215, v215
    v_exp_f32 v216, v216
    v_exp_f32 v217, v217
    v_exp_f32 v218, v218
    v_exp_f32 v219, v219
    v_exp_f32 v220, v220
    v_exp_f32 v221, v221
    v_exp_f32 v222, v222
    v_exp_f32 v223, v223
    v_pk_add_f32 v[208:209], v[208:209], s[54:55]
    v_pk_add_f32 v[210:211], v[210:211], s[54:55]
    v_pk_add_f32 v[212:213], v[212:213], s[54:55]
    v_pk_add_f32 v[214:215], v[214:215], s[54:55]
    v_pk_add_f32 v[216:217], v[216:217], s[54:55]
    v_pk_add_f32 v[218:219], v[218:219], s[54:55]
    v_pk_add_f32 v[220:221], v[220:221], s[54:55]
    v_pk_add_f32 v[222:223], v[222:223], s[54:55]
    v_rcp_f32 v208, v208
    v_rcp_f32 v209, v209
    v_rcp_f32 v210, v210
    v_rcp_f32 v211, v211
    v_rcp_f32 v212, v212
    v_rcp_f32 v213, v213
    v_rcp_f32 v214, v214
    v_rcp_f32 v215, v215
    v_rcp_f32 v216, v216
    v_rcp_f32 v217, v217
    v_rcp_f32 v218, v218
    v_rcp_f32 v219, v219
    v_rcp_f32 v220, v220
    v_rcp_f32 v221, v221
    v_rcp_f32 v222, v222
    v_rcp_f32 v223, v223
    v_pk_mul_f32 v[208:209], v[208:209], v[144:145]
    v_pk_mul_f32 v[210:211], v[210:211], v[146:147]
    v_pk_mul_f32 v[212:213], v[212:213], v[148:149]
    v_pk_mul_f32 v[214:215], v[214:215], v[150:151]
    v_pk_mul_f32 v[216:217], v[216:217], v[152:153]
    v_pk_mul_f32 v[218:219], v[218:219], v[154:155]
    v_pk_mul_f32 v[220:221], v[220:221], v[156:157]
    v_pk_mul_f32 v[222:223], v[222:223], v[158:159]
    v_cvt_pk_bf16_f32 v232, v208, v209
    v_cvt_pk_bf16_f32 v233, v210, v211
    v_cvt_pk_bf16_f32 v234, v212, v213
    v_cvt_pk_bf16_f32 v235, v214, v215
    v_cvt_pk_bf16_f32 v236, v216, v217
    v_cvt_pk_bf16_f32 v237, v218, v219
    v_cvt_pk_bf16_f32 v238, v220, v221
    v_cvt_pk_bf16_f32 v239, v222, v223
    buffer_store_dwordx4 v[232:235], v14, s[28:31], s50 offen offset:0 sc1
    buffer_store_dwordx4 v[236:239], v14, s[28:31], s50 offen offset:1024 sc1
    s_branch .g2_entry
.g1_qkv:
    s_mov_b32 s20, s4
    s_mov_b32 s21, s5
    s_mov_b32 s22, 6291456
    s_mov_b32 s23, 0x20000
    s_mov_b32 s32, s6
    s_mov_b32 s33, s7
    s_mov_b32 s34, 65536
    s_mov_b32 s35, 0x20000
    s_mov_b32 s38, 196608
    s_mul_i32 s37, s36, 3072
    s_mov_b32 s42, 0xf0ffffff
    s_mov_b32 s43, 0x000fffff
    s_lshl_b32 s44, s18, 7
    v_mul_u32_u24 v3, 6144, v10
    v_lshrrev_b32 v12, 3, v11
    v_lshl_add_u32 v3, v12, 11, v3
    v_and_b32 v12, 7, v11
    v_lshl_add_u32 v3, v12, 4, v3
    v_add_u32 v3, s44, v3
    v_add_u32 v4, 11392, v3
    s_lshl_b32 s45, s16, 6
    v_add_u32 v6, s45, v6
    s_lshl_b32 s53, s18, 1
    s_add_u32 s53, s53, s16
    s_cmp_lt_u32 s15, 2
    s_cbranch_scc0 .g1_nophi
    s_lshl_b32 s44, s53, 11
    s_lshl_b32 s45, s15, 10
    s_add_u32 s44, s44, s45
    s_lshl_b32 s54, s16, 11
    s_add_u32 s45, s45, s54
    s_add_u32 m0, s45, 153600
    s_nop 0
    buffer_load_dwordx4 v2, s[32:35], s44 offen lds
.g1_nophi:
    s_mov_b32 s49, 30720
    s_mov_b32 s12, s39
    s_add_u32 s13, s39, 153600
    s_mov_b32 m0, s39
    s_mov_b64 exec, s[42:43]
    buffer_load_dwordx4 v3, s[20:23], s37 offen lds
    s_mov_b64 exec, -1
    v_mov_b32 v64, 0
    v_mov_b32 v65, 0
    v_mov_b32 v66, 0
    v_mov_b32 v67, 0
    v_mov_b32 v68, 0
    v_mov_b32 v69, 0
    s_mov_b64 exec, s[42:43]
    buffer_load_dwordx4 v4, s[20:23], s37 offen offset:896 lds
    s_mov_b64 exec, -1
    s_add_u32 m0, s39, 1792
    s_add_u32 s37, s37, s38
    v_mov_b32 v70, 0
    v_mov_b32 v71, 0
    v_mov_b32 v72, 0
    v_mov_b32 v73, 0
    v_mov_b32 v74, 0
    v_mov_b32 v75, 0
    buffer_load_dwordx4 v244, s[24:27], s36 offen lds
    s_add_u32 s39, s39, 30720
    s_cmp_eq_u32 s39, s13
    s_cselect_b32 s39, s12, s39
    v_mov_b32 v76, 0
    v_mov_b32 v77, 0
    v_mov_b32 v78, 0
    v_mov_b32 v79, 0
    v_mov_b32 v80, 0
    v_mov_b32 v81, 0
    buffer_load_dwordx4 v245, s[24:27], s36 offen offset:1024 lds
    s_add_u32 s36, s36, 64
    s_cmp_eq_u32 s36, s59
    s_cselect_b32 s36, s78, s36
    s_cselect_b32 s37, s79, s37
    s_cmp_eq_u32 s36, 2048
    s_cselect_b32 s36, 0x100000, s36
    s_cselect_b32 s37, 0x10000000, s37
    v_mov_b32 v82, 0
    v_mov_b32 v83, 0
    v_mov_b32 v84, 0
    v_mov_b32 v85, 0
    v_mov_b32 v86, 0
    v_mov_b32 v87, 0
    s_mov_b32 m0, s39
    s_mov_b64 exec, s[42:43]
    buffer_load_dwordx4 v3, s[20:23], s37 offen lds
    s_mov_b64 exec, -1
    v_mov_b32 v88, 0
    v_mov_b32 v89, 0
    v_mov_b32 v90, 0
    v_mov_b32 v91, 0
    v_mov_b32 v92, 0
    v_mov_b32 v93, 0
    s_mov_b64 exec, s[42:43]
    buffer_load_dwordx4 v4, s[20:23], s37 offen offset:896 lds
    s_mov_b64 exec, -1
    s_add_u32 m0, s39, 1792
    s_add_u32 s37, s37, s38
    v_mov_b32 v94, 0
    v_mov_b32 v95, 0
    v_mov_b32 v96, 0
    v_mov_b32 v97, 0
    v_mov_b32 v98, 0
    v_mov_b32 v99, 0
    buffer_load_dwordx4 v244, s[24:27], s36 offen lds
    s_add_u32 s39, s39, 30720
    s_cmp_eq_u32 s39, s13
    s_cselect_b32 s39, s12, s39
    v_mov_b32 v100, 0
    v_mov_b32 v101, 0
    v_mov_b32 v102, 0
    v_mov_b32 v103, 0
    v_mov_b32 v104, 0
    v_mov_b32 v105, 0
    buffer_load_dwordx4 v245, s[24:27], s36 offen offset:1024 lds
    s_add_u32 s36, s36, 64
    s_cmp_eq_u32 s36, s59
    s_cselect_b32 s36, s78, s36
    s_cselect_b32 s37, s79, s37
    s_cmp_eq_u32 s36, 2048
    s_cselect_b32 s36, 0x100000, s36
    s_cselect_b32 s37, 0x10000000, s37
    v_mov_b32 v106, 0
    v_mov_b32 v107, 0
    v_mov_b32 v108, 0
    v_mov_b32 v109, 0
    v_mov_b32 v110, 0
    v_mov_b32 v111, 0
    s_mov_b32 m0, s39
    s_mov_b64 exec, s[42:43]
    buffer_load_dwordx4 v3, s[20:23], s37 offen lds
    s_mov_b64 exec, -1
    v_mov_b32 v112, 0
    v_mov_b32 v113, 0
    v_mov_b32 v114, 0
    v_mov_b32 v115, 0
    v_mov_b32 v116, 0
    v_mov_b32 v117, 0
    s_mov_b64 exec, s[42:43]
    buffer_load_dwordx4 v4, s[20:23], s37 offen offset:896 lds
    s_mov_b64 exec, -1
    s_add_u32 m0, s39, 1792
    s_add_u32 s37, s37, s38
    v_mov_b32 v118, 0
    v_mov_b32 v119, 0
    v_mov_b32 v120, 0
    v_mov_b32 v121, 0
    v_mov_b32 v122, 0
    v_mov_b32 v123, 0
    buffer_load_dwordx4 v244, s[24:27], s36 offen lds
    s_add_u32 s39, s39, 30720
    s_cmp_eq_u32 s39, s13
    s_cselect_b32 s39, s12, s39
    v_mov_b32 v124, 0
    v_mov_b32 v125, 0
    v_mov_b32 v126, 0
    v_mov_b32 v127, 0
    v_mov_b32 v128, 0
    v_mov_b32 v129, 0
    buffer_load_dwordx4 v245, s[24:27], s36 offen offset:1024 lds
    s_add_u32 s36, s36, 64
    s_cmp_eq_u32 s36, s59
    s_cselect_b32 s36, s78, s36
    s_cselect_b32 s37, s79, s37
    s_cmp_eq_u32 s36, 2048
    s_cselect_b32 s36, 0x100000, s36
    s_cselect_b32 s37, 0x10000000, s37
    v_mov_b32 v130, 0
    v_mov_b32 v131, 0
    v_mov_b32 v132, 0
    v_mov_b32 v133, 0
    v_mov_b32 v134, 0
    v_mov_b32 v135, 0
    s_mov_b32 m0, s39
    s_mov_b64 exec, s[42:43]
    buffer_load_dwordx4 v3, s[20:23], s37 offen lds
    s_mov_b64 exec, -1
    v_mov_b32 v136, 0
    v_mov_b32 v137, 0
    v_mov_b32 v138, 0
    v_mov_b32 v139, 0
    v_mov_b32 v140, 0
    v_mov_b32 v141, 0
    s_mov_b64 exec, s[42:43]
    buffer_load_dwordx4 v4, s[20:23], s37 offen offset:896 lds
    s_mov_b64 exec, -1
    s_add_u32 m0, s39, 1792
    s_add_u32 s37, s37, s38
    v_mov_b32 v142, 0
    v_mov_b32 v143, 0
    v_mov_b32 v144, 0
    v_mov_b32 v145, 0
    v_mov_b32 v146, 0
    v_mov_b32 v147, 0
    buffer_load_dwordx4 v244, s[24:27], s36 offen lds
    s_add_u32 s39, s39, 30720
    s_cmp_eq_u32 s39, s13
    s_cselect_b32 s39, s12, s39
    v_mov_b32 v148, 0
    v_mov_b32 v149, 0
    v_mov_b32 v150, 0
    v_mov_b32 v151, 0
    v_mov_b32 v152, 0
    v_mov_b32 v153, 0
    buffer_load_dwordx4 v245, s[24:27], s36 offen offset:1024 lds
    s_add_u32 s36, s36, 64
    s_cmp_eq_u32 s36, s59
    s_cselect_b32 s36, s78, s36
    s_cselect_b32 s37, s79, s37
    s_cmp_eq_u32 s36, 2048
    s_cselect_b32 s36, 0x100000, s36
    s_cselect_b32 s37, 0x10000000, s37
    v_mov_b32 v154, 0
    v_mov_b32 v155, 0
    v_mov_b32 v156, 0
    v_mov_b32 v157, 0
    v_mov_b32 v158, 0
    v_mov_b32 v159, 0
    s_waitcnt vmcnt(16)
    v_lshlrev_b32 v200, 16, v192
    v_and_b32 v201, s47, v192
    v_lshlrev_b32 v202, 16, v193
    v_and_b32 v203, s47, v193
    v_lshlrev_b32 v204, 16, v194
    v_and_b32 v205, s47, v194
    v_lshlrev_b32 v206, 16, v195
    v_and_b32 v207, s47, v195
    v_lshlrev_b32 v208, 16, v196
    v_and_b32 v209, s47, v196
    v_lshlrev_b32 v210, 16, v197
    v_and_b32 v211, s47, v197
    v_lshlrev_b32 v212, 16, v198
    v_and_b32 v213, s47, v198
    v_lshlrev_b32 v214, 16, v199
    v_and_b32 v215, s47, v199
    v_add_f32 v216, v200, v201
    v_add_f32 v220, v202, v203
    v_add_f32 v217, v204, v205
    v_add_f32 v221, v206, v207
    v_add_f32 v218, v208, v209
    v_add_f32 v222, v210, v211
    v_add_f32 v219, v212, v213
    v_add_f32 v223, v214, v215
    v_add_f32 v216, v216, v220
    v_add_f32 v217, v217, v221
    v_add_f32 v218, v218, v222
    v_add_f32 v219, v219, v223
    v_add_f32 v216, v216, v217
    v_add_f32 v218, v218, v219
    v_add_f32 v216, v216, v218
    s_nop 1
    v_add_f32_dpp v216, v216, v216 row_ror:8 row_mask:0xf bank_mask:0xf
    s_nop 1
    v_add_f32_dpp v216, v216, v216 row_ror:4 row_mask:0xf bank_mask:0xf
    s_nop 1
    v_add_f32_dpp v216, v216, v216 row_ror:2 row_mask:0xf bank_mask:0xf
    s_nop 1
    v_add_f32_dpp v216, v216, v216 row_ror:1 row_mask:0xf bank_mask:0xf
    v_mov_b32 v217, v216
    s_nop 1
    v_permlane16_swap_b32 v216, v217
    v_add_f32 v216, v216, v217
    v_mov_b32 v217, v216
    s_nop 1
    v_permlane32_swap_b32 v216, v217
    v_add_f32 v216, v216, v217
    v_mul_f32 v216, 0x3a800000, v216
    v_sub_f32 v200, v200, v216
    v_sub_f32 v201, v201, v216
    v_sub_f32 v202, v202, v216
    v_sub_f32 v203, v203, v216
    v_sub_f32 v204, v204, v216
    v_sub_f32 v205, v205, v216
    v_sub_f32 v206, v206, v216
    v_sub_f32 v207, v207, v216
    v_sub_f32 v208, v208, v216
    v_sub_f32 v209, v209, v216
    v_sub_f32 v210, v210, v216
    v_sub_f32 v211, v211, v216
    v_sub_f32 v212, v212, v216
    v_sub_f32 v213, v213, v216
    v_sub_f32 v214, v214, v216
    v_sub_f32 v215, v215, v216
    v_mul_f32 v220, v200, v200
    v_mul_f32 v221, v201, v201
    v_mul_f32 v222, v202, v202
    v_mul_f32 v223, v203, v203
    v_fmac_f32 v220, v204, v204
    v_fmac_f32 v221, v205, v205
    v_fmac_f32 v222, v206, v206
    v_fmac_f32 v223, v207, v207
    v_fmac_f32 v220, v208, v208
    v_fmac_f32 v221, v209, v209
    v_fmac_f32 v222, v210, v210
    v_fmac_f32 v223, v211, v211
    v_fmac_f32 v220, v212, v212
    v_fmac_f32 v221, v213, v213
    v_fmac_f32 v222, v214, v214
    v_fmac_f32 v223, v215, v215
    v_add_f32 v220, v220, v221
    v_add_f32 v222, v222, v223
    v_add_f32 v217, v220, v222
    s_nop 1
    v_add_f32_dpp v217, v217, v217 row_ror:8 row_mask:0xf bank_mask:0xf
    s_nop 1
    v_add_f32_dpp v217, v217, v217 row_ror:4 row_mask:0xf bank_mask:0xf
    s_nop 1
    v_add_f32_dpp v217, v217, v217 row_ror:2 row_mask:0xf bank_mask:0xf
    s_nop 1
    v_add_f32_dpp v217, v217, v217 row_ror:1 row_mask:0xf bank_mask:0xf
    v_mov_b32 v218, v217
    s_nop 1
    v_permlane16_swap_b32 v217, v218
    v_add_f32 v217, v217, v218
    v_mov_b32 v218, v217
    s_nop 1
    v_permlane32_swap_b32 v217, v218
    v_add_f32 v217, v217, v218
    v_mul_f32 v217, 0x3a800000, v217
    v_cvt_pk_bf16_f32 v217, v217, v217
    v_lshlrev_b32 v217, 16, v217
    v_add_f32 v217, 0x3727c5ac, v217
    v_sub_f32 v216, 0, v216
    v_cvt_pk_bf16_f32 v217, v217, v217
    v_lshlrev_b32 v217, 16, v217
    v_sqrt_f32 v217, v217
    s_lshl_b32 s57, s57, 3
    s_add_u32 s57, s57, 29360128
    v_cvt_pk_bf16_f32 v216, v216, v217
    v_and_b32 v217, s47, v216
    s_lshl_b32 s36, s17, 8
    s_lshr_b32 s44, s38, 6
    s_mul_i32 s37, s36, s44
    s_add_u32 s59, s36, 256
    s_cmp_le_u32 s17, 1
    s_cselect_b32 s78, 2, 1
    s_lshl_b32 s78, s78, 8
    s_mul_i32 s79, s78, s44
    v_rcp_f32 v217, v217
    s_mov_b64 exec, 1
    buffer_store_dwordx2 v[216:217], v254, s[28:31], s57 offen sc1
    s_mov_b64 exec, -1
    v_lshl_add_u32 v12, v7, 2, v8
    v_lshl_add_u32 v13, v12, 6, v9
    s_lshl_b32 s44, s16, 11
    s_add_u32 s44, s44, 153600
    v_add_u32 v13, s44, v13
    s_waitcnt vmcnt(13)
    s_barrier
    ds_read_b64_tr_b16 v[160:161], v13 offset:0
    ds_read_b64_tr_b16 v[162:163], v13 offset:512
    ds_read_b64_tr_b16 v[164:165], v13 offset:1024
    ds_read_b64_tr_b16 v[166:167], v13 offset:1536
    s_cmp_eq_u32 s16, 0
    s_cbranch_scc0 .g1_q1
    ds_read_b128 v[16:19], v5 offset:1792
    ds_read_b64_tr_b16 v[24:25], v6 offset:0
    ds_read_b64_tr_b16 v[26:27], v6 offset:3840
    ds_read_b128 v[20:23], v5 offset:5632
    ds_read_b64_tr_b16 v[28:29], v6 offset:128
    ds_read_b64_tr_b16 v[30:31], v6 offset:3968
    ds_read_b64_tr_b16 v[32:33], v6 offset:256
    ds_read_b64_tr_b16 v[34:35], v6 offset:4096
    s_mov_b32 m0, s39
    s_mov_b64 exec, s[42:43]
    buffer_load_dwordx4 v3, s[20:23], s37 offen lds
    s_mov_b64 exec, -1
    s_mov_b64 exec, s[42:43]
    buffer_load_dwordx4 v4, s[20:23], s37 offen offset:896 lds
    s_mov_b64 exec, -1
    s_add_u32 m0, s39, 1792
    s_add_u32 s37, s37, s38
    buffer_load_dwordx4 v244, s[24:27], s36 offen lds
    s_add_u32 s39, s39, 30720
    s_cmp_eq_u32 s39, s13
    s_cselect_b32 s39, s12, s39
    buffer_load_dwordx4 v245, s[24:27], s36 offen offset:1024 lds
    s_add_u32 s36, s36, 64
    s_cmp_eq_u32 s36, s59
    s_cselect_b32 s36, s78, s36
    s_cselect_b32 s37, s79, s37
    s_cmp_eq_u32 s36, 2048
    s_cselect_b32 s36, 0x100000, s36
    s_cselect_b32 s37, 0x10000000, s37
    s_branch .g1_loopq
.g1_loopqd0:
    s_waitcnt lgkmcnt(0)
    v_mfma_f32_32x32x16_bf16 v[64:79], v[24:27], v[16:19], v[64:79]
    ds_read_b128 v[40:43], v243 offset:1792
    ds_read_b64_tr_b16 v[48:49], v6 offset:15360
    v_mfma_f32_32x32x16_bf16 v[80:95], v[24:27], v[20:23], v[80:95]
    ds_read_b64_tr_b16 v[50:51], v6 offset:19200
    ds_read_b128 v[44:47], v243 offset:5632
    v_mfma_f32_32x32x16_bf16 v[96:111], v[28:31], v[16:19], v[96:111]
    ds_read_b64_tr_b16 v[52:53], v6 offset:15488
    ds_read_b64_tr_b16 v[54:55], v6 offset:19328
    v_dot2c_f32_bf16 v248, s56, v24
    v_mfma_f32_32x32x16_bf16 v[112:127], v[28:31], v[20:23], v[112:127]
    ds_read_b64_tr_b16 v[56:57], v6 offset:15616
    ds_read_b64_tr_b16 v[58:59], v6 offset:19456
    v_dot2c_f32_bf16 v248, s56, v25
    v_mfma_f32_32x32x16_bf16 v[128:143], v[16:19], v[32:35], v[128:143]
    s_add_u32 s46, s46, 1
    s_cmp_eq_u32 s46, 5
    s_cselect_b32 s41, -122880, s49
    s_cselect_b32 s46, 0, s46
    v_add_u32 v5, s41, v5
    v_add_u32 v6, s41, v6
    v_add_u32 v243, s41, v243
    v_dot2c_f32_bf16 v248, s56, v26
    v_mfma_f32_32x32x16_bf16 v[144:159], v[20:23], v[32:35], v[144:159]
    v_dot2c_f32_bf16 v248, s56, v27
    s_sub_u32 s40, s40, 1
    s_waitcnt vmcnt(12) lgkmcnt(0)
    s_barrier
    v_mfma_f32_32x32x16_bf16 v[64:79], v[48:51], v[40:43], v[64:79]
    ds_read_b128 v[16:19], v5 offset:1792
    ds_read_b64_tr_b16 v[24:25], v6 offset:0
    v_mfma_f32_32x32x16_bf16 v[80:95], v[48:51], v[44:47], v[80:95]
    ds_read_b64_tr_b16 v[26:27], v6 offset:3840
    ds_read_b128 v[20:23], v5 offset:5632
    v_mfma_f32_32x32x16_bf16 v[96:111], v[52:55], v[40:43], v[96:111]
    ds_read_b64_tr_b16 v[28:29], v6 offset:128
    ds_read_b64_tr_b16 v[30:31], v6 offset:3968
    s_mov_b32 m0, s39
    s_mov_b64 exec, s[42:43]
    buffer_load_dwordx4 v3, s[20:23], s37 offen lds
    s_mov_b64 exec, -1
    v_dot2c_f32_bf16 v248, s56, v48
    v_mfma_f32_32x32x16_bf16 v[112:127], v[52:55], v[44:47], v[112:127]
    ds_read_b64_tr_b16 v[32:33], v6 offset:256
    ds_read_b64_tr_b16 v[34:35], v6 offset:4096
    s_mov_b64 exec, s[42:43]
    buffer_load_dwordx4 v4, s[20:23], s37 offen offset:896 lds
    s_mov_b64 exec, -1
    s_add_u32 m0, s39, 1792
    s_add_u32 s37, s37, s38
    v_dot2c_f32_bf16 v248, s56, v49
    v_mfma_f32_32x32x16_bf16 v[128:143], v[40:43], v[56:59], v[128:143]
    buffer_load_dwordx4 v244, s[24:27], s36 offen lds
    s_add_u32 s39, s39, 30720
    s_cmp_eq_u32 s39, s13
    s_cselect_b32 s39, s12, s39
    v_dot2c_f32_bf16 v248, s56, v50
    v_mfma_f32_32x32x16_bf16 v[144:159], v[44:47], v[56:59], v[144:159]
    buffer_load_dwordx4 v245, s[24:27], s36 offen offset:1024 lds
    s_add_u32 s36, s36, 64
    s_cmp_eq_u32 s36, s59
    s_cselect_b32 s36, s78, s36
    s_cselect_b32 s37, s79, s37
    s_cmp_eq_u32 s36, 2048
    s_cselect_b32 s36, 0x100000, s36
    s_cselect_b32 s37, 0x10000000, s37
    v_dot2c_f32_bf16 v248, s56, v51
    s_cmp_lg_u32 s40, 0
    s_cbranch_scc1 .g1_loopqd0
    s_branch .g1_pubq
.g1_loopqd1:
    s_waitcnt lgkmcnt(0)
    v_mfma_f32_32x32x16_bf16 v[64:79], v[24:27], v[16:19], v[64:79]
    ds_read_b128 v[40:43], v243 offset:1792
    ds_read_b64_tr_b16 v[48:49], v6 offset:15360
    v_mfma_f32_32x32x16_bf16 v[80:95], v[24:27], v[20:23], v[80:95]
    ds_read_b64_tr_b16 v[50:51], v6 offset:19200
    ds_read_b128 v[44:47], v243 offset:5632
    v_mfma_f32_32x32x16_bf16 v[96:111], v[28:31], v[16:19], v[96:111]
    ds_read_b64_tr_b16 v[52:53], v6 offset:15488
    ds_read_b64_tr_b16 v[54:55], v6 offset:19328
    v_dot2c_f32_bf16 v248, s56, v28
    v_mfma_f32_32x32x16_bf16 v[112:127], v[28:31], v[20:23], v[112:127]
    ds_read_b64_tr_b16 v[56:57], v6 offset:15616
    ds_read_b64_tr_b16 v[58:59], v6 offset:19456
    v_dot2c_f32_bf16 v248, s56, v29
    v_mfma_f32_32x32x16_bf16 v[128:143], v[16:19], v[32:35], v[128:143]
    s_add_u32 s46, s46, 1
    s_cmp_eq_u32 s46, 5
    s_cselect_b32 s41, -122880, s49
    s_cselect_b32 s46, 0, s46
    v_add_u32 v5, s41, v5
    v_add_u32 v6, s41, v6
    v_add_u32 v243, s41, v243
    v_dot2c_f32_bf16 v248, s56, v30
    v_mfma_f32_32x32x16_bf16 v[144:159], v[20:23], v[32:35], v[144:159]
    v_dot2c_f32_bf16 v248, s56, v31
    s_sub_u32 s40, s40, 1
    s_waitcnt vmcnt(12) lgkmcnt(0)
    s_barrier
    v_mfma_f32_32x32x16_bf16 v[64:79], v[48:51], v[40:43], v[64:79]
    ds_read_b128 v[16:19], v5 offset:1792
    ds_read_b64_tr_b16 v[24:25], v6 offset:0
    v_mfma_f32_32x32x16_bf16 v[80:95], v[48:51], v[44:47], v[80:95]
    ds_read_b64_tr_b16 v[26:27], v6 offset:3840
    ds_read_b128 v[20:23], v5 offset:5632
    v_mfma_f32_32x32x16_bf16 v[96:111], v[52:55], v[40:43], v[96:111]
    ds_read_b64_tr_b16 v[28:29], v6 offset:128
    ds_read_b64_tr_b16 v[30:31], v6 offset:3968
    s_mov_b32 m0, s39
    s_mov_b64 exec, s[42:43]
    buffer_load_dwordx4 v3, s[20:23], s37 offen lds
    s_mov_b64 exec, -1
    v_dot2c_f32_bf16 v248, s56, v52
    v_mfma_f32_32x32x16_bf16 v[112:127], v[52:55], v[44:47], v[112:127]
    ds_read_b64_tr_b16 v[32:33], v6 offset:256
    ds_read_b64_tr_b16 v[34:35], v6 offset:4096
    s_mov_b64 exec, s[42:43]
    buffer_load_dwordx4 v4, s[20:23], s37 offen offset:896 lds
    s_mov_b64 exec, -1
    s_add_u32 m0, s39, 1792
    s_add_u32 s37, s37, s38
    v_dot2c_f32_bf16 v248, s56, v53
    v_mfma_f32_32x32x16_bf16 v[128:143], v[40:43], v[56:59], v[128:143]
    buffer_load_dwordx4 v244, s[24:27], s36 offen lds
    s_add_u32 s39, s39, 30720
    s_cmp_eq_u32 s39, s13
    s_cselect_b32 s39, s12, s39
    v_dot2c_f32_bf16 v248, s56, v54
    v_mfma_f32_32x32x16_bf16 v[144:159], v[44:47], v[56:59], v[144:159]
    buffer_load_dwordx4 v245, s[24:27], s36 offen offset:1024 lds
    s_add_u32 s36, s36, 64
    s_cmp_eq_u32 s36, s59
    s_cselect_b32 s36, s78, s36
    s_cselect_b32 s37, s79, s37
    s_cmp_eq_u32 s36, 2048
    s_cselect_b32 s36, 0x100000, s36
    s_cselect_b32 s37, 0x10000000, s37
    v_dot2c_f32_bf16 v248, s56, v55
    s_cmp_lg_u32 s40, 0
    s_cbranch_scc1 .g1_loopqd1
    s_branch .g1_pubq
.g1_loopqd2:
    s_waitcnt lgkmcnt(0)
    v_mfma_f32_32x32x16_bf16 v[64:79], v[24:27], v[16:19], v[64:79]
    ds_read_b128 v[40:43], v243 offset:1792
    ds_read_b64_tr_b16 v[48:49], v6 offset:15360
    v_mfma_f32_32x32x16_bf16 v[80:95], v[24:27], v[20:23], v[80:95]
    ds_read_b64_tr_b16 v[50:51], v6 offset:19200
    ds_read_b128 v[44:47], v243 offset:5632
    v_mfma_f32_32x32x16_bf16 v[96:111], v[28:31], v[16:19], v[96:111]
    ds_read_b64_tr_b16 v[52:53], v6 offset:15488
    ds_read_b64_tr_b16 v[54:55], v6 offset:19328
    v_dot2c_f32_bf16 v248, s56, v32
    v_mfma_f32_32x32x16_bf16 v[112:127], v[28:31], v[20:23], v[112:127]
    ds_read_b64_tr_b16 v[56:57], v6 offset:15616
    ds_read_b64_tr_b16 v[58:59], v6 offset:19456
    v_dot2c_f32_bf16 v248, s56, v33
    v_mfma_f32_32x32x16_bf16 v[128:143], v[16:19], v[32:35], v[128:143]
    s_add_u32 s46, s46, 1
    s_cmp_eq_u32 s46, 5
    s_cselect_b32 s41, -122880, s49
    s_cselect_b32 s46, 0, s46
    v_add_u32 v5, s41, v5
    v_add_u32 v6, s41, v6
    v_add_u32 v243, s41, v243
    v_dot2c_f32_bf16 v248, s56, v34
    v_mfma_f32_32x32x16_bf16 v[144:159], v[20:23], v[32:35], v[144:159]
    v_dot2c_f32_bf16 v248, s56, v35
    s_sub_u32 s40, s40, 1
    s_waitcnt vmcnt(12) lgkmcnt(0)
    s_barrier
    v_mfma_f32_32x32x16_bf16 v[64:79], v[48:51], v[40:43], v[64:79]
    ds_read_b128 v[16:19], v5 offset:1792
    ds_read_b64_tr_b16 v[24:25], v6 offset:0
    v_mfma_f32_32x32x16_bf16 v[80:95], v[48:51], v[44:47], v[80:95]
    ds_read_b64_tr_b16 v[26:27], v6 offset:3840
    ds_read_b128 v[20:23], v5 offset:5632
    v_mfma_f32_32x32x16_bf16 v[96:111], v[52:55], v[40:43], v[96:111]
    ds_read_b64_tr_b16 v[28:29], v6 offset:128
    ds_read_b64_tr_b16 v[30:31], v6 offset:3968
    s_mov_b32 m0, s39
    s_mov_b64 exec, s[42:43]
    buffer_load_dwordx4 v3, s[20:23], s37 offen lds
    s_mov_b64 exec, -1
    v_dot2c_f32_bf16 v248, s56, v56
    v_mfma_f32_32x32x16_bf16 v[112:127], v[52:55], v[44:47], v[112:127]
    ds_read_b64_tr_b16 v[32:33], v6 offset:256
    ds_read_b64_tr_b16 v[34:35], v6 offset:4096
    s_mov_b64 exec, s[42:43]
    buffer_load_dwordx4 v4, s[20:23], s37 offen offset:896 lds
    s_mov_b64 exec, -1
    s_add_u32 m0, s39, 1792
    s_add_u32 s37, s37, s38
    v_dot2c_f32_bf16 v248, s56, v57
    v_mfma_f32_32x32x16_bf16 v[128:143], v[40:43], v[56:59], v[128:143]
    buffer_load_dwordx4 v244, s[24:27], s36 offen lds
    s_add_u32 s39, s39, 30720
    s_cmp_eq_u32 s39, s13
    s_cselect_b32 s39, s12, s39
    v_dot2c_f32_bf16 v248, s56, v58
    v_mfma_f32_32x32x16_bf16 v[144:159], v[44:47], v[56:59], v[144:159]
    buffer_load_dwordx4 v245, s[24:27], s36 offen offset:1024 lds
    s_add_u32 s36, s36, 64
    s_cmp_eq_u32 s36, s59
    s_cselect_b32 s36, s78, s36
    s_cselect_b32 s37, s79, s37
    s_cmp_eq_u32 s36, 2048
    s_cselect_b32 s36, 0x100000, s36
    s_cselect_b32 s37, 0x10000000, s37
    v_dot2c_f32_bf16 v248, s56, v59
    s_cmp_lg_u32 s40, 0
    s_cbranch_scc1 .g1_loopqd2
    s_branch .g1_pubq
.g1_loopq:
    s_waitcnt lgkmcnt(0)
    v_mfma_f32_32x32x16_bf16 v[64:79], v[24:27], v[16:19], v[64:79]
    ds_read_b128 v[40:43], v243 offset:1792
    ds_read_b64_tr_b16 v[48:49], v6 offset:15360
    v_mfma_f32_32x32x16_bf16 v[80:95], v[24:27], v[20:23], v[80:95]
    ds_read_b64_tr_b16 v[50:51], v6 offset:19200
    ds_read_b128 v[44:47], v243 offset:5632
    v_mfma_f32_32x32x16_bf16 v[96:111], v[28:31], v[16:19], v[96:111]
    ds_read_b64_tr_b16 v[52:53], v6 offset:15488
    ds_read_b64_tr_b16 v[54:55], v6 offset:19328
    v_mfma_f32_32x32x16_bf16 v[112:127], v[28:31], v[20:23], v[112:127]
    ds_read_b64_tr_b16 v[56:57], v6 offset:15616
    ds_read_b64_tr_b16 v[58:59], v6 offset:19456
    v_mfma_f32_32x32x16_bf16 v[128:143], v[16:19], v[32:35], v[128:143]
    s_add_u32 s46, s46, 1
    s_cmp_eq_u32 s46, 5
    s_cselect_b32 s41, -122880, s49
    s_cselect_b32 s46, 0, s46
    v_add_u32 v5, s41, v5
    v_add_u32 v6, s41, v6
    v_add_u32 v243, s41, v243
    v_mfma_f32_32x32x16_bf16 v[144:159], v[20:23], v[32:35], v[144:159]
    s_sub_u32 s40, s40, 1
    s_waitcnt vmcnt(12) lgkmcnt(0)
    s_barrier
    v_mfma_f32_32x32x16_bf16 v[64:79], v[48:51], v[40:43], v[64:79]
    ds_read_b128 v[16:19], v5 offset:1792
    ds_read_b64_tr_b16 v[24:25], v6 offset:0
    v_mfma_f32_32x32x16_bf16 v[80:95], v[48:51], v[44:47], v[80:95]
    ds_read_b64_tr_b16 v[26:27], v6 offset:3840
    ds_read_b128 v[20:23], v5 offset:5632
    v_mfma_f32_32x32x16_bf16 v[96:111], v[52:55], v[40:43], v[96:111]
    ds_read_b64_tr_b16 v[28:29], v6 offset:128
    ds_read_b64_tr_b16 v[30:31], v6 offset:3968
    s_mov_b32 m0, s39
    s_mov_b64 exec, s[42:43]
    buffer_load_dwordx4 v3, s[20:23], s37 offen lds
    s_mov_b64 exec, -1
    v_mfma_f32_32x32x16_bf16 v[112:127], v[52:55], v[44:47], v[112:127]
    ds_read_b64_tr_b16 v[32:33], v6 offset:256
    ds_read_b64_tr_b16 v[34:35], v6 offset:4096
    s_mov_b64 exec, s[42:43]
    buffer_load_dwordx4 v4, s[20:23], s37 offen offset:896 lds
    s_mov_b64 exec, -1
    s_add_u32 m0, s39, 1792
    s_add_u32 s37, s37, s38
    v_mfma_f32_32x32x16_bf16 v[128:143], v[40:43], v[56:59], v[128:143]
    buffer_load_dwordx4 v244, s[24:27], s36 offen lds
    s_add_u32 s39, s39, 30720
    s_cmp_eq_u32 s39, s13
    s_cselect_b32 s39, s12, s39
    v_mfma_f32_32x32x16_bf16 v[144:159], v[44:47], v[56:59], v[144:159]
    buffer_load_dwordx4 v245, s[24:27], s36 offen offset:1024 lds
    s_add_u32 s36, s36, 64
    s_cmp_eq_u32 s36, s59
    s_cselect_b32 s36, s78, s36
    s_cselect_b32 s37, s79, s37
    s_cmp_eq_u32 s36, 2048
    s_cselect_b32 s36, 0x100000, s36
    s_cselect_b32 s37, 0x10000000, s37
    s_cmp_lg_u32 s40, 0
    s_cbranch_scc1 .g1_loopq
    s_add_u32 s58, s58, 1
    s_mov_b32 s40, 4
    s_cmp_eq_u32 s58, 2
    s_cbranch_scc1 .g1_loopq
    s_cmp_eq_u32 s58, 3
    s_cbranch_scc1 .g1_p2q
    s_cmp_eq_u32 s58, 4
    s_cbranch_scc1 .g1_p3q
    s_cmp_eq_u32 s58, 5
    s_cbranch_scc1 .g1_p4q
    s_sub_u32 s78, s59, 0
    s_sub_u32 s59, s59, 256
    s_lshr_b32 s44, s38, 6
    s_mul_i32 s79, s78, s44
    s_cmp_eq_u32 s15, 0
    s_cbranch_scc1 .g1_loopqd0
    s_cmp_eq_u32 s15, 1
    s_cbranch_scc1 .g1_loopqd1
    s_cmp_eq_u32 s15, 2
    s_cbranch_scc1 .g1_loopqd2
    s_branch .g1_loopq
.g1_p2q:
    s_mov_b32 s40, 12
    s_cmp_eq_u32 s14, 0
    s_cbranch_scc0 .g1_loopq
    v_mov_b32 v248, 1
    s_mov_b64 exec, 1
    buffer_atomic_add v248, v254, s[68:71], 0 offen offset:8 sc1
    s_mov_b64 exec, -1
    s_branch .g1_loopq
.g1_pubq:
    v_mov_b32 v249, v248
    s_nop 1
    v_permlane32_swap_b32 v248, v249
    v_add_f32 v248, v248, v249
    v_and_b32 v249, 31, v1
    v_lshlrev_b32 v249, 5, v249
    s_lshl_b32 s44, s15, 10
    s_lshl_b32 s45, s17, 2
    s_add_u32 s44, s44, s45
    s_add_u32 s44, s44, s60
    s_mov_b32 exec_hi, 0
    buffer_store_dword v248, v249, s[28:31], s44 offen sc1
    s_mov_b64 exec, -1
    s_mov_b32 s58, 2
    s_mov_b32 s40, 4
    s_branch .g1_loopq
.g1_p3q:
    buffer_load_dwordx4 v[216:219], v254, s[68:71], 0 offen
    s_branch .g1_loopq
.g1_p4q:
    s_mov_b32 s44, 16384
.g1_p4lq:
    v_readfirstlane_b32 s45, v218
    v_readfirstlane_b32 s76, v216
    v_readfirstlane_b32 s77, v217
    s_cmp_eq_u32 s45, 256
    s_cbranch_scc1 .g1_p4okq
    buffer_load_dwordx4 v[216:219], v254, s[68:71], 0 offen sc1
    s_sub_u32 s44, s44, 1
    s_waitcnt vmcnt(0)
    s_cmp_lg_u32 s44, 0
    s_cbranch_scc1 .g1_p4lq
.g1_p4okq:
    v_and_b32 v249, 31, v1
    v_lshlrev_b32 v248, 3, v249
    v_lshlrev_b32 v249, 5, v249
    v_lshl_add_u32 v249, v7, 4, v249
    buffer_load_dwordx2 v[240:241], v248, s[28:31], s61 offen sc1
    buffer_load_dwordx2 v[246:247], v248, s[28:31], s61 offen offset:256 sc1
    buffer_load_dwordx4 v[224:227], v249, s[28:31], s60 offen offset:0 sc1
    buffer_load_dwordx4 v[228:231], v249, s[28:31], s60 offen offset:1024 sc1
    buffer_load_dwordx4 v[232:235], v249, s[28:31], s60 offen offset:2048 sc1
    s_waitcnt lgkmcnt(0)
    v_mfma_f32_32x32x16_bf16 v[64:79], v[24:27], v[16:19], v[64:79]
    ds_read_b128 v[40:43], v243 offset:1792
    ds_read_b64_tr_b16 v[48:49], v6 offset:15360
    v_mfma_f32_32x32x16_bf16 v[80:95], v[24:27], v[20:23], v[80:95]
    ds_read_b64_tr_b16 v[50:51], v6 offset:19200
    ds_read_b128 v[44:47], v243 offset:5632
    v_mfma_f32_32x32x16_bf16 v[96:111], v[28:31], v[16:19], v[96:111]
    ds_read_b64_tr_b16 v[52:53], v6 offset:15488
    ds_read_b64_tr_b16 v[54:55], v6 offset:19328
    v_mfma_f32_32x32x16_bf16 v[112:127], v[28:31], v[20:23], v[112:127]
    ds_read_b64_tr_b16 v[56:57], v6 offset:15616
    ds_read_b64_tr_b16 v[58:59], v6 offset:19456
    v_mfma_f32_32x32x16_bf16 v[128:143], v[16:19], v[32:35], v[128:143]
    s_add_u32 s46, s46, 1
    s_cmp_eq_u32 s46, 5
    s_cselect_b32 s41, -122880, s49
    s_cselect_b32 s46, 0, s46
    v_add_u32 v5, s41, v5
    v_add_u32 v6, s41, v6
    v_add_u32 v243, s41, v243
    v_mfma_f32_32x32x16_bf16 v[144:159], v[20:23], v[32:35], v[144:159]
    s_waitcnt vmcnt(17) lgkmcnt(0)
    s_barrier
    v_mfma_f32_32x32x16_bf16 v[64:79], v[48:51], v[40:43], v[64:79]
    ds_read_b128 v[16:19], v5 offset:1792
    ds_read_b64_tr_b16 v[24:25], v6 offset:0
    v_mfma_f32_32x32x16_bf16 v[80:95], v[48:51], v[44:47], v[80:95]
    ds_read_b64_tr_b16 v[26:27], v6 offset:3840
    ds_read_b128 v[20:23], v5 offset:5632
    v_mfma_f32_32x32x16_bf16 v[96:111], v[52:55], v[40:43], v[96:111]
    ds_read_b64_tr_b16 v[28:29], v6 offset:128
    ds_read_b64_tr_b16 v[30:31], v6 offset:3968
    v_mfma_f32_32x32x16_bf16 v[112:127], v[52:55], v[44:47], v[112:127]
    ds_read_b64_tr_b16 v[32:33], v6 offset:256
    ds_read_b64_tr_b16 v[34:35], v6 offset:4096
    v_mfma_f32_32x32x16_bf16 v[128:143], v[40:43], v[56:59], v[128:143]
    v_mfma_f32_32x32x16_bf16 v[144:159], v[44:47], v[56:59], v[144:159]
    s_waitcnt lgkmcnt(0)
    v_mfma_f32_32x32x16_bf16 v[64:79], v[24:27], v[16:19], v[64:79]
    ds_read_b128 v[40:43], v243 offset:1792
    ds_read_b64_tr_b16 v[48:49], v6 offset:15360
    v_mfma_f32_32x32x16_bf16 v[80:95], v[24:27], v[20:23], v[80:95]
    ds_read_b64_tr_b16 v[50:51], v6 offset:19200
    ds_read_b128 v[44:47], v243 offset:5632
    v_mfma_f32_32x32x16_bf16 v[96:111], v[28:31], v[16:19], v[96:111]
    ds_read_b64_tr_b16 v[52:53], v6 offset:15488
    ds_read_b64_tr_b16 v[54:55], v6 offset:19328
    v_mfma_f32_32x32x16_bf16 v[112:127], v[28:31], v[20:23], v[112:127]
    ds_read_b64_tr_b16 v[56:57], v6 offset:15616
    ds_read_b64_tr_b16 v[58:59], v6 offset:19456
    v_mfma_f32_32x32x16_bf16 v[128:143], v[16:19], v[32:35], v[128:143]
    s_add_u32 s46, s46, 1
    s_cmp_eq_u32 s46, 5
    s_cselect_b32 s41, -122880, s49
    s_cselect_b32 s46, 0, s46
    v_add_u32 v5, s41, v5
    v_add_u32 v6, s41, v6
    v_add_u32 v243, s41, v243
    v_mfma_f32_32x32x16_bf16 v[144:159], v[20:23], v[32:35], v[144:159]
    s_waitcnt vmcnt(13) lgkmcnt(0)
    s_barrier
    v_mfma_f32_32x32x16_bf16 v[64:79], v[48:51], v[40:43], v[64:79]
    ds_read_b128 v[16:19], v5 offset:1792
    ds_read_b64_tr_b16 v[24:25], v6 offset:0
    v_mfma_f32_32x32x16_bf16 v[80:95], v[48:51], v[44:47], v[80:95]
    ds_read_b64_tr_b16 v[26:27], v6 offset:3840
    ds_read_b128 v[20:23], v5 offset:5632
    v_mfma_f32_32x32x16_bf16 v[96:111], v[52:55], v[40:43], v[96:111]
    ds_read_b64_tr_b16 v[28:29], v6 offset:128
    ds_read_b64_tr_b16 v[30:31], v6 offset:3968
    v_mfma_f32_32x32x16_bf16 v[112:127], v[52:55], v[44:47], v[112:127]
    ds_read_b64_tr_b16 v[32:33], v6 offset:256
    ds_read_b64_tr_b16 v[34:35], v6 offset:4096
    v_mfma_f32_32x32x16_bf16 v[128:143], v[40:43], v[56:59], v[128:143]
    v_mfma_f32_32x32x16_bf16 v[144:159], v[44:47], v[56:59], v[144:159]
    s_waitcnt lgkmcnt(0)
    v_mfma_f32_32x32x16_bf16 v[64:79], v[24:27], v[16:19], v[64:79]
    ds_read_b128 v[40:43], v243 offset:1792
    ds_read_b64_tr_b16 v[48:49], v6 offset:15360
    v_mfma_f32_32x32x16_bf16 v[80:95], v[24:27], v[20:23], v[80:95]
    ds_read_b64_tr_b16 v[50:51], v6 offset:19200
    ds_read_b128 v[44:47], v243 offset:5632
    v_mfma_f32_32x32x16_bf16 v[96:111], v[28:31], v[16:19], v[96:111]
    ds_read_b64_tr_b16 v[52:53], v6 offset:15488
    ds_read_b64_tr_b16 v[54:55], v6 offset:19328
    v_mfma_f32_32x32x16_bf16 v[112:127], v[28:31], v[20:23], v[112:127]
    ds_read_b64_tr_b16 v[56:57], v6 offset:15616
    ds_read_b64_tr_b16 v[58:59], v6 offset:19456
    v_mfma_f32_32x32x16_bf16 v[128:143], v[16:19], v[32:35], v[128:143]
    s_add_u32 s46, s46, 1
    s_cmp_eq_u32 s46, 5
    s_cselect_b32 s41, -122880, s49
    s_cselect_b32 s46, 0, s46
    v_add_u32 v5, s41, v5
    v_add_u32 v6, s41, v6
    v_add_u32 v243, s41, v243
    v_mfma_f32_32x32x16_bf16 v[144:159], v[20:23], v[32:35], v[144:159]
    s_waitcnt vmcnt(9) lgkmcnt(0)
    s_barrier
    v_mfma_f32_32x32x16_bf16 v[64:79], v[48:51], v[40:43], v[64:79]
    ds_read_b128 v[16:19], v5 offset:1792
    ds_read_b64_tr_b16 v[24:25], v6 offset:0
    v_mfma_f32_32x32x16_bf16 v[80:95], v[48:51], v[44:47], v[80:95]
    ds_read_b64_tr_b16 v[26:27], v6 offset:3840
    ds_read_b128 v[20:23], v5 offset:5632
    v_mfma_f32_32x32x16_bf16 v[96:111], v[52:55], v[40:43], v[96:111]
    ds_read_b64_tr_b16 v[28:29], v6 offset:128
    ds_read_b64_tr_b16 v[30:31], v6 offset:3968
    v_mfma_f32_32x32x16_bf16 v[112:127], v[52:55], v[44:47], v[112:127]
    ds_read_b64_tr_b16 v[32:33], v6 offset:256
    ds_read_b64_tr_b16 v[34:35], v6 offset:4096
    v_mfma_f32_32x32x16_bf16 v[128:143], v[40:43], v[56:59], v[128:143]
    v_mfma_f32_32x32x16_bf16 v[144:159], v[44:47], v[56:59], v[144:159]
    s_waitcnt lgkmcnt(0)
    v_mfma_f32_32x32x16_bf16 v[64:79], v[24:27], v[16:19], v[64:79]
    ds_read_b128 v[40:43], v243 offset:1792
    ds_read_b64_tr_b16 v[48:49], v6 offset:15360
    v_mfma_f32_32x32x16_bf16 v[80:95], v[24:27], v[20:23], v[80:95]
    ds_read_b64_tr_b16 v[50:51], v6 offset:19200
    ds_read_b128 v[44:47], v243 offset:5632
    v_mfma_f32_32x32x16_bf16 v[96:111], v[28:31], v[16:19], v[96:111]
    ds_read_b64_tr_b16 v[52:53], v6 offset:15488
    ds_read_b64_tr_b16 v[54:55], v6 offset:19328
    v_mfma_f32_32x32x16_bf16 v[112:127], v[28:31], v[20:23], v[112:127]
    ds_read_b64_tr_b16 v[56:57], v6 offset:15616
    ds_read_b64_tr_b16 v[58:59], v6 offset:19456
    v_mfma_f32_32x32x16_bf16 v[128:143], v[16:19], v[32:35], v[128:143]
    s_add_u32 s46, s46, 1
    s_cmp_eq_u32 s46, 5
    s_cselect_b32 s41, -122880, s49
    s_cselect_b32 s46, 0, s46
    v_add_u32 v5, s41, v5
    v_add_u32 v6, s41, v6
    v_add_u32 v243, s41, v243
    v_mfma_f32_32x32x16_bf16 v[144:159], v[20:23], v[32:35], v[144:159]
    s_waitcnt lgkmcnt(0)
    s_barrier
    v_mfma_f32_32x32x16_bf16 v[64:79], v[48:51], v[40:43], v[64:79]
    v_mfma_f32_32x32x16_bf16 v[80:95], v[48:51], v[44:47], v[80:95]
    v_mfma_f32_32x32x16_bf16 v[96:111], v[52:55], v[40:43], v[96:111]
    v_mfma_f32_32x32x16_bf16 v[112:127], v[52:55], v[44:47], v[112:127]
    v_mfma_f32_32x32x16_bf16 v[128:143], v[40:43], v[56:59], v[128:143]
    v_mfma_f32_32x32x16_bf16 v[144:159], v[44:47], v[56:59], v[144:159]
.g1_doneq:
    s_branch .g1_qdone
.g1_q1:
    ds_read_b128 v[16:19], v5 offset:1792
    ds_read_b64_tr_b16 v[24:25], v6 offset:0
    ds_read_b64_tr_b16 v[26:27], v6 offset:3840
    ds_read_b128 v[20:23], v5 offset:5632
    ds_read_b64_tr_b16 v[28:29], v6 offset:128
    ds_read_b64_tr_b16 v[30:31], v6 offset:3968
    ds_read_b64_tr_b16 v[32:33], v6 offset:256
    ds_read_b64_tr_b16 v[34:35], v6 offset:4096
    s_branch .g1_loopr
.g1_looprd0:
    s_waitcnt lgkmcnt(0)
    v_mfma_f32_32x32x16_bf16 v[64:79], v[24:27], v[16:19], v[64:79]
    ds_read_b128 v[40:43], v243 offset:1792
    ds_read_b64_tr_b16 v[48:49], v6 offset:15360
    v_mfma_f32_32x32x16_bf16 v[80:95], v[24:27], v[20:23], v[80:95]
    ds_read_b64_tr_b16 v[50:51], v6 offset:19200
    ds_read_b128 v[44:47], v243 offset:5632
    v_mfma_f32_32x32x16_bf16 v[96:111], v[28:31], v[16:19], v[96:111]
    ds_read_b64_tr_b16 v[52:53], v6 offset:15488
    ds_read_b64_tr_b16 v[54:55], v6 offset:19328
    s_mov_b32 m0, s39
    s_mov_b64 exec, s[42:43]
    buffer_load_dwordx4 v3, s[20:23], s37 offen lds
    s_mov_b64 exec, -1
    v_dot2c_f32_bf16 v248, s56, v24
    v_mfma_f32_32x32x16_bf16 v[112:127], v[28:31], v[20:23], v[112:127]
    ds_read_b64_tr_b16 v[56:57], v6 offset:15616
    ds_read_b64_tr_b16 v[58:59], v6 offset:19456
    s_mov_b64 exec, s[42:43]
    buffer_load_dwordx4 v4, s[20:23], s37 offen offset:896 lds
    s_mov_b64 exec, -1
    s_add_u32 m0, s39, 1792
    s_add_u32 s37, s37, s38
    v_dot2c_f32_bf16 v248, s56, v25
    v_mfma_f32_32x32x16_bf16 v[128:143], v[16:19], v[32:35], v[128:143]
    s_add_u32 s46, s46, 1
    s_cmp_eq_u32 s46, 5
    s_cselect_b32 s41, -122880, s49
    s_cselect_b32 s46, 0, s46
    v_add_u32 v5, s41, v5
    v_add_u32 v6, s41, v6
    v_add_u32 v243, s41, v243
    buffer_load_dwordx4 v244, s[24:27], s36 offen lds
    s_add_u32 s39, s39, 30720
    s_cmp_eq_u32 s39, s13
    s_cselect_b32 s39, s12, s39
    v_dot2c_f32_bf16 v248, s56, v26
    v_mfma_f32_32x32x16_bf16 v[144:159], v[20:23], v[32:35], v[144:159]
    buffer_load_dwordx4 v245, s[24:27], s36 offen offset:1024 lds
    s_add_u32 s36, s36, 64
    s_cmp_eq_u32 s36, s59
    s_cselect_b32 s36, s78, s36
    s_cselect_b32 s37, s79, s37
    s_cmp_eq_u32 s36, 2048
    s_cselect_b32 s36, 0x100000, s36
    s_cselect_b32 s37, 0x10000000, s37
    v_dot2c_f32_bf16 v248, s56, v27
    s_sub_u32 s40, s40, 1
    s_waitcnt vmcnt(12) lgkmcnt(0)
    s_barrier
    v_mfma_f32_32x32x16_bf16 v[64:79], v[48:51], v[40:43], v[64:79]
    ds_read_b128 v[16:19], v5 offset:1792
    ds_read_b64_tr_b16 v[24:25], v6 offset:0
    v_mfma_f32_32x32x16_bf16 v[80:95], v[48:51], v[44:47], v[80:95]
    ds_read_b64_tr_b16 v[26:27], v6 offset:3840
    ds_read_b128 v[20:23], v5 offset:5632
    v_mfma_f32_32x32x16_bf16 v[96:111], v[52:55], v[40:43], v[96:111]
    ds_read_b64_tr_b16 v[28:29], v6 offset:128
    ds_read_b64_tr_b16 v[30:31], v6 offset:3968
    v_dot2c_f32_bf16 v248, s56, v48
    v_mfma_f32_32x32x16_bf16 v[112:127], v[52:55], v[44:47], v[112:127]
    ds_read_b64_tr_b16 v[32:33], v6 offset:256
    ds_read_b64_tr_b16 v[34:35], v6 offset:4096
    v_dot2c_f32_bf16 v248, s56, v49
    v_mfma_f32_32x32x16_bf16 v[128:143], v[40:43], v[56:59], v[128:143]
    v_dot2c_f32_bf16 v248, s56, v50
    v_mfma_f32_32x32x16_bf16 v[144:159], v[44:47], v[56:59], v[144:159]
    v_dot2c_f32_bf16 v248, s56, v51
    s_cmp_lg_u32 s40, 0
    s_cbranch_scc1 .g1_looprd0
    s_branch .g1_pubr
.g1_looprd1:
    s_waitcnt lgkmcnt(0)
    v_mfma_f32_32x32x16_bf16 v[64:79], v[24:27], v[16:19], v[64:79]
    ds_read_b128 v[40:43], v243 offset:1792
    ds_read_b64_tr_b16 v[48:49], v6 offset:15360
    v_mfma_f32_32x32x16_bf16 v[80:95], v[24:27], v[20:23], v[80:95]
    ds_read_b64_tr_b16 v[50:51], v6 offset:19200
    ds_read_b128 v[44:47], v243 offset:5632
    v_mfma_f32_32x32x16_bf16 v[96:111], v[28:31], v[16:19], v[96:111]
    ds_read_b64_tr_b16 v[52:53], v6 offset:15488
    ds_read_b64_tr_b16 v[54:55], v6 offset:19328
    s_mov_b32 m0, s39
    s_mov_b64 exec, s[42:43]
    buffer_load_dwordx4 v3, s[20:23], s37 offen lds
    s_mov_b64 exec, -1
    v_dot2c_f32_bf16 v248, s56, v28
    v_mfma_f32_32x32x16_bf16 v[112:127], v[28:31], v[20:23], v[112:127]
    ds_read_b64_tr_b16 v[56:57], v6 offset:15616
    ds_read_b64_tr_b16 v[58:59], v6 offset:19456
    s_mov_b64 exec, s[42:43]
    buffer_load_dwordx4 v4, s[20:23], s37 offen offset:896 lds
    s_mov_b64 exec, -1
    s_add_u32 m0, s39, 1792
    s_add_u32 s37, s37, s38
    v_dot2c_f32_bf16 v248, s56, v29
    v_mfma_f32_32x32x16_bf16 v[128:143], v[16:19], v[32:35], v[128:143]
    s_add_u32 s46, s46, 1
    s_cmp_eq_u32 s46, 5
    s_cselect_b32 s41, -122880, s49
    s_cselect_b32 s46, 0, s46
    v_add_u32 v5, s41, v5
    v_add_u32 v6, s41, v6
    v_add_u32 v243, s41, v243
    buffer_load_dwordx4 v244, s[24:27], s36 offen lds
    s_add_u32 s39, s39, 30720
    s_cmp_eq_u32 s39, s13
    s_cselect_b32 s39, s12, s39
    v_dot2c_f32_bf16 v248, s56, v30
    v_mfma_f32_32x32x16_bf16 v[144:159], v[20:23], v[32:35], v[144:159]
    buffer_load_dwordx4 v245, s[24:27], s36 offen offset:1024 lds
    s_add_u32 s36, s36, 64
    s_cmp_eq_u32 s36, s59
    s_cselect_b32 s36, s78, s36
    s_cselect_b32 s37, s79, s37
    s_cmp_eq_u32 s36, 2048
    s_cselect_b32 s36, 0x100000, s36
    s_cselect_b32 s37, 0x10000000, s37
    v_dot2c_f32_bf16 v248, s56, v31
    s_sub_u32 s40, s40, 1
    s_waitcnt vmcnt(12) lgkmcnt(0)
    s_barrier
    v_mfma_f32_32x32x16_bf16 v[64:79], v[48:51], v[40:43], v[64:79]
    ds_read_b128 v[16:19], v5 offset:1792
    ds_read_b64_tr_b16 v[24:25], v6 offset:0
    v_mfma_f32_32x32x16_bf16 v[80:95], v[48:51], v[44:47], v[80:95]
    ds_read_b64_tr_b16 v[26:27], v6 offset:3840
    ds_read_b128 v[20:23], v5 offset:5632
    v_mfma_f32_32x32x16_bf16 v[96:111], v[52:55], v[40:43], v[96:111]
    ds_read_b64_tr_b16 v[28:29], v6 offset:128
    ds_read_b64_tr_b16 v[30:31], v6 offset:3968
    v_dot2c_f32_bf16 v248, s56, v52
    v_mfma_f32_32x32x16_bf16 v[112:127], v[52:55], v[44:47], v[112:127]
    ds_read_b64_tr_b16 v[32:33], v6 offset:256
    ds_read_b64_tr_b16 v[34:35], v6 offset:4096
    v_dot2c_f32_bf16 v248, s56, v53
    v_mfma_f32_32x32x16_bf16 v[128:143], v[40:43], v[56:59], v[128:143]
    v_dot2c_f32_bf16 v248, s56, v54
    v_mfma_f32_32x32x16_bf16 v[144:159], v[44:47], v[56:59], v[144:159]
    v_dot2c_f32_bf16 v248, s56, v55
    s_cmp_lg_u32 s40, 0
    s_cbranch_scc1 .g1_looprd1
    s_branch .g1_pubr
.g1_looprd2:
    s_waitcnt lgkmcnt(0)
    v_mfma_f32_32x32x16_bf16 v[64:79], v[24:27], v[16:19], v[64:79]
    ds_read_b128 v[40:43], v243 offset:1792
    ds_read_b64_tr_b16 v[48:49], v6 offset:15360
    v_mfma_f32_32x32x16_bf16 v[80:95], v[24:27], v[20:23], v[80:95]
    ds_read_b64_tr_b16 v[50:51], v6 offset:19200
    ds_read_b128 v[44:47], v243 offset:5632
    v_mfma_f32_32x32x16_bf16 v[96:111], v[28:31], v[16:19], v[96:111]
    ds_read_b64_tr_b16 v[52:53], v6 offset:15488
    ds_read_b64_tr_b16 v[54:55], v6 offset:19328
    s_mov_b32 m0, s39
    s_mov_b64 exec, s[42:43]
    buffer_load_dwordx4 v3, s[20:23], s37 offen lds
    s_mov_b64 exec, -1
    v_dot2c_f32_bf16 v248, s56, v32
    v_mfma_f32_32x32x16_bf16 v[112:127], v[28:31], v[20:23], v[112:127]
    ds_read_b64_tr_b16 v[56:57], v6 offset:15616
    ds_read_b64_tr_b16 v[58:59], v6 offset:19456
    s_mov_b64 exec, s[42:43]
    buffer_load_dwordx4 v4, s[20:23], s37 offen offset:896 lds
    s_mov_b64 exec, -1
    s_add_u32 m0, s39, 1792
    s_add_u32 s37, s37, s38
    v_dot2c_f32_bf16 v248, s56, v33
    v_mfma_f32_32x32x16_bf16 v[128:143], v[16:19], v[32:35], v[128:143]
    s_add_u32 s46, s46, 1
    s_cmp_eq_u32 s46, 5
    s_cselect_b32 s41, -122880, s49
    s_cselect_b32 s46, 0, s46
    v_add_u32 v5, s41, v5
    v_add_u32 v6, s41, v6
    v_add_u32 v243, s41, v243
    buffer_load_dwordx4 v244, s[24:27], s36 offen lds
    s_add_u32 s39, s39, 30720
    s_cmp_eq_u32 s39, s13
    s_cselect_b32 s39, s12, s39
    v_dot2c_f32_bf16 v248, s56, v34
    v_mfma_f32_32x32x16_bf16 v[144:159], v[20:23], v[32:35], v[144:159]
    buffer_load_dwordx4 v245, s[24:27], s36 offen offset:1024 lds
    s_add_u32 s36, s36, 64
    s_cmp_eq_u32 s36, s59
    s_cselect_b32 s36, s78, s36
    s_cselect_b32 s37, s79, s37
    s_cmp_eq_u32 s36, 2048
    s_cselect_b32 s36, 0x100000, s36
    s_cselect_b32 s37, 0x10000000, s37
    v_dot2c_f32_bf16 v248, s56, v35
    s_sub_u32 s40, s40, 1
    s_waitcnt vmcnt(12) lgkmcnt(0)
    s_barrier
    v_mfma_f32_32x32x16_bf16 v[64:79], v[48:51], v[40:43], v[64:79]
    ds_read_b128 v[16:19], v5 offset:1792
    ds_read_b64_tr_b16 v[24:25], v6 offset:0
    v_mfma_f32_32x32x16_bf16 v[80:95], v[48:51], v[44:47], v[80:95]
    ds_read_b64_tr_b16 v[26:27], v6 offset:3840
    ds_read_b128 v[20:23], v5 offset:5632
    v_mfma_f32_32x32x16_bf16 v[96:111], v[52:55], v[40:43], v[96:111]
    ds_read_b64_tr_b16 v[28:29], v6 offset:128
    ds_read_b64_tr_b16 v[30:31], v6 offset:3968
    v_dot2c_f32_bf16 v248, s56, v56
    v_mfma_f32_32x32x16_bf16 v[112:127], v[52:55], v[44:47], v[112:127]
    ds_read_b64_tr_b16 v[32:33], v6 offset:256
    ds_read_b64_tr_b16 v[34:35], v6 offset:4096
    v_dot2c_f32_bf16 v248, s56, v57
    v_mfma_f32_32x32x16_bf16 v[128:143], v[40:43], v[56:59], v[128:143]
    v_dot2c_f32_bf16 v248, s56, v58
    v_mfma_f32_32x32x16_bf16 v[144:159], v[44:47], v[56:59], v[144:159]
    v_dot2c_f32_bf16 v248, s56, v59
    s_cmp_lg_u32 s40, 0
    s_cbranch_scc1 .g1_looprd2
    s_branch .g1_pubr
.g1_loopr:
    s_waitcnt lgkmcnt(0)
    v_mfma_f32_32x32x16_bf16 v[64:79], v[24:27], v[16:19], v[64:79]
    ds_read_b128 v[40:43], v243 offset:1792
    ds_read_b64_tr_b16 v[48:49], v6 offset:15360
    v_mfma_f32_32x32x16_bf16 v[80:95], v[24:27], v[20:23], v[80:95]
    ds_read_b64_tr_b16 v[50:51], v6 offset:19200
    ds_read_b128 v[44:47], v243 offset:5632
    v_mfma_f32_32x32x16_bf16 v[96:111], v[28:31], v[16:19], v[96:111]
    ds_read_b64_tr_b16 v[52:53], v6 offset:15488
    ds_read_b64_tr_b16 v[54:55], v6 offset:19328
    s_mov_b32 m0, s39
    s_mov_b64 exec, s[42:43]
    buffer_load_dwordx4 v3, s[20:23], s37 offen lds
    s_mov_b64 exec, -1
    v_mfma_f32_32x32x16_bf16 v[112:127], v[28:31], v[20:23], v[112:127]
    ds_read_b64_tr_b16 v[56:57], v6 offset:15616
    ds_read_b64_tr_b16 v[58:59], v6 offset:19456
    s_mov_b64 exec, s[42:43]
    buffer_load_dwordx4 v4, s[20:23], s37 offen offset:896 lds
    s_mov_b64 exec, -1
    s_add_u32 m0, s39, 1792
    s_add_u32 s37, s37, s38
    v_mfma_f32_32x32x16_bf16 v[128:143], v[16:19], v[32:35], v[128:143]
    s_add_u32 s46, s46, 1
    s_cmp_eq_u32 s46, 5
    s_cselect_b32 s41, -122880, s49
    s_cselect_b32 s46, 0, s46
    v_add_u32 v5, s41, v5
    v_add_u32 v6, s41, v6
    v_add_u32 v243, s41, v243
    buffer_load_dwordx4 v244, s[24:27], s36 offen lds
    s_add_u32 s39, s39, 30720
    s_cmp_eq_u32 s39, s13
    s_cselect_b32 s39, s12, s39
    v_mfma_f32_32x32x16_bf16 v[144:159], v[20:23], v[32:35], v[144:159]
    buffer_load_dwordx4 v245, s[24:27], s36 offen offset:1024 lds
    s_add_u32 s36, s36, 64
    s_cmp_eq_u32 s36, s59
    s_cselect_b32 s36, s78, s36
    s_cselect_b32 s37, s79, s37
    s_cmp_eq_u32 s36, 2048
    s_cselect_b32 s36, 0x100000, s36
    s_cselect_b32 s37, 0x10000000, s37
    s_sub_u32 s40, s40, 1
    s_waitcnt vmcnt(12) lgkmcnt(0)
    s_barrier
    v_mfma_f32_32x32x16_bf16 v[64:79], v[48:51], v[40:43], v[64:79]
    ds_read_b128 v[16:19], v5 offset:1792
    ds_read_b64_tr_b16 v[24:25], v6 offset:0
    v_mfma_f32_32x32x16_bf16 v[80:95], v[48:51], v[44:47], v[80:95]
    ds_read_b64_tr_b16 v[26:27], v6 offset:3840
    ds_read_b128 v[20:23], v5 offset:5632
    v_mfma_f32_32x32x16_bf16 v[96:111], v[52:55], v[40:43], v[96:111]
    ds_read_b64_tr_b16 v[28:29], v6 offset:128
    ds_read_b64_tr_b16 v[30:31], v6 offset:3968
    v_mfma_f32_32x32x16_bf16 v[112:127], v[52:55], v[44:47], v[112:127]
    ds_read_b64_tr_b16 v[32:33], v6 offset:256
    ds_read_b64_tr_b16 v[34:35], v6 offset:4096
    v_mfma_f32_32x32x16_bf16 v[128:143], v[40:43], v[56:59], v[128:143]
    v_mfma_f32_32x32x16_bf16 v[144:159], v[44:47], v[56:59], v[144:159]
    s_cmp_lg_u32 s40, 0
    s_cbranch_scc1 .g1_loopr
    s_add_u32 s58, s58, 1
    s_mov_b32 s40, 4
    s_cmp_eq_u32 s58, 2
    s_cbranch_scc1 .g1_loopr
    s_cmp_eq_u32 s58, 3
    s_cbranch_scc1 .g1_p2r
    s_cmp_eq_u32 s58, 4
    s_cbranch_scc1 .g1_p3r
    s_cmp_eq_u32 s58, 5
    s_cbranch_scc1 .g1_p4r
    s_sub_u32 s78, s59, 0
    s_sub_u32 s59, s59, 256
    s_lshr_b32 s44, s38, 6
    s_mul_i32 s79, s78, s44
    s_cmp_eq_u32 s15, 0
    s_cbranch_scc1 .g1_looprd0
    s_cmp_eq_u32 s15, 1
    s_cbranch_scc1 .g1_looprd1
    s_cmp_eq_u32 s15, 2
    s_cbranch_scc1 .g1_looprd2
    s_branch .g1_loopr
.g1_p2r:
    s_mov_b32 s40, 12
    s_cmp_eq_u32 s14, 0
    s_cbranch_scc0 .g1_loopr
    v_mov_b32 v248, 1
    s_mov_b64 exec, 1
    buffer_atomic_add v248, v254, s[68:71], 0 offen offset:8 sc1
    s_mov_b64 exec, -1
    s_branch .g1_loopr
.g1_pubr:
    v_mov_b32 v249, v248
    s_nop 1
    v_permlane32_swap_b32 v248, v249
    v_add_f32 v248, v248, v249
    v_and_b32 v249, 31, v1
    v_lshlrev_b32 v249, 5, v249
    s_lshl_b32 s44, s15, 10
    s_lshl_b32 s45, s17, 2
    s_add_u32 s44, s44, s45
    s_add_u32 s44, s44, s60
    s_mov_b32 exec_hi, 0
    buffer_store_dword v248, v249, s[28:31], s44 offen sc1
    s_mov_b64 exec, -1
    s_mov_b32 s58, 2
    s_mov_b32 s40, 4
    s_branch .g1_loopr
.g1_p3r:
    buffer_load_dwordx4 v[216:219], v254, s[68:71], 0 offen
    s_branch .g1_loopr
.g1_p4r:
    s_mov_b32 s44, 16384
.g1_p4lr:
    v_readfirstlane_b32 s45, v218
    v_readfirstlane_b32 s76, v216
    v_readfirstlane_b32 s77, v217
    s_cmp_eq_u32 s45, 256
    s_cbranch_scc1 .g1_p4okr
    buffer_load_dwordx4 v[216:219], v254, s[68:71], 0 offen sc1
    s_sub_u32 s44, s44, 1
    s_waitcnt vmcnt(0)
    s_cmp_lg_u32 s44, 0
    s_cbranch_scc1 .g1_p4lr
.g1_p4okr:
    v_and_b32 v249, 31, v1
    v_lshlrev_b32 v248, 3, v249
    v_lshlrev_b32 v249, 5, v249
    v_lshl_add_u32 v249, v7, 4, v249
    buffer_load_dwordx2 v[240:241], v248, s[28:31], s61 offen sc1
    buffer_load_dwordx2 v[246:247], v248, s[28:31], s61 offen offset:256 sc1
    buffer_load_dwordx4 v[224:227], v249, s[28:31], s60 offen offset:0 sc1
    buffer_load_dwordx4 v[228:231], v249, s[28:31], s60 offen offset:1024 sc1
    buffer_load_dwordx4 v[232:235], v249, s[28:31], s60 offen offset:2048 sc1
    s_waitcnt lgkmcnt(0)
    v_mfma_f32_32x32x16_bf16 v[64:79], v[24:27], v[16:19], v[64:79]
    ds_read_b128 v[40:43], v243 offset:1792
    ds_read_b64_tr_b16 v[48:49], v6 offset:15360
    v_mfma_f32_32x32x16_bf16 v[80:95], v[24:27], v[20:23], v[80:95]
    ds_read_b64_tr_b16 v[50:51], v6 offset:19200
    ds_read_b128 v[44:47], v243 offset:5632
    v_mfma_f32_32x32x16_bf16 v[96:111], v[28:31], v[16:19], v[96:111]
    ds_read_b64_tr_b16 v[52:53], v6 offset:15488
    ds_read_b64_tr_b16 v[54:55], v6 offset:19328
    v_mfma_f32_32x32x16_bf16 v[112:127], v[28:31], v[20:23], v[112:127]
    ds_read_b64_tr_b16 v[56:57], v6 offset:15616
    ds_read_b64_tr_b16 v[58:59], v6 offset:19456
    v_mfma_f32_32x32x16_bf16 v[128:143], v[16:19], v[32:35], v[128:143]
    s_add_u32 s46, s46, 1
    s_cmp_eq_u32 s46, 5
    s_cselect_b32 s41, -122880, s49
    s_cselect_b32 s46, 0, s46
    v_add_u32 v5, s41, v5
    v_add_u32 v6, s41, v6
    v_add_u32 v243, s41, v243
    v_mfma_f32_32x32x16_bf16 v[144:159], v[20:23], v[32:35], v[144:159]
    s_waitcnt vmcnt(13) lgkmcnt(0)
    s_barrier
    v_mfma_f32_32x32x16_bf16 v[64:79], v[48:51], v[40:43], v[64:79]
    ds_read_b128 v[16:19], v5 offset:1792
    ds_read_b64_tr_b16 v[24:25], v6 offset:0
    v_mfma_f32_32x32x16_bf16 v[80:95], v[48:51], v[44:47], v[80:95]
    ds_read_b64_tr_b16 v[26:27], v6 offset:3840
    ds_read_b128 v[20:23], v5 offset:5632
    v_mfma_f32_32x32x16_bf16 v[96:111], v[52:55], v[40:43], v[96:111]
    ds_read_b64_tr_b16 v[28:29], v6 offset:128
    ds_read_b64_tr_b16 v[30:31], v6 offset:3968
    v_mfma_f32_32x32x16_bf16 v[112:127], v[52:55], v[44:47], v[112:127]
    ds_read_b64_tr_b16 v[32:33], v6 offset:256
    ds_read_b64_tr_b16 v[34:35], v6 offset:4096
    v_mfma_f32_32x32x16_bf16 v[128:143], v[40:43], v[56:59], v[128:143]
    v_mfma_f32_32x32x16_bf16 v[144:159], v[44:47], v[56:59], v[144:159]
    s_waitcnt lgkmcnt(0)
    v_mfma_f32_32x32x16_bf16 v[64:79], v[24:27], v[16:19], v[64:79]
    ds_read_b128 v[40:43], v243 offset:1792
    ds_read_b64_tr_b16 v[48:49], v6 offset:15360
    v_mfma_f32_32x32x16_bf16 v[80:95], v[24:27], v[20:23], v[80:95]
    ds_read_b64_tr_b16 v[50:51], v6 offset:19200
    ds_read_b128 v[44:47], v243 offset:5632
    v_mfma_f32_32x32x16_bf16 v[96:111], v[28:31], v[16:19], v[96:111]
    ds_read_b64_tr_b16 v[52:53], v6 offset:15488
    ds_read_b64_tr_b16 v[54:55], v6 offset:19328
    v_mfma_f32_32x32x16_bf16 v[112:127], v[28:31], v[20:23], v[112:127]
    ds_read_b64_tr_b16 v[56:57], v6 offset:15616
    ds_read_b64_tr_b16 v[58:59], v6 offset:19456
    v_mfma_f32_32x32x16_bf16 v[128:143], v[16:19], v[32:35], v[128:143]
    s_add_u32 s46, s46, 1
    s_cmp_eq_u32 s46, 5
    s_cselect_b32 s41, -122880, s49
    s_cselect_b32 s46, 0, s46
    v_add_u32 v5, s41, v5
    v_add_u32 v6, s41, v6
    v_add_u32 v243, s41, v243
    v_mfma_f32_32x32x16_bf16 v[144:159], v[20:23], v[32:35], v[144:159]
    s_waitcnt vmcnt(9) lgkmcnt(0)
    s_barrier
    v_mfma_f32_32x32x16_bf16 v[64:79], v[48:51], v[40:43], v[64:79]
    ds_read_b128 v[16:19], v5 offset:1792
    ds_read_b64_tr_b16 v[24:25], v6 offset:0
    v_mfma_f32_32x32x16_bf16 v[80:95], v[48:51], v[44:47], v[80:95]
    ds_read_b64_tr_b16 v[26:27], v6 offset:3840
    ds_read_b128 v[20:23], v5 offset:5632
    v_mfma_f32_32x32x16_bf16 v[96:111], v[52:55], v[40:43], v[96:111]
    ds_read_b64_tr_b16 v[28:29], v6 offset:128
    ds_read_b64_tr_b16 v[30:31], v6 offset:3968
    v_mfma_f32_32x32x16_bf16 v[112:127], v[52:55], v[44:47], v[112:127]
    ds_read_b64_tr_b16 v[32:33], v6 offset:256
    ds_read_b64_tr_b16 v[34:35], v6 offset:4096
    v_mfma_f32_32x32x16_bf16 v[128:143], v[40:43], v[56:59], v[128:143]
    v_mfma_f32_32x32x16_bf16 v[144:159], v[44:47], v[56:59], v[144:159]
    s_waitcnt lgkmcnt(0)
    v_mfma_f32_32x32x16_bf16 v[64:79], v[24:27], v[16:19], v[64:79]
    ds_read_b128 v[40:43], v243 offset:1792
    ds_read_b64_tr_b16 v[48:49], v6 offset:15360
    v_mfma_f32_32x32x16_bf16 v[80:95], v[24:27], v[20:23], v[80:95]
    ds_read_b64_tr_b16 v[50:51], v6 offset:19200
    ds_read_b128 v[44:47], v243 offset:5632
    v_mfma_f32_32x32x16_bf16 v[96:111], v[28:31], v[16:19], v[96:111]
    ds_read_b64_tr_b16 v[52:53], v6 offset:15488
    ds_read_b64_tr_b16 v[54:55], v6 offset:19328
    v_mfma_f32_32x32x16_bf16 v[112:127], v[28:31], v[20:23], v[112:127]
    ds_read_b64_tr_b16 v[56:57], v6 offset:15616
    ds_read_b64_tr_b16 v[58:59], v6 offset:19456
    v_mfma_f32_32x32x16_bf16 v[128:143], v[16:19], v[32:35], v[128:143]
    s_add_u32 s46, s46, 1
    s_cmp_eq_u32 s46, 5
    s_cselect_b32 s41, -122880, s49
    s_cselect_b32 s46, 0, s46
    v_add_u32 v5, s41, v5
    v_add_u32 v6, s41, v6
    v_add_u32 v243, s41, v243
    v_mfma_f32_32x32x16_bf16 v[144:159], v[20:23], v[32:35], v[144:159]
    s_waitcnt vmcnt(5) lgkmcnt(0)
    s_barrier
    v_mfma_f32_32x32x16_bf16 v[64:79], v[48:51], v[40:43], v[64:79]
    ds_read_b128 v[16:19], v5 offset:1792
    ds_read_b64_tr_b16 v[24:25], v6 offset:0
    v_mfma_f32_32x32x16_bf16 v[80:95], v[48:51], v[44:47], v[80:95]
    ds_read_b64_tr_b16 v[26:27], v6 offset:3840
    ds_read_b128 v[20:23], v5 offset:5632
    v_mfma_f32_32x32x16_bf16 v[96:111], v[52:55], v[40:43], v[96:111]
    ds_read_b64_tr_b16 v[28:29], v6 offset:128
    ds_read_b64_tr_b16 v[30:31], v6 offset:3968
    v_mfma_f32_32x32x16_bf16 v[112:127], v[52:55], v[44:47], v[112:127]
    ds_read_b64_tr_b16 v[32:33], v6 offset:256
    ds_read_b64_tr_b16 v[34:35], v6 offset:4096
    v_mfma_f32_32x32x16_bf16 v[128:143], v[40:43], v[56:59], v[128:143]
    v_mfma_f32_32x32x16_bf16 v[144:159], v[44:47], v[56:59], v[144:159]
    s_waitcnt lgkmcnt(0)
    v_mfma_f32_32x32x16_bf16 v[64:79], v[24:27], v[16:19], v[64:79]
    ds_read_b128 v[40:43], v243 offset:1792
    ds_read_b64_tr_b16 v[48:49], v6 offset:15360
    v_mfma_f32_32x32x16_bf16 v[80:95], v[24:27], v[20:23], v[80:95]
    ds_read_b64_tr_b16 v[50:51], v6 offset:19200
    ds_read_b128 v[44:47], v243 offset:5632
    v_mfma_f32_32x32x16_bf16 v[96:111], v[28:31], v[16:19], v[96:111]
    ds_read_b64_tr_b16 v[52:53], v6 offset:15488
    ds_read_b64_tr_b16 v[54:55], v6 offset:19328
    v_mfma_f32_32x32x16_bf16 v[112:127], v[28:31], v[20:23], v[112:127]
    ds_read_b64_tr_b16 v[56:57], v6 offset:15616
    ds_read_b64_tr_b16 v[58:59], v6 offset:19456
    v_mfma_f32_32x32x16_bf16 v[128:143], v[16:19], v[32:35], v[128:143]
    s_add_u32 s46, s46, 1
    s_cmp_eq_u32 s46, 5
    s_cselect_b32 s41, -122880, s49
    s_cselect_b32 s46, 0, s46
    v_add_u32 v5, s41, v5
    v_add_u32 v6, s41, v6
    v_add_u32 v243, s41, v243
    v_mfma_f32_32x32x16_bf16 v[144:159], v[20:23], v[32:35], v[144:159]
    s_waitcnt lgkmcnt(0)
    s_barrier
    v_mfma_f32_32x32x16_bf16 v[64:79], v[48:51], v[40:43], v[64:79]
    v_mfma_f32_32x32x16_bf16 v[80:95], v[48:51], v[44:47], v[80:95]
    v_mfma_f32_32x32x16_bf16 v[96:111], v[52:55], v[40:43], v[96:111]
    v_mfma_f32_32x32x16_bf16 v[112:127], v[52:55], v[44:47], v[112:127]
    v_mfma_f32_32x32x16_bf16 v[128:143], v[40:43], v[56:59], v[128:143]
    v_mfma_f32_32x32x16_bf16 v[144:159], v[44:47], v[56:59], v[144:159]
.g1_doner:
.g1_qdone:
    s_waitcnt vmcnt(0) lgkmcnt(0)
    s_lshl_b32 s44, s14, 8
    s_add_u32 s44, s44, 161792
    v_and_b32 v253, 31, v1
    v_lshl_add_u32 v253, v253, 2, s44
    ds_write_b32 v253, v241
    ds_write_b32 v253, v247 offset:128
    v_lshl_add_u32 v253, v7, 4, s44
    s_waitcnt lgkmcnt(0)
    ds_read_b128 v[192:195], v253 offset:0
    ds_read_b128 v[196:199], v253 offset:32
    ds_read_b128 v[200:203], v253 offset:64
    ds_read_b128 v[204:207], v253 offset:96
    ds_read_b128 v[208:211], v253 offset:128
    ds_read_b128 v[212:215], v253 offset:160
    ds_read_b128 v[216:219], v253 offset:192
    ds_read_b128 v[220:223], v253 offset:224
    v_mov_b32 v18, 0
    v_mov_b32 v19, 0
    v_mov_b32 v22, 0
    v_mov_b32 v23, 0
    v_mov_b32 v56, v241
    v_mov_b32 v57, v241
    v_mov_b32 v58, v247
    v_mov_b32 v59, v247
    v_cmp_gt_u32 vcc, 32, v1
    s_mov_b32 s44, 0x01000100
    v_perm_b32 v16, v240, v240, s44
    v_perm_b32 v20, v246, v246, s44
    v_cndmask_b32 v17, 0, v240, vcc
    v_cndmask_b32 v21, 0, v246, vcc
    v_cndmask_b32 v16, 0, v16, vcc
    v_cndmask_b32 v20, 0, v20, vcc
    v_add_f32 v224, v224, v225
    v_add_f32 v226, v226, v227
    v_mov_b32 v26, 0
    v_add_f32 v224, v224, v226
    v_mov_b32 v27, 0
    v_add_f32 v228, v228, v229
    v_add_f32 v230, v230, v231
    v_mov_b32 v30, 0
    v_add_f32 v228, v228, v230
    v_mov_b32 v31, 0
    v_add_f32 v232, v232, v233
    v_add_f32 v234, v234, v235
    v_mov_b32 v34, 0
    v_add_f32 v232, v232, v234
    v_mov_b32 v35, 0
    v_mov_b32 v225, v224
    v_mov_b32 v229, v228
    v_mov_b32 v233, v232
    v_permlane32_swap_b32 v224, v225
    v_permlane32_swap_b32 v228, v229
    v_permlane32_swap_b32 v232, v233
    v_add_f32 v224, v224, v225
    v_add_f32 v228, v228, v229
    v_add_f32 v232, v232, v233
    v_cvt_pk_bf16_f32 v225, v224, v224
    v_cvt_pk_bf16_f32 v229, v228, v228
    v_cvt_pk_bf16_f32 v233, v232, v232
    v_lshlrev_b32 v225, 16, v225
    v_lshlrev_b32 v229, 16, v229
    v_lshlrev_b32 v233, 16, v233
    v_sub_f32 v224, v224, v225
    v_sub_f32 v228, v228, v229
    v_sub_f32 v232, v232, v233
    v_cvt_pk_bf16_f32 v226, v224, v224
    v_cvt_pk_bf16_f32 v230, v228, v228
    v_cvt_pk_bf16_f32 v234, v232, v232
    v_lshlrev_b32 v226, 16, v226
    v_lshlrev_b32 v230, 16, v230
    v_lshlrev_b32 v234, 16, v234
    v_sub_f32 v224, v224, v226
    v_sub_f32 v228, v228, v230
    v_sub_f32 v232, v232, v234
    v_cvt_pk_bf16_f32 v24, v225, v226
    v_cvt_pk_bf16_f32 v25, v224, 0
    v_cvt_pk_bf16_f32 v28, v229, v230
    v_cvt_pk_bf16_f32 v29, v228, 0
    v_cvt_pk_bf16_f32 v32, v233, v234
    v_cvt_pk_bf16_f32 v33, v232, 0
    v_mfma_f32_32x32x16_bf16 v[64:79], v[24:27], v[16:19], v[64:79]
    v_mfma_f32_32x32x16_bf16 v[80:95], v[24:27], v[20:23], v[80:95]
    v_mfma_f32_32x32x16_bf16 v[96:111], v[28:31], v[16:19], v[96:111]
    v_mfma_f32_32x32x16_bf16 v[112:127], v[28:31], v[20:23], v[112:127]
    v_mfma_f32_32x32x16_bf16 v[128:143], v[16:19], v[32:35], v[128:143]
    v_mfma_f32_32x32x16_bf16 v[144:159], v[20:23], v[32:35], v[144:159]
    s_mul_i32 s44, s14, 8704
    v_and_b32 v14, 31, v1
    v_mul_u32_u24 v14, 136, v14
    v_lshl_add_u32 v14, v7, 3, v14
    v_add_u32 v14, s44, v14
    v_mul_u32_u24 v15, 136, v12
    v_add3_u32 v15, v15, v9, s44
    s_mov_b32 s55, 0x3fb8aa3b
    s_waitcnt lgkmcnt(0)
    v_pk_mul_f32 v[96:97], v[96:97], v[56:57]
    v_pk_mul_f32 v[98:99], v[98:99], v[56:57]
    v_pk_mul_f32 v[100:101], v[100:101], v[56:57]
    v_pk_mul_f32 v[102:103], v[102:103], v[56:57]
    v_pk_mul_f32 v[104:105], v[104:105], v[56:57]
    v_pk_mul_f32 v[106:107], v[106:107], v[56:57]
    v_pk_mul_f32 v[108:109], v[108:109], v[56:57]
    v_pk_mul_f32 v[110:111], v[110:111], v[56:57]
    v_pk_mul_f32 v[112:113], v[112:113], v[58:59]
    v_pk_mul_f32 v[114:115], v[114:115], v[58:59]
    v_pk_mul_f32 v[116:117], v[116:117], v[58:59]
    v_pk_mul_f32 v[118:119], v[118:119], v[58:59]
    v_pk_mul_f32 v[120:121], v[120:121], v[58:59]
    v_pk_mul_f32 v[122:123], v[122:123], v[58:59]
    v_pk_mul_f32 v[124:125], v[124:125], v[58:59]
    v_pk_mul_f32 v[126:127], v[126:127], v[58:59]
    v_pk_mul_f32 v[64:65], v[64:65], v[56:57]
    v_pk_mul_f32 v[66:67], v[66:67], v[56:57]
    v_pk_mul_f32 v[68:69], v[68:69], v[56:57]
    v_pk_mul_f32 v[70:71], v[70:71], v[56:57]
    v_pk_mul_f32 v[72:73], v[72:73], v[56:57]
    v_pk_mul_f32 v[74:75], v[74:75], v[56:57]
    v_pk_mul_f32 v[76:77], v[76:77], v[56:57]
    v_pk_mul_f32 v[78:79], v[78:79], v[56:57]
    v_pk_mul_f32 v[80:81], v[80:81], v[58:59]
    v_pk_mul_f32 v[82:83], v[82:83], v[58:59]
    v_pk_mul_f32 v[84:85], v[84:85], v[58:59]
    v_pk_mul_f32 v[86:87], v[86:87], v[58:59]
    v_pk_mul_f32 v[88:89], v[88:89], v[58:59]
    v_pk_mul_f32 v[90:91], v[90:91], v[58:59]
    v_pk_mul_f32 v[92:93], v[92:93], v[58:59]
    v_pk_mul_f32 v[94:95], v[94:95], v[58:59]
    v_pk_mul_f32 v[128:129], v[128:129], v[192:193]
    v_pk_mul_f32 v[130:131], v[130:131], v[194:195]
    v_pk_mul_f32 v[132:133], v[132:133], v[196:197]
    v_pk_mul_f32 v[134:135], v[134:135], v[198:199]
    v_pk_mul_f32 v[136:137], v[136:137], v[200:201]
    v_pk_mul_f32 v[138:139], v[138:139], v[202:203]
    v_pk_mul_f32 v[140:141], v[140:141], v[204:205]
    v_pk_mul_f32 v[142:143], v[142:143], v[206:207]
    v_pk_mul_f32 v[144:145], v[144:145], v[208:209]
    v_pk_mul_f32 v[146:147], v[146:147], v[210:211]
    v_pk_mul_f32 v[148:149], v[148:149], v[212:213]
    v_pk_mul_f32 v[150:151], v[150:151], v[214:215]
    v_pk_mul_f32 v[152:153], v[152:153], v[216:217]
    v_pk_mul_f32 v[154:155], v[154:155], v[218:219]
    v_pk_mul_f32 v[156:157], v[156:157], v[220:221]
    v_pk_mul_f32 v[158:159], v[158:159], v[222:223]
    v_cvt_pk_bf16_f32 v16, v96, v97
    v_cvt_pk_bf16_f32 v17, v98, v99
    v_cvt_pk_bf16_f32 v18, v100, v101
    v_cvt_pk_bf16_f32 v19, v102, v103
    v_cvt_pk_bf16_f32 v20, v104, v105
    v_cvt_pk_bf16_f32 v21, v106, v107
    v_cvt_pk_bf16_f32 v22, v108, v109
    v_cvt_pk_bf16_f32 v23, v110, v111
    v_cvt_pk_bf16_f32 v24, v112, v113
    v_cvt_pk_bf16_f32 v25, v114, v115
    v_cvt_pk_bf16_f32 v26, v116, v117
    v_cvt_pk_bf16_f32 v27, v118, v119
    v_cvt_pk_bf16_f32 v28, v120, v121
    v_cvt_pk_bf16_f32 v29, v122, v123
    v_cvt_pk_bf16_f32 v30, v124, v125
    v_cvt_pk_bf16_f32 v31, v126, v127
    v_cvt_pk_bf16_f32 v48, v64, v65
    v_cvt_pk_bf16_f32 v49, v66, v67
    v_cvt_pk_bf16_f32 v50, v68, v69
    v_cvt_pk_bf16_f32 v51, v70, v71
    v_cvt_pk_bf16_f32 v52, v72, v73
    v_cvt_pk_bf16_f32 v53, v74, v75
    v_cvt_pk_bf16_f32 v54, v76, v77
    v_cvt_pk_bf16_f32 v55, v78, v79
    v_cvt_pk_bf16_f32 v56, v80, v81
    v_cvt_pk_bf16_f32 v57, v82, v83
    v_cvt_pk_bf16_f32 v58, v84, v85
    v_cvt_pk_bf16_f32 v59, v86, v87
    v_cvt_pk_bf16_f32 v60, v88, v89
    v_cvt_pk_bf16_f32 v61, v90, v91
    v_cvt_pk_bf16_f32 v62, v92, v93
    v_cvt_pk_bf16_f32 v63, v94, v95
    v_mfma_f32_32x32x16_bf16 v[64:79], v[160:163], v[16:19], 0
    v_mfma_f32_32x32x16_bf16 v[64:79], v[164:167], v[20:23], v[64:79]
    v_mfma_f32_32x32x16_bf16 v[80:95], v[160:163], v[24:27], 0
    v_mfma_f32_32x32x16_bf16 v[80:95], v[164:167], v[28:31], v[80:95]
    v_mfma_f32_32x32x16_bf16 v[96:111], v[160:163], v[48:51], 0
    v_mfma_f32_32x32x16_bf16 v[96:111], v[164:167], v[52:55], v[96:111]
    v_mfma_f32_32x32x16_bf16 v[112:127], v[160:163], v[56:59], 0
    v_mfma_f32_32x32x16_bf16 v[112:127], v[164:167], v[60:63], v[112:127]
    v_cvt_pk_bf16_f32 v32, v128, v129
    v_cvt_pk_bf16_f32 v33, v130, v131
    v_cvt_pk_bf16_f32 v34, v132, v133
    v_cvt_pk_bf16_f32 v35, v134, v135
    v_cvt_pk_bf16_f32 v36, v136, v137
    v_cvt_pk_bf16_f32 v37, v138, v139
    v_cvt_pk_bf16_f32 v38, v140, v141
    v_cvt_pk_bf16_f32 v39, v142, v143
    v_cvt_pk_bf16_f32 v40, v144, v145
    v_cvt_pk_bf16_f32 v41, v146, v147
    v_cvt_pk_bf16_f32 v42, v148, v149
    v_cvt_pk_bf16_f32 v43, v150, v151
    v_cvt_pk_bf16_f32 v44, v152, v153
    v_cvt_pk_bf16_f32 v45, v154, v155
    v_cvt_pk_bf16_f32 v46, v156, v157
    v_cvt_pk_bf16_f32 v47, v158, v159
    s_barrier
    v_cvt_pk_bf16_f32 v128, v64, v65
    v_cvt_pk_bf16_f32 v129, v66, v67
    v_cvt_pk_bf16_f32 v130, v68, v69
    v_cvt_pk_bf16_f32 v131, v70, v71
    v_cvt_pk_bf16_f32 v132, v72, v73
    v_cvt_pk_bf16_f32 v133, v74, v75
    v_cvt_pk_bf16_f32 v134, v76, v77
    v_cvt_pk_bf16_f32 v135, v78, v79
    v_lshlrev_b32 v64, 16, v128
    v_and_b32 v65, s47, v128
    v_lshlrev_b32 v66, 16, v129
    v_and_b32 v67, s47, v129
    v_lshlrev_b32 v68, 16, v130
    v_and_b32 v69, s47, v130
    v_lshlrev_b32 v70, 16, v131
    v_and_b32 v71, s47, v131
    v_lshlrev_b32 v72, 16, v132
    v_and_b32 v73, s47, v132
    v_lshlrev_b32 v74, 16, v133
    v_and_b32 v75, s47, v133
    v_lshlrev_b32 v76, 16, v134
    v_and_b32 v77, s47, v134
    v_lshlrev_b32 v78, 16, v135
    v_and_b32 v79, s47, v135
    v_max3_f32 v168, v64, v65, v66
    v_min3_f32 v169, v64, v65, v66
    v_max3_f32 v170, v67, v68, v69
    v_min3_f32 v171, v67, v68, v69
    v_max3_f32 v168, v168, v70, v71
    v_min3_f32 v169, v169, v70, v71
    v_max3_f32 v170, v170, v72, v73
    v_min3_f32 v171, v171, v72, v73
    v_max3_f32 v168, v168, v74, v75
    v_min3_f32 v169, v169, v74, v75
    v_max3_f32 v170, v170, v76, v77
    v_min3_f32 v171, v171, v76, v77
    v_max3_f32 v168, v168, v78, v79
    v_min3_f32 v169, v169, v78, v79
    v_max_f32 v168, v168, v170
    v_min_f32 v169, v169, v171
    v_mov_b32 v170, v168
    v_mov_b32 v171, v169
    s_nop 0
    v_permlane32_swap_b32 v168, v170
    v_permlane32_swap_b32 v169, v171
    v_max_f32 v168, v168, v170
    v_min_f32 v169, v169, v171
    v_mul_f32 v168, s55, v168
    v_mul_f32 v169, s55, v169
    v_pk_fma_f32 v[128:129], v[64:65], s[54:55], v[168:169] op_sel:[0,1,0] op_sel_hi:[1,1,0] neg_lo:[0,0,1] neg_hi:[0,0,1]
    v_pk_fma_f32 v[144:145], v[64:65], s[54:55], v[168:169] op_sel:[0,1,1] op_sel_hi:[1,1,1] neg_lo:[1,0,0] neg_hi:[1,0,0]
    v_pk_fma_f32 v[130:131], v[66:67], s[54:55], v[168:169] op_sel:[0,1,0] op_sel_hi:[1,1,0] neg_lo:[0,0,1] neg_hi:[0,0,1]
    v_pk_fma_f32 v[146:147], v[66:67], s[54:55], v[168:169] op_sel:[0,1,1] op_sel_hi:[1,1,1] neg_lo:[1,0,0] neg_hi:[1,0,0]
    v_pk_fma_f32 v[132:133], v[68:69], s[54:55], v[168:169] op_sel:[0,1,0] op_sel_hi:[1,1,0] neg_lo:[0,0,1] neg_hi:[0,0,1]
    v_pk_fma_f32 v[148:149], v[68:69], s[54:55], v[168:169] op_sel:[0,1,1] op_sel_hi:[1,1,1] neg_lo:[1,0,0] neg_hi:[1,0,0]
    v_pk_fma_f32 v[134:135], v[70:71], s[54:55], v[168:169] op_sel:[0,1,0] op_sel_hi:[1,1,0] neg_lo:[0,0,1] neg_hi:[0,0,1]
    v_pk_fma_f32 v[150:151], v[70:71], s[54:55], v[168:169] op_sel:[0,1,1] op_sel_hi:[1,1,1] neg_lo:[1,0,0] neg_hi:[1,0,0]
    v_pk_fma_f32 v[136:137], v[72:73], s[54:55], v[168:169] op_sel:[0,1,0] op_sel_hi:[1,1,0] neg_lo:[0,0,1] neg_hi:[0,0,1]
    v_pk_fma_f32 v[152:153], v[72:73], s[54:55], v[168:169] op_sel:[0,1,1] op_sel_hi:[1,1,1] neg_lo:[1,0,0] neg_hi:[1,0,0]
    v_pk_fma_f32 v[138:139], v[74:75], s[54:55], v[168:169] op_sel:[0,1,0] op_sel_hi:[1,1,0] neg_lo:[0,0,1] neg_hi:[0,0,1]
    v_pk_fma_f32 v[154:155], v[74:75], s[54:55], v[168:169] op_sel:[0,1,1] op_sel_hi:[1,1,1] neg_lo:[1,0,0] neg_hi:[1,0,0]
    v_pk_fma_f32 v[140:141], v[76:77], s[54:55], v[168:169] op_sel:[0,1,0] op_sel_hi:[1,1,0] neg_lo:[0,0,1] neg_hi:[0,0,1]
    v_pk_fma_f32 v[156:157], v[76:77], s[54:55], v[168:169] op_sel:[0,1,1] op_sel_hi:[1,1,1] neg_lo:[1,0,0] neg_hi:[1,0,0]
    v_pk_fma_f32 v[142:143], v[78:79], s[54:55], v[168:169] op_sel:[0,1,0] op_sel_hi:[1,1,0] neg_lo:[0,0,1] neg_hi:[0,0,1]
    v_pk_fma_f32 v[158:159], v[78:79], s[54:55], v[168:169] op_sel:[0,1,1] op_sel_hi:[1,1,1] neg_lo:[1,0,0] neg_hi:[1,0,0]
    v_exp_f32 v128, v128
    v_exp_f32 v144, v144
    v_exp_f32 v129, v129
    v_exp_f32 v145, v145
    v_exp_f32 v130, v130
    v_exp_f32 v146, v146
    v_exp_f32 v131, v131
    v_exp_f32 v147, v147
    v_exp_f32 v132, v132
    v_exp_f32 v148, v148
    v_exp_f32 v133, v133
    v_exp_f32 v149, v149
    v_exp_f32 v134, v134
    v_exp_f32 v150, v150
    v_exp_f32 v135, v135
    v_exp_f32 v151, v151
    v_exp_f32 v136, v136
    v_exp_f32 v152, v152
    v_exp_f32 v137, v137
    v_exp_f32 v153, v153
    v_exp_f32 v138, v138
    v_exp_f32 v154, v154
    v_exp_f32 v139, v139
    v_exp_f32 v155, v155
    v_exp_f32 v140, v140
    v_exp_f32 v156, v156
    v_exp_f32 v141, v141
    v_exp_f32 v157, v157
    v_exp_f32 v142, v142
    v_exp_f32 v158, v158
    v_exp_f32 v143, v143
    v_exp_f32 v159, v159
    v_pk_add_f32 v[168:169], v[128:129], v[130:131]
    v_pk_add_f32 v[170:171], v[144:145], v[146:147]
    v_pk_add_f32 v[172:173], v[132:133], v[134:135]
    v_pk_add_f32 v[174:175], v[148:149], v[150:151]
    v_pk_add_f32 v[168:169], v[168:169], v[136:137]
    v_pk_add_f32 v[170:171], v[170:171], v[152:153]
    v_pk_add_f32 v[172:173], v[172:173], v[138:139]
    v_pk_add_f32 v[174:175], v[174:175], v[154:155]
    v_pk_add_f32 v[168:169], v[168:169], v[140:141]
    v_pk_add_f32 v[170:171], v[170:171], v[156:157]
    v_pk_add_f32 v[172:173], v[172:173], v[142:143]
    v_pk_add_f32 v[174:175], v[174:175], v[158:159]
    v_pk_add_f32 v[168:169], v[168:169], v[172:173]
    v_pk_add_f32 v[170:171], v[170:171], v[174:175]
    v_add_f32 v168, v168, v169
    v_add_f32 v169, v170, v171
    v_mov_b32 v170, v168
    v_mov_b32 v171, v169
    s_nop 0
    v_permlane32_swap_b32 v168, v170
    v_permlane32_swap_b32 v169, v171
    v_add_f32 v168, v168, v170
    v_add_f32 v169, v169, v171
    v_rcp_f32 v168, v168
    v_rcp_f32 v169, v169
    s_nop 0
    v_pk_mul_f32 v[128:129], v[128:129], v[168:169] op_sel:[0,0] op_sel_hi:[1,0]
    v_pk_mul_f32 v[144:145], v[144:145], v[168:169] op_sel:[0,1] op_sel_hi:[1,1]
    v_pk_mul_f32 v[130:131], v[130:131], v[168:169] op_sel:[0,0] op_sel_hi:[1,0]
    v_pk_mul_f32 v[146:147], v[146:147], v[168:169] op_sel:[0,1] op_sel_hi:[1,1]
    v_pk_mul_f32 v[132:133], v[132:133], v[168:169] op_sel:[0,0] op_sel_hi:[1,0]
    v_pk_mul_f32 v[148:149], v[148:149], v[168:169] op_sel:[0,1] op_sel_hi:[1,1]
    v_pk_mul_f32 v[134:135], v[134:135], v[168:169] op_sel:[0,0] op_sel_hi:[1,0]
    v_pk_mul_f32 v[150:151], v[150:151], v[168:169] op_sel:[0,1] op_sel_hi:[1,1]
    v_pk_mul_f32 v[136:137], v[136:137], v[168:169] op_sel:[0,0] op_sel_hi:[1,0]
    v_pk_mul_f32 v[152:153], v[152:153], v[168:169] op_sel:[0,1] op_sel_hi:[1,1]
    v_pk_mul_f32 v[138:139], v[138:139], v[168:169] op_sel:[0,0] op_sel_hi:[1,0]
    v_pk_mul_f32 v[154:155], v[154:155], v[168:169] op_sel:[0,1] op_sel_hi:[1,1]
    v_pk_mul_f32 v[140:141], v[140:141], v[168:169] op_sel:[0,0] op_sel_hi:[1,0]
    v_pk_mul_f32 v[156:157], v[156:157], v[168:169] op_sel:[0,1] op_sel_hi:[1,1]
    v_pk_mul_f32 v[142:143], v[142:143], v[168:169] op_sel:[0,0] op_sel_hi:[1,0]
    v_pk_mul_f32 v[158:159], v[158:159], v[168:169] op_sel:[0,1] op_sel_hi:[1,1]
    v_cvt_pk_bf16_f32 v176, v128, v129
    v_cvt_pk_bf16_f32 v177, v130, v131
    v_cvt_pk_bf16_f32 v178, v132, v133
    v_cvt_pk_bf16_f32 v179, v134, v135
    v_cvt_pk_bf16_f32 v180, v136, v137
    v_cvt_pk_bf16_f32 v181, v138, v139
    v_cvt_pk_bf16_f32 v182, v140, v141
    v_cvt_pk_bf16_f32 v183, v142, v143
    v_cvt_pk_bf16_f32 v184, v144, v145
    v_cvt_pk_bf16_f32 v185, v146, v147
    v_cvt_pk_bf16_f32 v186, v148, v149
    v_cvt_pk_bf16_f32 v187, v150, v151
    v_cvt_pk_bf16_f32 v188, v152, v153
    v_cvt_pk_bf16_f32 v189, v154, v155
    v_cvt_pk_bf16_f32 v190, v156, v157
    v_cvt_pk_bf16_f32 v191, v158, v159
    ds_write_b64 v14, v[176:177] offset:0
    ds_write_b64 v14, v[178:179] offset:16
    ds_write_b64 v14, v[180:181] offset:32
    ds_write_b64 v14, v[182:183] offset:48
    ds_write_b64 v14, v[184:185] offset:64
    ds_write_b64 v14, v[186:187] offset:80
    ds_write_b64 v14, v[188:189] offset:96
    ds_write_b64 v14, v[190:191] offset:112
    v_cvt_pk_bf16_f32 v128, v80, v81
    v_cvt_pk_bf16_f32 v129, v82, v83
    v_cvt_pk_bf16_f32 v130, v84, v85
    v_cvt_pk_bf16_f32 v131, v86, v87
    v_cvt_pk_bf16_f32 v132, v88, v89
    v_cvt_pk_bf16_f32 v133, v90, v91
    v_cvt_pk_bf16_f32 v134, v92, v93
    v_cvt_pk_bf16_f32 v135, v94, v95
    v_lshlrev_b32 v80, 16, v128
    v_and_b32 v81, s47, v128
    v_lshlrev_b32 v82, 16, v129
    v_and_b32 v83, s47, v129
    v_lshlrev_b32 v84, 16, v130
    v_and_b32 v85, s47, v130
    v_lshlrev_b32 v86, 16, v131
    v_and_b32 v87, s47, v131
    v_lshlrev_b32 v88, 16, v132
    v_and_b32 v89, s47, v132
    v_lshlrev_b32 v90, 16, v133
    v_and_b32 v91, s47, v133
    v_lshlrev_b32 v92, 16, v134
    v_and_b32 v93, s47, v134
    v_lshlrev_b32 v94, 16, v135
    v_and_b32 v95, s47, v135
    v_max3_f32 v168, v80, v81, v82
    v_min3_f32 v169, v80, v81, v82
    v_max3_f32 v170, v83, v84, v85
    v_min3_f32 v171, v83, v84, v85
    v_max3_f32 v168, v168, v86, v87
    v_min3_f32 v169, v169, v86, v87
    v_max3_f32 v170, v170, v88, v89
    v_min3_f32 v171, v171, v88, v89
    v_max3_f32 v168, v168, v90, v91
    v_min3_f32 v169, v169, v90, v91
    v_max3_f32 v170, v170, v92, v93
    v_min3_f32 v171, v171, v92, v93
    v_max3_f32 v168, v168, v94, v95
    v_min3_f32 v169, v169, v94, v95
    v_max_f32 v168, v168, v170
    v_min_f32 v169, v169, v171
    v_mov_b32 v170, v168
    v_mov_b32 v171, v169
    s_nop 0
    v_permlane32_swap_b32 v168, v170
    v_permlane32_swap_b32 v169, v171
    v_max_f32 v168, v168, v170
    v_min_f32 v169, v169, v171
    v_mul_f32 v168, s55, v168
    v_mul_f32 v169, s55, v169
    v_pk_fma_f32 v[128:129], v[80:81], s[54:55], v[168:169] op_sel:[0,1,0] op_sel_hi:[1,1,0] neg_lo:[0,0,1] neg_hi:[0,0,1]
    v_pk_fma_f32 v[144:145], v[80:81], s[54:55], v[168:169] op_sel:[0,1,1] op_sel_hi:[1,1,1] neg_lo:[1,0,0] neg_hi:[1,0,0]
    v_pk_fma_f32 v[130:131], v[82:83], s[54:55], v[168:169] op_sel:[0,1,0] op_sel_hi:[1,1,0] neg_lo:[0,0,1] neg_hi:[0,0,1]
    v_pk_fma_f32 v[146:147], v[82:83], s[54:55], v[168:169] op_sel:[0,1,1] op_sel_hi:[1,1,1] neg_lo:[1,0,0] neg_hi:[1,0,0]
    v_pk_fma_f32 v[132:133], v[84:85], s[54:55], v[168:169] op_sel:[0,1,0] op_sel_hi:[1,1,0] neg_lo:[0,0,1] neg_hi:[0,0,1]
    v_pk_fma_f32 v[148:149], v[84:85], s[54:55], v[168:169] op_sel:[0,1,1] op_sel_hi:[1,1,1] neg_lo:[1,0,0] neg_hi:[1,0,0]
    v_pk_fma_f32 v[134:135], v[86:87], s[54:55], v[168:169] op_sel:[0,1,0] op_sel_hi:[1,1,0] neg_lo:[0,0,1] neg_hi:[0,0,1]
    v_pk_fma_f32 v[150:151], v[86:87], s[54:55], v[168:169] op_sel:[0,1,1] op_sel_hi:[1,1,1] neg_lo:[1,0,0] neg_hi:[1,0,0]
    v_pk_fma_f32 v[136:137], v[88:89], s[54:55], v[168:169] op_sel:[0,1,0] op_sel_hi:[1,1,0] neg_lo:[0,0,1] neg_hi:[0,0,1]
    v_pk_fma_f32 v[152:153], v[88:89], s[54:55], v[168:169] op_sel:[0,1,1] op_sel_hi:[1,1,1] neg_lo:[1,0,0] neg_hi:[1,0,0]
    v_pk_fma_f32 v[138:139], v[90:91], s[54:55], v[168:169] op_sel:[0,1,0] op_sel_hi:[1,1,0] neg_lo:[0,0,1] neg_hi:[0,0,1]
    v_pk_fma_f32 v[154:155], v[90:91], s[54:55], v[168:169] op_sel:[0,1,1] op_sel_hi:[1,1,1] neg_lo:[1,0,0] neg_hi:[1,0,0]
    v_pk_fma_f32 v[140:141], v[92:93], s[54:55], v[168:169] op_sel:[0,1,0] op_sel_hi:[1,1,0] neg_lo:[0,0,1] neg_hi:[0,0,1]
    v_pk_fma_f32 v[156:157], v[92:93], s[54:55], v[168:169] op_sel:[0,1,1] op_sel_hi:[1,1,1] neg_lo:[1,0,0] neg_hi:[1,0,0]
    v_pk_fma_f32 v[142:143], v[94:95], s[54:55], v[168:169] op_sel:[0,1,0] op_sel_hi:[1,1,0] neg_lo:[0,0,1] neg_hi:[0,0,1]
    v_pk_fma_f32 v[158:159], v[94:95], s[54:55], v[168:169] op_sel:[0,1,1] op_sel_hi:[1,1,1] neg_lo:[1,0,0] neg_hi:[1,0,0]
    v_exp_f32 v128, v128
    v_exp_f32 v144, v144
    v_exp_f32 v129, v129
    v_exp_f32 v145, v145
    v_exp_f32 v130, v130
    v_exp_f32 v146, v146
    v_exp_f32 v131, v131
    v_exp_f32 v147, v147
    v_exp_f32 v132, v132
    v_exp_f32 v148, v148
    v_exp_f32 v133, v133
    v_exp_f32 v149, v149
    v_exp_f32 v134, v134
    v_exp_f32 v150, v150
    v_exp_f32 v135, v135
    v_exp_f32 v151, v151
    v_exp_f32 v136, v136
    v_exp_f32 v152, v152
    v_exp_f32 v137, v137
    v_exp_f32 v153, v153
    v_exp_f32 v138, v138
    v_exp_f32 v154, v154
    v_exp_f32 v139, v139
    v_exp_f32 v155, v155
    v_exp_f32 v140, v140
    v_exp_f32 v156, v156
    v_exp_f32 v141, v141
    v_exp_f32 v157, v157
    v_exp_f32 v142, v142
    v_exp_f32 v158, v158
    v_exp_f32 v143, v143
    v_exp_f32 v159, v159
    v_pk_add_f32 v[168:169], v[128:129], v[130:131]
    v_pk_add_f32 v[170:171], v[144:145], v[146:147]
    v_pk_add_f32 v[172:173], v[132:133], v[134:135]
    v_pk_add_f32 v[174:175], v[148:149], v[150:151]
    v_pk_add_f32 v[168:169], v[168:169], v[136:137]
    v_pk_add_f32 v[170:171], v[170:171], v[152:153]
    v_pk_add_f32 v[172:173], v[172:173], v[138:139]
    v_pk_add_f32 v[174:175], v[174:175], v[154:155]
    v_pk_add_f32 v[168:169], v[168:169], v[140:141]
    v_pk_add_f32 v[170:171], v[170:171], v[156:157]
    v_pk_add_f32 v[172:173], v[172:173], v[142:143]
    v_pk_add_f32 v[174:175], v[174:175], v[158:159]
    v_pk_add_f32 v[168:169], v[168:169], v[172:173]
    v_pk_add_f32 v[170:171], v[170:171], v[174:175]
    v_add_f32 v168, v168, v169
    v_add_f32 v169, v170, v171
    v_mov_b32 v170, v168
    v_mov_b32 v171, v169
    s_nop 0
    v_permlane32_swap_b32 v168, v170
    v_permlane32_swap_b32 v169, v171
    v_add_f32 v168, v168, v170
    v_add_f32 v169, v169, v171
    v_rcp_f32 v168, v168
    v_rcp_f32 v169, v169
    s_nop 0
    v_pk_mul_f32 v[128:129], v[128:129], v[168:169] op_sel:[0,0] op_sel_hi:[1,0]
    v_pk_mul_f32 v[144:145], v[144:145], v[168:169] op_sel:[0,1] op_sel_hi:[1,1]
    v_pk_mul_f32 v[130:131], v[130:131], v[168:169] op_sel:[0,0] op_sel_hi:[1,0]
    v_pk_mul_f32 v[146:147], v[146:147], v[168:169] op_sel:[0,1] op_sel_hi:[1,1]
    v_pk_mul_f32 v[132:133], v[132:133], v[168:169] op_sel:[0,0] op_sel_hi:[1,0]
    v_pk_mul_f32 v[148:149], v[148:149], v[168:169] op_sel:[0,1] op_sel_hi:[1,1]
    v_pk_mul_f32 v[134:135], v[134:135], v[168:169] op_sel:[0,0] op_sel_hi:[1,0]
    v_pk_mul_f32 v[150:151], v[150:151], v[168:169] op_sel:[0,1] op_sel_hi:[1,1]
    v_pk_mul_f32 v[136:137], v[136:137], v[168:169] op_sel:[0,0] op_sel_hi:[1,0]
    v_pk_mul_f32 v[152:153], v[152:153], v[168:169] op_sel:[0,1] op_sel_hi:[1,1]
    v_pk_mul_f32 v[138:139], v[138:139], v[168:169] op_sel:[0,0] op_sel_hi:[1,0]
    v_pk_mul_f32 v[154:155], v[154:155], v[168:169] op_sel:[0,1] op_sel_hi:[1,1]
    v_pk_mul_f32 v[140:141], v[140:141], v[168:169] op_sel:[0,0] op_sel_hi:[1,0]
    v_pk_mul_f32 v[156:157], v[156:157], v[168:169] op_sel:[0,1] op_sel_hi:[1,1]
    v_pk_mul_f32 v[142:143], v[142:143], v[168:169] op_sel:[0,0] op_sel_hi:[1,0]
    v_pk_mul_f32 v[158:159], v[158:159], v[168:169] op_sel:[0,1] op_sel_hi:[1,1]
    v_cvt_pk_bf16_f32 v192, v128, v129
    v_cvt_pk_bf16_f32 v193, v130, v131
    v_cvt_pk_bf16_f32 v194, v132, v133
    v_cvt_pk_bf16_f32 v195, v134, v135
    v_cvt_pk_bf16_f32 v196, v136, v137
    v_cvt_pk_bf16_f32 v197, v138, v139
    v_cvt_pk_bf16_f32 v198, v140, v141
    v_cvt_pk_bf16_f32 v199, v142, v143
    v_cvt_pk_bf16_f32 v200, v144, v145
    v_cvt_pk_bf16_f32 v201, v146, v147
    v_cvt_pk_bf16_f32 v202, v148, v149
    v_cvt_pk_bf16_f32 v203, v150, v151
    v_cvt_pk_bf16_f32 v204, v152, v153
    v_cvt_pk_bf16_f32 v205, v154, v155
    v_cvt_pk_bf16_f32 v206, v156, v157
    v_cvt_pk_bf16_f32 v207, v158, v159
    ds_write_b64 v14, v[192:193] offset:4352
    ds_write_b64 v14, v[194:195] offset:4368
    ds_write_b64 v14, v[196:197] offset:4384
    ds_write_b64 v14, v[198:199] offset:4400
    ds_write_b64 v14, v[200:201] offset:4416
    ds_write_b64 v14, v[202:203] offset:4432
    ds_write_b64 v14, v[204:205] offset:4448
    ds_write_b64 v14, v[206:207] offset:4464
    s_waitcnt lgkmcnt(0)
    ds_read_b64_tr_b16 v[128:129], v15 offset:0
    ds_read_b64_tr_b16 v[130:131], v15 offset:1088
    ds_read_b64_tr_b16 v[132:133], v15 offset:2176
    ds_read_b64_tr_b16 v[134:135], v15 offset:3264
    ds_read_b64_tr_b16 v[136:137], v15 offset:4352
    ds_read_b64_tr_b16 v[138:139], v15 offset:5440
    ds_read_b64_tr_b16 v[140:141], v15 offset:6528
    ds_read_b64_tr_b16 v[142:143], v15 offset:7616
    v_mov_b32 v168, 0
    v_mov_b32 v169, 0
    ds_read_b64_tr_b16 v[144:145], v15 offset:64
    ds_read_b64_tr_b16 v[146:147], v15 offset:1152
    ds_read_b64_tr_b16 v[148:149], v15 offset:2240
    ds_read_b64_tr_b16 v[150:151], v15 offset:3328
    ds_read_b64_tr_b16 v[152:153], v15 offset:4416
    ds_read_b64_tr_b16 v[154:155], v15 offset:5504
    ds_read_b64_tr_b16 v[156:157], v15 offset:6592
    ds_read_b64_tr_b16 v[158:159], v15 offset:7680
    s_waitcnt lgkmcnt(8)
    v_mfma_f32_32x32x16_bf16 v[224:239], v[128:131], v[32:35], 0
    v_dot2c_f32_bf16 v168, s56, v128
    v_dot2c_f32_bf16 v168, s56, v129
    v_dot2c_f32_bf16 v168, s56, v130
    v_dot2c_f32_bf16 v168, s56, v131
    v_mfma_f32_32x32x16_bf16 v[224:239], v[132:135], v[36:39], v[224:239]
    v_dot2c_f32_bf16 v168, s56, v132
    v_dot2c_f32_bf16 v168, s56, v133
    v_dot2c_f32_bf16 v168, s56, v134
    v_dot2c_f32_bf16 v168, s56, v135
    v_mfma_f32_32x32x16_bf16 v[224:239], v[136:139], v[40:43], v[224:239]
    v_dot2c_f32_bf16 v168, s56, v136
    v_dot2c_f32_bf16 v168, s56, v137
    v_dot2c_f32_bf16 v168, s56, v138
    v_dot2c_f32_bf16 v168, s56, v139
    v_mfma_f32_32x32x16_bf16 v[224:239], v[140:143], v[44:47], v[224:239]
    v_dot2c_f32_bf16 v168, s56, v140
    v_dot2c_f32_bf16 v168, s56, v141
    v_dot2c_f32_bf16 v168, s56, v142
    v_dot2c_f32_bf16 v168, s56, v143
    s_waitcnt lgkmcnt(0)
    v_mfma_f32_32x32x16_bf16 v[240:255], v[144:147], v[32:35], 0
    v_dot2c_f32_bf16 v169, s56, v144
    v_dot2c_f32_bf16 v169, s56, v145
    v_dot2c_f32_bf16 v169, s56, v146
    v_dot2c_f32_bf16 v169, s56, v147
    v_mfma_f32_32x32x16_bf16 v[240:255], v[148:151], v[36:39], v[240:255]
    v_dot2c_f32_bf16 v169, s56, v148
    v_dot2c_f32_bf16 v169, s56, v149
    v_dot2c_f32_bf16 v169, s56, v150
    v_dot2c_f32_bf16 v169, s56, v151
    v_mfma_f32_32x32x16_bf16 v[240:255], v[152:155], v[40:43], v[240:255]
    v_dot2c_f32_bf16 v169, s56, v152
    v_dot2c_f32_bf16 v169, s56, v153
    v_dot2c_f32_bf16 v169, s56, v154
    v_dot2c_f32_bf16 v169, s56, v155
    v_mfma_f32_32x32x16_bf16 v[240:255], v[156:159], v[44:47], v[240:255]
    v_dot2c_f32_bf16 v169, s56, v156
    v_dot2c_f32_bf16 v169, s56, v157
    v_dot2c_f32_bf16 v169, s56, v158
    v_dot2c_f32_bf16 v169, s56, v159
    s_nop 2
    v_permlane32_swap_b32 v168, v169
    v_add_f32 v168, v168, v169
    s_lshl_b32 s44, s14, 13
    v_add_u32 v14, s44, v2
    v_add_u32 v14, 69632, v14
    s_lshl_b32 s44, s14, 8
    v_lshlrev_b32 v13, 2, v1
    v_add_u32 v15, s44, v13
    v_add_u32 v15, 135168, v15
    ds_write_b32 v15, v168
    ds_write_b128 v14, v[224:227] offset:0
    ds_write_b128 v14, v[228:231] offset:1024
    ds_write_b128 v14, v[232:235] offset:2048
    ds_write_b128 v14, v[236:239] offset:3072
    ds_write_b128 v14, v[240:243] offset:4096
    ds_write_b128 v14, v[244:247] offset:5120
    ds_write_b128 v14, v[248:251] offset:6144
    ds_write_b128 v14, v[252:255] offset:7168
    s_lshl_b32 s44, s16, 15
    s_lshl_b32 s45, s15, 11
    s_add_u32 s44, s44, s45
    v_add_u32 v14, s44, v2
    v_add_u32 v14, 69632, v14
    s_lshl_b32 s44, s16, 10
    v_add_u32 v15, s44, v13
    v_add_u32 v15, 135168, v15
    s_lshl_b32 s57, s53, 16
    s_add_u32 s57, s57, s45
    s_add_u32 s57, s57, 25165824
    s_lshl_b32 s44, s17, 13
    s_add_u32 s58, s57, s44
    s_lshl_b32 s59, s53, 11
    s_add_u32 s59, s59, 27262976
    s_lshl_b32 s44, s17, 8
    s_add_u32 s60, s59, s44
    s_waitcnt lgkmcnt(0)
    s_barrier
    ds_read_b128 v[128:131], v14 offset:0
    ds_read_b128 v[132:135], v14 offset:1024
    ds_read_b128 v[136:139], v14 offset:8192
    ds_read_b128 v[140:143], v14 offset:9216
    ds_read_b128 v[144:147], v14 offset:16384
    ds_read_b128 v[148:151], v14 offset:17408
    ds_read_b128 v[152:155], v14 offset:24576
    ds_read_b128 v[156:159], v14 offset:25600
    ds_read_b32 v168, v15 offset:0
    ds_read_b32 v169, v15 offset:256
    ds_read_b32 v170, v15 offset:512
    ds_read_b32 v171, v15 offset:768
    s_waitcnt lgkmcnt(4)
    v_pk_add_f32 v[128:129], v[128:129], v[136:137]
    v_pk_add_f32 v[144:145], v[144:145], v[152:153]
    v_pk_add_f32 v[130:131], v[130:131], v[138:139]
    v_pk_add_f32 v[146:147], v[146:147], v[154:155]
    v_pk_add_f32 v[132:133], v[132:133], v[140:141]
    v_pk_add_f32 v[148:149], v[148:149], v[156:157]
    v_pk_add_f32 v[134:135], v[134:135], v[142:143]
    v_pk_add_f32 v[150:151], v[150:151], v[158:159]
    v_pk_add_f32 v[208:209], v[128:129], v[144:145]
    v_pk_add_f32 v[210:211], v[130:131], v[146:147]
    v_pk_add_f32 v[212:213], v[132:133], v[148:149]
    v_pk_add_f32 v[214:215], v[134:135], v[150:151]
    buffer_store_dwordx4 v[208:211], v2, s[28:31], s58 offen sc1
    buffer_store_dwordx4 v[212:215], v2, s[28:31], s58 offen offset:1024 sc1
    s_waitcnt lgkmcnt(0)
    v_add_f32 v168, v168, v169
    v_add_f32 v170, v170, v171
    v_add_f32 v216, v168, v170
    s_cmp_eq_u32 s15, 0
    s_cbranch_scc0 .g1_noz
    buffer_store_dword v216, v13, s[28:31], s60 offen sc1
.g1_noz:
    v_cvt_pk_bf16_f32 v128, v96, v97
    v_cvt_pk_bf16_f32 v129, v98, v99
    v_cvt_pk_bf16_f32 v130, v100, v101
    v_cvt_pk_bf16_f32 v131, v102, v103
    v_cvt_pk_bf16_f32 v132, v104, v105
    v_cvt_pk_bf16_f32 v133, v106, v107
    v_cvt_pk_bf16_f32 v134, v108, v109
    v_cvt_pk_bf16_f32 v135, v110, v111
    v_lshlrev_b32 v96, 16, v128
    v_and_b32 v97, s47, v128
    v_lshlrev_b32 v98, 16, v129
    v_and_b32 v99, s47, v129
    v_lshlrev_b32 v100, 16, v130
    v_and_b32 v101, s47, v130
    v_lshlrev_b32 v102, 16, v131
    v_and_b32 v103, s47, v131
    v_lshlrev_b32 v104, 16, v132
    v_and_b32 v105, s47, v132
    v_lshlrev_b32 v106, 16, v133
    v_and_b32 v107, s47, v133
    v_lshlrev_b32 v108, 16, v134
    v_and_b32 v109, s47, v134
    v_lshlrev_b32 v110, 16, v135
    v_and_b32 v111, s47, v135
    v_max3_f32 v168, v96, v97, v98
    v_min3_f32 v169, v96, v97, v98
    v_max3_f32 v170, v99, v100, v101
    v_min3_f32 v171, v99, v100, v101
    v_max3_f32 v168, v168, v102, v103
    v_min3_f32 v169, v169, v102, v103
    v_max3_f32 v170, v170, v104, v105
    v_min3_f32 v171, v171, v104, v105
    v_max3_f32 v168, v168, v106, v107
    v_min3_f32 v169, v169, v106, v107
    v_max3_f32 v170, v170, v108, v109
    v_min3_f32 v171, v171, v108, v109
    v_max3_f32 v168, v168, v110, v111
    v_min3_f32 v169, v169, v110, v111
    v_max_f32 v168, v168, v170
    v_min_f32 v169, v169, v171
    v_mov_b32 v170, v168
    v_mov_b32 v171, v169
    s_nop 0
    v_permlane32_swap_b32 v168, v170
    v_permlane32_swap_b32 v169, v171
    v_max_f32 v168, v168, v170
    v_min_f32 v169, v169, v171
    v_mul_f32 v168, s55, v168
    v_mul_f32 v169, s55, v169
    v_pk_fma_f32 v[128:129], v[96:97], s[54:55], v[168:169] op_sel:[0,1,0] op_sel_hi:[1,1,0] neg_lo:[0,0,1] neg_hi:[0,0,1]
    v_pk_fma_f32 v[144:145], v[96:97], s[54:55], v[168:169] op_sel:[0,1,1] op_sel_hi:[1,1,1] neg_lo:[1,0,0] neg_hi:[1,0,0]
    v_pk_fma_f32 v[130:131], v[98:99], s[54:55], v[168:169] op_sel:[0,1,0] op_sel_hi:[1,1,0] neg_lo:[0,0,1] neg_hi:[0,0,1]
    v_pk_fma_f32 v[146:147], v[98:99], s[54:55], v[168:169] op_sel:[0,1,1] op_sel_hi:[1,1,1] neg_lo:[1,0,0] neg_hi:[1,0,0]
    v_pk_fma_f32 v[132:133], v[100:101], s[54:55], v[168:169] op_sel:[0,1,0] op_sel_hi:[1,1,0] neg_lo:[0,0,1] neg_hi:[0,0,1]
    v_pk_fma_f32 v[148:149], v[100:101], s[54:55], v[168:169] op_sel:[0,1,1] op_sel_hi:[1,1,1] neg_lo:[1,0,0] neg_hi:[1,0,0]
    v_pk_fma_f32 v[134:135], v[102:103], s[54:55], v[168:169] op_sel:[0,1,0] op_sel_hi:[1,1,0] neg_lo:[0,0,1] neg_hi:[0,0,1]
    v_pk_fma_f32 v[150:151], v[102:103], s[54:55], v[168:169] op_sel:[0,1,1] op_sel_hi:[1,1,1] neg_lo:[1,0,0] neg_hi:[1,0,0]
    v_pk_fma_f32 v[136:137], v[104:105], s[54:55], v[168:169] op_sel:[0,1,0] op_sel_hi:[1,1,0] neg_lo:[0,0,1] neg_hi:[0,0,1]
    v_pk_fma_f32 v[152:153], v[104:105], s[54:55], v[168:169] op_sel:[0,1,1] op_sel_hi:[1,1,1] neg_lo:[1,0,0] neg_hi:[1,0,0]
    v_pk_fma_f32 v[138:139], v[106:107], s[54:55], v[168:169] op_sel:[0,1,0] op_sel_hi:[1,1,0] neg_lo:[0,0,1] neg_hi:[0,0,1]
    v_pk_fma_f32 v[154:155], v[106:107], s[54:55], v[168:169] op_sel:[0,1,1] op_sel_hi:[1,1,1] neg_lo:[1,0,0] neg_hi:[1,0,0]
    v_pk_fma_f32 v[140:141], v[108:109], s[54:55], v[168:169] op_sel:[0,1,0] op_sel_hi:[1,1,0] neg_lo:[0,0,1] neg_hi:[0,0,1]
    v_pk_fma_f32 v[156:157], v[108:109], s[54:55], v[168:169] op_sel:[0,1,1] op_sel_hi:[1,1,1] neg_lo:[1,0,0] neg_hi:[1,0,0]
    v_pk_fma_f32 v[142:143], v[110:111], s[54:55], v[168:169] op_sel:[0,1,0] op_sel_hi:[1,1,0] neg_lo:[0,0,1] neg_hi:[0,0,1]
    v_pk_fma_f32 v[158:159], v[110:111], s[54:55], v[168:169] op_sel:[0,1,1] op_sel_hi:[1,1,1] neg_lo:[1,0,0] neg_hi:[1,0,0]
    v_exp_f32 v128, v128
    v_exp_f32 v144, v144
    v_exp_f32 v129, v129
    v_exp_f32 v145, v145
    v_exp_f32 v130, v130
    v_exp_f32 v146, v146
    v_exp_f32 v131, v131
    v_exp_f32 v147, v147
    v_exp_f32 v132, v132
    v_exp_f32 v148, v148
    v_exp_f32 v133, v133
    v_exp_f32 v149, v149
    v_exp_f32 v134, v134
    v_exp_f32 v150, v150
    v_exp_f32 v135, v135
    v_exp_f32 v151, v151
    v_exp_f32 v136, v136
    v_exp_f32 v152, v152
    v_exp_f32 v137, v137
    v_exp_f32 v153, v153
    v_exp_f32 v138, v138
    v_exp_f32 v154, v154
    v_exp_f32 v139, v139
    v_exp_f32 v155, v155
    v_exp_f32 v140, v140
    v_exp_f32 v156, v156
    v_exp_f32 v141, v141
    v_exp_f32 v157, v157
    v_exp_f32 v142, v142
    v_exp_f32 v158, v158
    v_exp_f32 v143, v143
    v_exp_f32 v159, v159
    v_pk_add_f32 v[168:169], v[128:129], v[130:131]
    v_pk_add_f32 v[170:171], v[144:145], v[146:147]
    v_pk_add_f32 v[172:173], v[132:133], v[134:135]
    v_pk_add_f32 v[174:175], v[148:149], v[150:151]
    v_pk_add_f32 v[168:169], v[168:169], v[136:137]
    v_pk_add_f32 v[170:171], v[170:171], v[152:153]
    v_pk_add_f32 v[172:173], v[172:173], v[138:139]
    v_pk_add_f32 v[174:175], v[174:175], v[154:155]
    v_pk_add_f32 v[168:169], v[168:169], v[140:141]
    v_pk_add_f32 v[170:171], v[170:171], v[156:157]
    v_pk_add_f32 v[172:173], v[172:173], v[142:143]
    v_pk_add_f32 v[174:175], v[174:175], v[158:159]
    v_pk_add_f32 v[168:169], v[168:169], v[172:173]
    v_pk_add_f32 v[170:171], v[170:171], v[174:175]
    v_add_f32 v168, v168, v169
    v_add_f32 v169, v170, v171
    v_mov_b32 v170, v168
    v_mov_b32 v171, v169
    s_nop 0
    v_permlane32_swap_b32 v168, v170
    v_permlane32_swap_b32 v169, v171
    v_add_f32 v168, v168, v170
    v_add_f32 v169, v169, v171
    v_rcp_f32 v168, v168
    v_rcp_f32 v169, v169
    s_nop 0
    v_pk_mul_f32 v[128:129], v[128:129], v[168:169] op_sel:[0,0] op_sel_hi:[1,0]
    v_pk_mul_f32 v[144:145], v[144:145], v[168:169] op_sel:[0,1] op_sel_hi:[1,1]
    v_pk_mul_f32 v[130:131], v[130:131], v[168:169] op_sel:[0,0] op_sel_hi:[1,0]
    v_pk_mul_f32 v[146:147], v[146:147], v[168:169] op_sel:[0,1] op_sel_hi:[1,1]
    v_pk_mul_f32 v[132:133], v[132:133], v[168:169] op_sel:[0,0] op_sel_hi:[1,0]
    v_pk_mul_f32 v[148:149], v[148:149], v[168:169] op_sel:[0,1] op_sel_hi:[1,1]
    v_pk_mul_f32 v[134:135], v[134:135], v[168:169] op_sel:[0,0] op_sel_hi:[1,0]
    v_pk_mul_f32 v[150:151], v[150:151], v[168:169] op_sel:[0,1] op_sel_hi:[1,1]
    v_pk_mul_f32 v[136:137], v[136:137], v[168:169] op_sel:[0,0] op_sel_hi:[1,0]
    v_pk_mul_f32 v[152:153], v[152:153], v[168:169] op_sel:[0,1] op_sel_hi:[1,1]
    v_pk_mul_f32 v[138:139], v[138:139], v[168:169] op_sel:[0,0] op_sel_hi:[1,0]
    v_pk_mul_f32 v[154:155], v[154:155], v[168:169] op_sel:[0,1] op_sel_hi:[1,1]
    v_pk_mul_f32 v[140:141], v[140:141], v[168:169] op_sel:[0,0] op_sel_hi:[1,0]
    v_pk_mul_f32 v[156:157], v[156:157], v[168:169] op_sel:[0,1] op_sel_hi:[1,1]
    v_pk_mul_f32 v[142:143], v[142:143], v[168:169] op_sel:[0,0] op_sel_hi:[1,0]
    v_pk_mul_f32 v[158:159], v[158:159], v[168:169] op_sel:[0,1] op_sel_hi:[1,1]
    v_cvt_pk_bf16_f32 v176, v128, v129
    v_cvt_pk_bf16_f32 v177, v130, v131
    v_cvt_pk_bf16_f32 v178, v132, v133
    v_cvt_pk_bf16_f32 v179, v134, v135
    v_cvt_pk_bf16_f32 v180, v136, v137
    v_cvt_pk_bf16_f32 v181, v138, v139
    v_cvt_pk_bf16_f32 v182, v140, v141
    v_cvt_pk_bf16_f32 v183, v142, v143
    v_cvt_pk_bf16_f32 v184, v144, v145
    v_cvt_pk_bf16_f32 v185, v146, v147
    v_cvt_pk_bf16_f32 v186, v148, v149
    v_cvt_pk_bf16_f32 v187, v150, v151
    v_cvt_pk_bf16_f32 v188, v152, v153
    v_cvt_pk_bf16_f32 v189, v154, v155
    v_cvt_pk_bf16_f32 v190, v156, v157
    v_cvt_pk_bf16_f32 v191, v158, v159
    s_waitcnt vmcnt(0)
    s_barrier
    s_lshl_b32 s61, s18, 7
    s_add_u32 s61, s61, 28311552
    s_cmp_eq_u32 s14, 0
    s_cbranch_scc0 .g1_nofl
    s_lshl_b32 s44, s17, 3
    v_mov_b32 v14, s44
    v_mov_b32 v220, s76
    v_mov_b32 v221, s77
    s_mov_b64 exec, 1
    buffer_store_dwordx2 v[220:221], v14, s[28:31], s61 offen sc1
    s_mov_b64 exec, -1
.g1_nofl:
    s_cmp_eq_u32 s16, 0
    s_cbranch_scc1 .g1_nowf
    s_and_b32 s39, s2, 3
    s_sub_u32 s36, s39, 1
    s_mul_i32 s36, s36, 2424832
    s_mov_b32 s24, s64
    s_mov_b32 s25, s65
    s_mov_b32 s26, 7340032
    s_mov_b32 s27, 0x20000
    s_mul_i32 s40, s39, 5
    s_lshl_b32 s40, 0x3f, s40
    s_lshr_b32 s40, s40, 5
    s_mov_b32 s41, 0
    s_mov_b32 s38, 28333056
    s_cmp_eq_u32 s39, 0
    s_cbranch_scc0 .g1_wfq
    s_mov_b32 s36, 0
    s_mov_b32 s40, 0xffff
    s_mov_b32 s38, 28332032
    s_mov_b32 s24, s62
    s_mov_b32 s25, s63
    s_mov_b32 s26, 2097152
    s_mov_b32 s27, 0x20000
.g1_wfq:
    v_lshrrev_b32 v5, 4, v1
    v_bfe_u32 v6, v1, 2, 2
    v_xor_b32 v6, v6, v5
    v_lshlrev_b32 v3, 11, v5
    v_lshl_add_u32 v3, v6, 6, v3
    v_and_b32 v6, 3, v1
    v_lshl_add_u32 v3, v6, 4, v3
    s_lshl_b32 s37, s15, 14
    s_lshr_b32 s39, s2, 5
    s_lshl_b32 s39, s39, 8
    s_add_u32 s37, s37, s39
    v_add_u32 v3, s37, v3
    v_add_u32 v4, 7168, v3
    s_mul_i32 s37, s15, 6144
    s_bfe_u32 s39, s2, 0x10002
    s_lshl_b32 s39, s39, 9
    s_add_u32 s38, s38, s39
    s_bfe_u32 s39, s2, 0x20003
    s_lshl_b32 s39, s39, 7
    s_add_u32 s38, s38, s39
    v_lshlrev_b32 v5, 3, v1
    v_mov_b32 v10, 0
    v_mov_b32 v11, 0
    s_add_u32 m0, s37, 0
    s_nop 0
    buffer_load_dwordx4 v3, s[24:27], s36 offen lds
    buffer_load_dwordx4 v4, s[24:27], s36 offen offset:1024 lds
    s_add_u32 s36, s36, 65536
    s_add_u32 m0, s37, 24576
    s_nop 0
    buffer_load_dwordx4 v3, s[24:27], s36 offen lds
    buffer_load_dwordx4 v4, s[24:27], s36 offen offset:1024 lds
    s_add_u32 s36, s36, 65536
    s_add_u32 m0, s37, 49152
    s_nop 0
    buffer_load_dwordx4 v3, s[24:27], s36 offen lds
    buffer_load_dwordx4 v4, s[24:27], s36 offen offset:1024 lds
    s_add_u32 s36, s36, 65536
    s_add_u32 m0, s37, 73728
    s_nop 0
    buffer_load_dwordx4 v3, s[24:27], s36 offen lds
    buffer_load_dwordx4 v4, s[24:27], s36 offen offset:1024 lds
    s_add_u32 s36, s36, 65536
    s_add_u32 m0, s37, 98304
    s_nop 0
    buffer_load_dwordx4 v3, s[24:27], s36 offen lds
    buffer_load_dwordx4 v4, s[24:27], s36 offen offset:1024 lds
    s_add_u32 s36, s36, 65536
    s_add_u32 m0, s37, 122880
    s_nop 0
    buffer_load_dwordx4 v3, s[24:27], s36 offen lds
    buffer_load_dwordx4 v4, s[24:27], s36 offen offset:1024 lds
    s_add_u32 s36, s36, 65536
.g1_nowf:
    v_cvt_pk_bf16_f32 v128, v112, v113
    v_cvt_pk_bf16_f32 v129, v114, v115
    v_cvt_pk_bf16_f32 v130, v116, v117
    v_cvt_pk_bf16_f32 v131, v118, v119
    v_cvt_pk_bf16_f32 v132, v120, v121
    v_cvt_pk_bf16_f32 v133, v122, v123
    v_cvt_pk_bf16_f32 v134, v124, v125
    v_cvt_pk_bf16_f32 v135, v126, v127
    v_lshlrev_b32 v112, 16, v128
    v_and_b32 v113, s47, v128
    v_lshlrev_b32 v114, 16, v129
    v_and_b32 v115, s47, v129
    v_lshlrev_b32 v116, 16, v130
    v_and_b32 v117, s47, v130
    v_lshlrev_b32 v118, 16, v131
    v_and_b32 v119, s47, v131
    v_lshlrev_b32 v120, 16, v132
    v_and_b32 v121, s47, v132
    v_lshlrev_b32 v122, 16, v133
    v_and_b32 v123, s47, v133
    v_lshlrev_b32 v124, 16, v134
    v_and_b32 v125, s47, v134
    v_lshlrev_b32 v126, 16, v135
    v_and_b32 v127, s47, v135
    v_max3_f32 v168, v112, v113, v114
    v_min3_f32 v169, v112, v113, v114
    v_max3_f32 v170, v115, v116, v117
    v_min3_f32 v171, v115, v116, v117
    v_max3_f32 v168, v168, v118, v119
    v_min3_f32 v169, v169, v118, v119
    v_max3_f32 v170, v170, v120, v121
    v_min3_f32 v171, v171, v120, v121
    v_max3_f32 v168, v168, v122, v123
    v_min3_f32 v169, v169, v122, v123
    v_max3_f32 v170, v170, v124, v125
    v_min3_f32 v171, v171, v124, v125
    v_max3_f32 v168, v168, v126, v127
    v_min3_f32 v169, v169, v126, v127
    v_max_f32 v168, v168, v170
    v_min_f32 v169, v169, v171
    v_mov_b32 v170, v168
    v_mov_b32 v171, v169
    s_nop 0
    v_permlane32_swap_b32 v168, v170
    v_permlane32_swap_b32 v169, v171
    v_max_f32 v168, v168, v170
    v_min_f32 v169, v169, v171
    v_mul_f32 v168, s55, v168
    v_mul_f32 v169, s55, v169
    v_pk_fma_f32 v[128:129], v[112:113], s[54:55], v[168:169] op_sel:[0,1,0] op_sel_hi:[1,1,0] neg_lo:[0,0,1] neg_hi:[0,0,1]
    v_pk_fma_f32 v[144:145], v[112:113], s[54:55], v[168:169] op_sel:[0,1,1] op_sel_hi:[1,1,1] neg_lo:[1,0,0] neg_hi:[1,0,0]
    v_pk_fma_f32 v[130:131], v[114:115], s[54:55], v[168:169] op_sel:[0,1,0] op_sel_hi:[1,1,0] neg_lo:[0,0,1] neg_hi:[0,0,1]
    v_pk_fma_f32 v[146:147], v[114:115], s[54:55], v[168:169] op_sel:[0,1,1] op_sel_hi:[1,1,1] neg_lo:[1,0,0] neg_hi:[1,0,0]
    v_pk_fma_f32 v[132:133], v[116:117], s[54:55], v[168:169] op_sel:[0,1,0] op_sel_hi:[1,1,0] neg_lo:[0,0,1] neg_hi:[0,0,1]
    v_pk_fma_f32 v[148:149], v[116:117], s[54:55], v[168:169] op_sel:[0,1,1] op_sel_hi:[1,1,1] neg_lo:[1,0,0] neg_hi:[1,0,0]
    v_pk_fma_f32 v[134:135], v[118:119], s[54:55], v[168:169] op_sel:[0,1,0] op_sel_hi:[1,1,0] neg_lo:[0,0,1] neg_hi:[0,0,1]
    v_pk_fma_f32 v[150:151], v[118:119], s[54:55], v[168:169] op_sel:[0,1,1] op_sel_hi:[1,1,1] neg_lo:[1,0,0] neg_hi:[1,0,0]
    v_pk_fma_f32 v[136:137], v[120:121], s[54:55], v[168:169] op_sel:[0,1,0] op_sel_hi:[1,1,0] neg_lo:[0,0,1] neg_hi:[0,0,1]
    v_pk_fma_f32 v[152:153], v[120:121], s[54:55], v[168:169] op_sel:[0,1,1] op_sel_hi:[1,1,1] neg_lo:[1,0,0] neg_hi:[1,0,0]
    v_pk_fma_f32 v[138:139], v[122:123], s[54:55], v[168:169] op_sel:[0,1,0] op_sel_hi:[1,1,0] neg_lo:[0,0,1] neg_hi:[0,0,1]
    v_pk_fma_f32 v[154:155], v[122:123], s[54:55], v[168:169] op_sel:[0,1,1] op_sel_hi:[1,1,1] neg_lo:[1,0,0] neg_hi:[1,0,0]
    v_pk_fma_f32 v[140:141], v[124:125], s[54:55], v[168:169] op_sel:[0,1,0] op_sel_hi:[1,1,0] neg_lo:[0,0,1] neg_hi:[0,0,1]
    v_pk_fma_f32 v[156:157], v[124:125], s[54:55], v[168:169] op_sel:[0,1,1] op_sel_hi:[1,1,1] neg_lo:[1,0,0] neg_hi:[1,0,0]
    v_pk_fma_f32 v[142:143], v[126:127], s[54:55], v[168:169] op_sel:[0,1,0] op_sel_hi:[1,1,0] neg_lo:[0,0,1] neg_hi:[0,0,1]
    v_pk_fma_f32 v[158:159], v[126:127], s[54:55], v[168:169] op_sel:[0,1,1] op_sel_hi:[1,1,1] neg_lo:[1,0,0] neg_hi:[1,0,0]
    v_exp_f32 v128, v128
    v_exp_f32 v144, v144
    v_exp_f32 v129, v129
    v_exp_f32 v145, v145
    v_exp_f32 v130, v130
    v_exp_f32 v146, v146
    v_exp_f32 v131, v131
    v_exp_f32 v147, v147
    v_exp_f32 v132, v132
    v_exp_f32 v148, v148
    v_exp_f32 v133, v133
    v_exp_f32 v149, v149
    v_exp_f32 v134, v134
    v_exp_f32 v150, v150
    v_exp_f32 v135, v135
    v_exp_f32 v151, v151
    v_exp_f32 v136, v136
    v_exp_f32 v152, v152
    v_exp_f32 v137, v137
    v_exp_f32 v153, v153
    v_exp_f32 v138, v138
    v_exp_f32 v154, v154
    v_exp_f32 v139, v139
    v_exp_f32 v155, v155
    v_exp_f32 v140, v140
    v_exp_f32 v156, v156
    v_exp_f32 v141, v141
    v_exp_f32 v157, v157
    v_exp_f32 v142, v142
    v_exp_f32 v158, v158
    v_exp_f32 v143, v143
    v_exp_f32 v159, v159
    v_pk_add_f32 v[168:169], v[128:129], v[130:131]
    v_pk_add_f32 v[170:171], v[144:145], v[146:147]
    v_pk_add_f32 v[172:173], v[132:133], v[134:135]
    v_pk_add_f32 v[174:175], v[148:149], v[150:151]
    v_pk_add_f32 v[168:169], v[168:169], v[136:137]
    v_pk_add_f32 v[170:171], v[170:171], v[152:153]
    v_pk_add_f32 v[172:173], v[172:173], v[138:139]
    v_pk_add_f32 v[174:175], v[174:175], v[154:155]
    v_pk_add_f32 v[168:169], v[168:169], v[140:141]
    v_pk_add_f32 v[170:171], v[170:171], v[156:157]
    v_pk_add_f32 v[172:173], v[172:173], v[142:143]
    v_pk_add_f32 v[174:175], v[174:175], v[158:159]
    v_pk_add_f32 v[168:169], v[168:169], v[172:173]
    v_pk_add_f32 v[170:171], v[170:171], v[174:175]
    v_add_f32 v168, v168, v169
    v_add_f32 v169, v170, v171
    v_mov_b32 v170, v168
    v_mov_b32 v171, v169
    s_nop 0
    v_permlane32_swap_b32 v168, v170
    v_permlane32_swap_b32 v169, v171
    v_add_f32 v168, v168, v170
    v_add_f32 v169, v169, v171
    v_rcp_f32 v168, v168
    v_rcp_f32 v169, v169
    s_nop 0
    v_pk_mul_f32 v[128:129], v[128:129], v[168:169] op_sel:[0,0] op_sel_hi:[1,0]
    v_pk_mul_f32 v[144:145], v[144:145], v[168:169] op_sel:[0,1] op_sel_hi:[1,1]
    v_pk_mul_f32 v[130:131], v[130:131], v[168:169] op_sel:[0,0] op_sel_hi:[1,0]
    v_pk_mul_f32 v[146:147], v[146:147], v[168:169] op_sel:[0,1] op_sel_hi:[1,1]
    v_pk_mul_f32 v[132:133], v[132:133], v[168:169] op_sel:[0,0] op_sel_hi:[1,0]
    v_pk_mul_f32 v[148:149], v[148:149], v[168:169] op_sel:[0,1] op_sel_hi:[1,1]
    v_pk_mul_f32 v[134:135], v[134:135], v[168:169] op_sel:[0,0] op_sel_hi:[1,0]
    v_pk_mul_f32 v[150:151], v[150:151], v[168:169] op_sel:[0,1] op_sel_hi:[1,1]
    v_pk_mul_f32 v[136:137], v[136:137], v[168:169] op_sel:[0,0] op_sel_hi:[1,0]
    v_pk_mul_f32 v[152:153], v[152:153], v[168:169] op_sel:[0,1] op_sel_hi:[1,1]
    v_pk_mul_f32 v[138:139], v[138:139], v[168:169] op_sel:[0,0] op_sel_hi:[1,0]
    v_pk_mul_f32 v[154:155], v[154:155], v[168:169] op_sel:[0,1] op_sel_hi:[1,1]
    v_pk_mul_f32 v[140:141], v[140:141], v[168:169] op_sel:[0,0] op_sel_hi:[1,0]
    v_pk_mul_f32 v[156:157], v[156:157], v[168:169] op_sel:[0,1] op_sel_hi:[1,1]
    v_pk_mul_f32 v[142:143], v[142:143], v[168:169] op_sel:[0,0] op_sel_hi:[1,0]
    v_pk_mul_f32 v[158:159], v[158:159], v[168:169] op_sel:[0,1] op_sel_hi:[1,1]
    v_cvt_pk_bf16_f32 v192, v128, v129
    v_cvt_pk_bf16_f32 v193, v130, v131
    v_cvt_pk_bf16_f32 v194, v132, v133
    v_cvt_pk_bf16_f32 v195, v134, v135
    v_cvt_pk_bf16_f32 v196, v136, v137
    v_cvt_pk_bf16_f32 v197, v138, v139
    v_cvt_pk_bf16_f32 v198, v140, v141
    v_cvt_pk_bf16_f32 v199, v142, v143
    v_cvt_pk_bf16_f32 v200, v144, v145
    v_cvt_pk_bf16_f32 v201, v146, v147
    v_cvt_pk_bf16_f32 v202, v148, v149
    v_cvt_pk_bf16_f32 v203, v150, v151
    v_cvt_pk_bf16_f32 v204, v152, v153
    v_cvt_pk_bf16_f32 v205, v154, v155
    v_cvt_pk_bf16_f32 v206, v156, v157
    v_cvt_pk_bf16_f32 v207, v158, v159
    s_cmp_eq_u32 s14, 0
    s_cbranch_scc0 .g1_polled
    s_mov_b32 s44, 16384
    v_lshlrev_b32 v14, 3, v1
    s_mov_b64 exec, 0xff
.g1_poll:
    buffer_load_dwordx2 v[220:221], v14, s[28:31], s61 offen sc1
    s_waitcnt vmcnt(0)
    v_cmp_ne_u64 vcc, s[76:77], v[220:221]
    s_sub_u32 s44, s44, 1
    s_cbranch_vccz .g1_pdone
    s_sleep 1
    s_cmp_lg_u32 s44, 0
    s_cbranch_scc1 .g1_poll
.g1_pdone:
    s_mov_b64 exec, -1
.g1_polled:
    s_barrier
    buffer_load_dwordx4 v[64:67], v2, s[28:31], s57 offen sc1
    buffer_load_dwordx4 v[68:71], v2, s[28:31], s57 offen offset:1024 sc1
    s_add_u32 s57, s57, 8192
    buffer_load_dwordx4 v[72:75], v2, s[28:31], s57 offen sc1
    buffer_load_dwordx4 v[76:79], v2, s[28:31], s57 offen offset:1024 sc1
    s_add_u32 s57, s57, 8192
    buffer_load_dwordx4 v[80:83], v2, s[28:31], s57 offen sc1
    buffer_load_dwordx4 v[84:87], v2, s[28:31], s57 offen offset:1024 sc1
    s_add_u32 s57, s57, 8192
    buffer_load_dwordx4 v[88:91], v2, s[28:31], s57 offen sc1
    buffer_load_dwordx4 v[92:95], v2, s[28:31], s57 offen offset:1024 sc1
    s_add_u32 s57, s57, 8192
    buffer_load_dwordx4 v[96:99], v2, s[28:31], s57 offen sc1
    buffer_load_dwordx4 v[100:103], v2, s[28:31], s57 offen offset:1024 sc1
    s_add_u32 s57, s57, 8192
    buffer_load_dwordx4 v[104:107], v2, s[28:31], s57 offen sc1
    buffer_load_dwordx4 v[108:111], v2, s[28:31], s57 offen offset:1024 sc1
    s_add_u32 s57, s57, 8192
    buffer_load_dwordx4 v[112:115], v2, s[28:31], s57 offen sc1
    buffer_load_dwordx4 v[116:119], v2, s[28:31], s57 offen offset:1024 sc1
    s_add_u32 s57, s57, 8192
    buffer_load_dwordx4 v[120:123], v2, s[28:31], s57 offen sc1
    buffer_load_dwordx4 v[124:127], v2, s[28:31], s57 offen offset:1024 sc1
    s_cmp_eq_u32 s15, 0
    s_cbranch_scc0 .g1_noz2
    buffer_load_dword v128, v13, s[28:31], s59 offen offset:0 sc1
    buffer_load_dword v129, v13, s[28:31], s59 offen offset:256 sc1
    buffer_load_dword v130, v13, s[28:31], s59 offen offset:512 sc1
    buffer_load_dword v131, v13, s[28:31], s59 offen offset:768 sc1
    buffer_load_dword v132, v13, s[28:31], s59 offen offset:1024 sc1
    buffer_load_dword v133, v13, s[28:31], s59 offen offset:1280 sc1
    buffer_load_dword v134, v13, s[28:31], s59 offen offset:1536 sc1
    buffer_load_dword v135, v13, s[28:31], s59 offen offset:1792 sc1
    s_lshl_b32 s44, s16, 7
    v_lshlrev_b32 v14, 1, v1
    v_add_u32 v14, s44, v14
    v_add_u32 v14, 155648, v14
    s_waitcnt vmcnt(0)
    v_add_f32 v128, v128, v129
    v_add_f32 v130, v130, v131
    v_add_f32 v132, v132, v133
    v_add_f32 v134, v134, v135
    v_add_f32 v128, v128, v130
    v_add_f32 v132, v132, v134
    v_add_f32 v128, v128, v132
    v_cvt_pk_bf16_f32 v128, v128, v128
    ds_write_b16 v14, v128
.g1_noz2:
    s_lshl_b32 s44, s16, 12
    v_add_u32 v14, s44, v2
    v_add_u32 v14, 147456, v14
    s_lshl_b32 s45, s15, 10
    v_add_u32 v15, s45, v14
    s_lshl_b32 s44, s16, 7
    v_lshlrev_b32 v12, 3, v7
    v_add_u32 v12, s44, v12
    v_add_u32 v12, 155648, v12
    s_waitcnt vmcnt(0)
    v_pk_add_f32 v[64:65], v[64:65], v[96:97]
    v_pk_add_f32 v[66:67], v[66:67], v[98:99]
    v_pk_add_f32 v[68:69], v[68:69], v[100:101]
    v_pk_add_f32 v[70:71], v[70:71], v[102:103]
    v_pk_add_f32 v[72:73], v[72:73], v[104:105]
    v_pk_add_f32 v[74:75], v[74:75], v[106:107]
    v_pk_add_f32 v[76:77], v[76:77], v[108:109]
    v_pk_add_f32 v[78:79], v[78:79], v[110:111]
    v_pk_add_f32 v[80:81], v[80:81], v[112:113]
    v_pk_add_f32 v[82:83], v[82:83], v[114:115]
    v_pk_add_f32 v[84:85], v[84:85], v[116:117]
    v_pk_add_f32 v[86:87], v[86:87], v[118:119]
    v_pk_add_f32 v[88:89], v[88:89], v[120:121]
    v_pk_add_f32 v[90:91], v[90:91], v[122:123]
    v_pk_add_f32 v[92:93], v[92:93], v[124:125]
    v_pk_add_f32 v[94:95], v[94:95], v[126:127]
    v_pk_add_f32 v[64:65], v[64:65], v[80:81]
    v_pk_add_f32 v[66:67], v[66:67], v[82:83]
    v_pk_add_f32 v[68:69], v[68:69], v[84:85]
    v_pk_add_f32 v[70:71], v[70:71], v[86:87]
    v_pk_add_f32 v[72:73], v[72:73], v[88:89]
    v_pk_add_f32 v[74:75], v[74:75], v[90:91]
    v_pk_add_f32 v[76:77], v[76:77], v[92:93]
    v_pk_add_f32 v[78:79], v[78:79], v[94:95]
    v_pk_add_f32 v[64:65], v[64:65], v[72:73]
    v_pk_add_f32 v[66:67], v[66:67], v[74:75]
    v_pk_add_f32 v[68:69], v[68:69], v[76:77]
    v_pk_add_f32 v[70:71], v[70:71], v[78:79]
    v_cvt_pk_bf16_f32 v64, v64, v65
    v_cvt_pk_bf16_f32 v65, v66, v67
    v_cvt_pk_bf16_f32 v66, v68, v69
    v_cvt_pk_bf16_f32 v67, v70, v71
    ds_write_b128 v15, v[64:67]
    s_waitcnt lgkmcnt(0)
    s_barrier
    ds_read_b128 v[64:67], v14 offset:0
    ds_read_b128 v[68:71], v14 offset:1024
    ds_read_b128 v[72:75], v14 offset:2048
    ds_read_b128 v[76:79], v14 offset:3072
    ds_read_b64 v[80:81], v12 offset:0
    ds_read_b64 v[82:83], v12 offset:16
    ds_read_b64 v[84:85], v12 offset:32
    ds_read_b64 v[86:87], v12 offset:48
    ds_read_b64 v[88:89], v12 offset:64
    ds_read_b64 v[90:91], v12 offset:80
    ds_read_b64 v[92:93], v12 offset:96
    ds_read_b64 v[94:95], v12 offset:112
    s_lshl_b32 s44, s53, 11
    s_add_u32 s48, s48, s44
    s_add_u32 s50, s48, 294912
    s_waitcnt lgkmcnt(0)
    v_mfma_f32_32x32x16_bf16 v[128:143], v[80:83], v[176:179], 0
    v_mfma_f32_32x32x16_bf16 v[96:111], v[64:67], v[176:179], 0
    v_mfma_f32_32x32x16_bf16 v[128:143], v[84:87], v[180:183], v[128:143]
    v_mfma_f32_32x32x16_bf16 v[96:111], v[68:71], v[180:183], v[96:111]
    v_mfma_f32_32x32x16_bf16 v[128:143], v[88:91], v[184:187], v[128:143]
    v_mfma_f32_32x32x16_bf16 v[96:111], v[72:75], v[184:187], v[96:111]
    v_mfma_f32_32x32x16_bf16 v[128:143], v[92:95], v[188:191], v[128:143]
    v_mfma_f32_32x32x16_bf16 v[96:111], v[76:79], v[188:191], v[96:111]
    v_mfma_f32_32x32x16_bf16 v[144:159], v[80:83], v[192:195], 0
    v_mfma_f32_32x32x16_bf16 v[112:127], v[64:67], v[192:195], 0
    v_mfma_f32_32x32x16_bf16 v[144:159], v[84:87], v[196:199], v[144:159]
    v_mfma_f32_32x32x16_bf16 v[112:127], v[68:71], v[196:199], v[112:127]
    v_mfma_f32_32x32x16_bf16 v[144:159], v[88:91], v[200:203], v[144:159]
    v_mfma_f32_32x32x16_bf16 v[112:127], v[72:75], v[200:203], v[112:127]
    v_mfma_f32_32x32x16_bf16 v[144:159], v[92:95], v[204:207], v[144:159]
    v_mfma_f32_32x32x16_bf16 v[112:127], v[76:79], v[204:207], v[112:127]
    s_nop 2
    v_cvt_pk_bf16_f32 v128, v128, v128
    v_lshlrev_b32 v128, 16, v128
    v_add_f32 v128, 0x358637bd, v128
    v_cvt_pk_bf16_f32 v128, v128, v128
    v_lshlrev_b32 v128, 16, v128
    v_rcp_f32 v128, v128
    v_cvt_pk_bf16_f32 v16, v96, v97
    v_cvt_pk_bf16_f32 v17, v98, v99
    v_cvt_pk_bf16_f32 v18, v100, v101
    v_cvt_pk_bf16_f32 v19, v102, v103
    v_cvt_pk_bf16_f32 v20, v104, v105
    v_cvt_pk_bf16_f32 v21, v106, v107
    v_cvt_pk_bf16_f32 v22, v108, v109
    v_cvt_pk_bf16_f32 v23, v110, v111
    v_lshlrev_b32 v96, 16, v16
    v_and_b32 v97, s47, v16
    v_lshlrev_b32 v98, 16, v17
    v_and_b32 v99, s47, v17
    v_lshlrev_b32 v100, 16, v18
    v_and_b32 v101, s47, v18
    v_lshlrev_b32 v102, 16, v19
    v_and_b32 v103, s47, v19
    v_lshlrev_b32 v104, 16, v20
    v_and_b32 v105, s47, v20
    v_lshlrev_b32 v106, 16, v21
    v_and_b32 v107, s47, v21
    v_lshlrev_b32 v108, 16, v22
    v_and_b32 v109, s47, v22
    v_lshlrev_b32 v110, 16, v23
    v_and_b32 v111, s47, v23
    v_pk_mul_f32 v[96:97], v[96:97], v[128:129] op_sel:[0,0] op_sel_hi:[1,0]
    v_pk_mul_f32 v[98:99], v[98:99], v[128:129] op_sel:[0,0] op_sel_hi:[1,0]
    v_pk_mul_f32 v[100:101], v[100:101], v[128:129] op_sel:[0,0] op_sel_hi:[1,0]
    v_pk_mul_f32 v[102:103], v[102:103], v[128:129] op_sel:[0,0] op_sel_hi:[1,0]
    v_pk_mul_f32 v[104:105], v[104:105], v[128:129] op_sel:[0,0] op_sel_hi:[1,0]
    v_pk_mul_f32 v[106:107], v[106:107], v[128:129] op_sel:[0,0] op_sel_hi:[1,0]
    v_pk_mul_f32 v[108:109], v[108:109], v[128:129] op_sel:[0,0] op_sel_hi:[1,0]
    v_pk_mul_f32 v[110:111], v[110:111], v[128:129] op_sel:[0,0] op_sel_hi:[1,0]
    v_cvt_pk_bf16_f32 v16, v96, v97
    v_cvt_pk_bf16_f32 v17, v98, v99
    v_cvt_pk_bf16_f32 v18, v100, v101
    v_cvt_pk_bf16_f32 v19, v102, v103
    v_cvt_pk_bf16_f32 v20, v104, v105
    v_cvt_pk_bf16_f32 v21, v106, v107
    v_cvt_pk_bf16_f32 v22, v108, v109
    v_cvt_pk_bf16_f32 v23, v110, v111
    s_cmp_eq_u32 s16, 0
    s_cbranch_scc1 .g1_noep
    s_mov_b64 exec, s[40:41]
    buffer_load_dwordx2 v[10:11], v5, s[28:31], s38 offen sc1
    s_mov_b64 exec, -1
.g1_noep:
    buffer_store_dwordx4 v[16:19], v2, s[28:31], s48 offen offset:0 sc1
    buffer_store_dwordx4 v[20:23], v2, s[28:31], s48 offen offset:1024 sc1
    v_cvt_pk_bf16_f32 v144, v144, v144
    v_lshlrev_b32 v144, 16, v144
    v_add_f32 v144, 0x358637bd, v144
    v_cvt_pk_bf16_f32 v144, v144, v144
    v_lshlrev_b32 v144, 16, v144
    v_rcp_f32 v144, v144
    v_cvt_pk_bf16_f32 v24, v112, v113
    v_cvt_pk_bf16_f32 v25, v114, v115
    v_cvt_pk_bf16_f32 v26, v116, v117
    v_cvt_pk_bf16_f32 v27, v118, v119
    v_cvt_pk_bf16_f32 v28, v120, v121
    v_cvt_pk_bf16_f32 v29, v122, v123
    v_cvt_pk_bf16_f32 v30, v124, v125
    v_cvt_pk_bf16_f32 v31, v126, v127
    v_lshlrev_b32 v112, 16, v24
    v_and_b32 v113, s47, v24
    v_lshlrev_b32 v114, 16, v25
    v_and_b32 v115, s47, v25
    v_lshlrev_b32 v116, 16, v26
    v_and_b32 v117, s47, v26
    v_lshlrev_b32 v118, 16, v27
    v_and_b32 v119, s47, v27
    v_lshlrev_b32 v120, 16, v28
    v_and_b32 v121, s47, v28
    v_lshlrev_b32 v122, 16, v29
    v_and_b32 v123, s47, v29
    v_lshlrev_b32 v124, 16, v30
    v_and_b32 v125, s47, v30
    v_lshlrev_b32 v126, 16, v31
    v_and_b32 v127, s47, v31
    v_pk_mul_f32 v[112:113], v[112:113], v[144:145] op_sel:[0,0] op_sel_hi:[1,0]
    v_pk_mul_f32 v[114:115], v[114:115], v[144:145] op_sel:[0,0] op_sel_hi:[1,0]
    v_pk_mul_f32 v[116:117], v[116:117], v[144:145] op_sel:[0,0] op_sel_hi:[1,0]
    v_pk_mul_f32 v[118:119], v[118:119], v[144:145] op_sel:[0,0] op_sel_hi:[1,0]
    v_pk_mul_f32 v[120:121], v[120:121], v[144:145] op_sel:[0,0] op_sel_hi:[1,0]
    v_pk_mul_f32 v[122:123], v[122:123], v[144:145] op_sel:[0,0] op_sel_hi:[1,0]
    v_pk_mul_f32 v[124:125], v[124:125], v[144:145] op_sel:[0,0] op_sel_hi:[1,0]
    v_pk_mul_f32 v[126:127], v[126:127], v[144:145] op_sel:[0,0] op_sel_hi:[1,0]
    v_cvt_pk_bf16_f32 v24, v112, v113
    v_cvt_pk_bf16_f32 v25, v114, v115
    v_cvt_pk_bf16_f32 v26, v116, v117
    v_cvt_pk_bf16_f32 v27, v118, v119
    v_cvt_pk_bf16_f32 v28, v120, v121
    v_cvt_pk_bf16_f32 v29, v122, v123
    v_cvt_pk_bf16_f32 v30, v124, v125
    v_cvt_pk_bf16_f32 v31, v126, v127
    buffer_store_dwordx4 v[24:27], v2, s[28:31], s50 offen offset:0 sc1
    buffer_store_dwordx4 v[28:31], v2, s[28:31], s50 offen offset:1024 sc1
.g2_entry:
    s_mov_b64 exec, -1
    s_lshl_b32 s70, s19, 3
    s_add_u32 s70, s70, s17
    s_lshl_b32 s70, s70, 7
    s_lshl_b32 s71, s18, 3
    s_add_u32 s70, s70, s71
    s_add_u32 s70, s70, 28332032
    s_load_dwordx2 s[4:5], s[0:1], 0
    s_load_dwordx4 s[8:11], s[0:1], 56
    s_load_dwordx2 s[12:13], s[0:1], 72
    s_load_dwordx2 s[14:15], s[0:1], 88
    v_lshrrev_b32 v2, 6, v0
    v_and_b32 v1, 63, v0
    s_and_b32 s17, s2, 3
    s_bfe_u32 s18, s2, 0x10002
    v_readfirstlane_b32 s16, v2
    s_lshl_b32 s18, s18, 2
    s_bfe_u32 s54, s2, 0x20003
    s_add_u32 s18, s18, s54
    s_lshr_b32 s19, s2, 5
    s_lshl_b32 s20, s18, 3
    s_add_u32 s20, s20, s19
    v_lshlrev_b32 v2, 4, v1
    s_sub_u32 s54, s17, 1
    s_mul_i32 s54, s54, 37
    s_cmp_eq_u32 s17, 3
    s_cselect_b32 s21, 38, 37
    s_lshl_b32 s48, s54, 11
    s_add_u32 s48, s48, 65536
    s_cmp_eq_u32 s17, 0
    s_cselect_b32 s21, 32, s21
    s_cselect_b32 s48, 0, s48
    s_mul_i32 s54, s18, 2359296
    s_add_u32 s54, s54, 5240832
    s_waitcnt lgkmcnt(0)
    s_add_u32 s28, s14, s54
    s_addc_u32 s29, s15, 0
    s_mov_b32 s30, 2361344
    s_mov_b32 s31, 0x20000
    s_mov_b32 s32, s14
    s_mov_b32 s33, s15
    s_mov_b32 s34, 268435456
    s_mov_b32 s35, 0x20000
    s_cmp_lt_u32 s16, 4
    s_cbranch_scc1 .g2_comp
    s_sub_u32 s22, s16, 4
    s_mov_b32 s49, s36
    v_mov_b32 v12, v5
    s_and_b32 s54, s22, 1
    s_lshl_b32 s54, s54, 1
    s_xor_b32 s54, s54, s17
    s_lshr_b32 s55, s22, 1
    s_lshl_b32 s55, s55, 2
    s_add_u32 s54, s54, s55
    s_xor_b32 s55, s54, 1
    s_mul_i32 s54, s54, 294912
    s_mul_i32 s55, s55, 294912
    s_add_u32 s55, s55, 2048
    v_add_u32 v5, s54, v2
    v_add_u32 v6, s55, v2
    s_mul_i32 s50, s22, 6144
    s_add_u32 s51, s50, 147456
    s_mov_b32 s59, 16384
    s_mov_b64 exec, s[40:41]
    s_waitcnt vmcnt(4)
    v_cmp_ne_u64 vcc, s[76:77], v[10:11]
    s_mov_b64 exec, -1
    s_cbranch_vccnz .g2_slow
    s_add_u32 m0, s50, 0
    s_add_u32 s52, s50, 4096
    buffer_load_dwordx4 v5, s[28:31], s48 offen offset:2048 lds
    buffer_load_dwordx4 v5, s[28:31], s48 offen offset:3072 lds
    s_mov_b32 m0, s52
    s_nop 0
    buffer_load_dwordx4 v6, s[28:31], s48 offen lds
    buffer_load_dwordx4 v6, s[28:31], s48 offen offset:1024 lds
    s_add_u32 s48, s48, 2048
    s_add_u32 m0, s50, 24576
    s_add_u32 s52, s50, 28672
    buffer_load_dwordx4 v5, s[28:31], s48 offen offset:2048 lds
    buffer_load_dwordx4 v5, s[28:31], s48 offen offset:3072 lds
    s_mov_b32 m0, s52
    s_nop 0
    buffer_load_dwordx4 v6, s[28:31], s48 offen lds
    buffer_load_dwordx4 v6, s[28:31], s48 offen offset:1024 lds
    s_add_u32 s48, s48, 2048
    s_add_u32 m0, s50, 49152
    s_add_u32 s52, s50, 53248
    buffer_load_dwordx4 v5, s[28:31], s48 offen offset:2048 lds
    buffer_load_dwordx4 v5, s[28:31], s48 offen offset:3072 lds
    s_mov_b32 m0, s52
    s_nop 0
    buffer_load_dwordx4 v6, s[28:31], s48 offen lds
    buffer_load_dwordx4 v6, s[28:31], s48 offen offset:1024 lds
    s_add_u32 s48, s48, 2048
    s_add_u32 m0, s50, 73728
    s_add_u32 s52, s50, 77824
    buffer_load_dwordx4 v5, s[28:31], s48 offen offset:2048 lds
    buffer_load_dwordx4 v5, s[28:31], s48 offen offset:3072 lds
    s_mov_b32 m0, s52
    s_nop 0
    buffer_load_dwordx4 v6, s[28:31], s48 offen lds
    buffer_load_dwordx4 v6, s[28:31], s48 offen offset:1024 lds
    s_add_u32 s48, s48, 2048
    s_add_u32 m0, s50, 98304
    s_add_u32 s52, s50, 102400
    buffer_load_dwordx4 v5, s[28:31], s48 offen offset:2048 lds
    buffer_load_dwordx4 v5, s[28:31], s48 offen offset:3072 lds
    s_mov_b32 m0, s52
    s_nop 0
    buffer_load_dwordx4 v6, s[28:31], s48 offen lds
    buffer_load_dwordx4 v6, s[28:31], s48 offen offset:1024 lds
    s_add_u32 s48, s48, 2048
    s_add_u32 m0, s50, 122880
    s_add_u32 s52, s50, 126976
    buffer_load_dwordx4 v5, s[28:31], s48 offen offset:2048 lds
    buffer_load_dwordx4 v5, s[28:31], s48 offen offset:3072 lds
    s_mov_b32 m0, s52
    s_nop 0
    buffer_load_dwordx4 v6, s[28:31], s48 offen lds
    buffer_load_dwordx4 v6, s[28:31], s48 offen offset:1024 lds
    s_add_u32 s48, s48, 2048
    s_waitcnt vmcnt(24)
    s_barrier
    s_branch .g2_join
.g2_slow:
    s_waitcnt vmcnt(0)
    s_barrier
    s_mov_b64 exec, s[40:41]
.g2_rpoll:
    buffer_load_dwordx2 v[10:11], v12, s[32:35], s38 offen sc1
    s_waitcnt vmcnt(0)
    v_cmp_ne_u64 vcc, s[76:77], v[10:11]
    s_sub_u32 s59, s59, 1
    s_cbranch_vccz .g2_rdone
    s_cmp_lg_u32 s59, 0
    s_cbranch_scc1 .g2_rpoll
.g2_rdone:
    s_mov_b64 exec, -1
    s_add_u32 m0, s50, 0
    s_add_u32 s52, s50, 4096
    buffer_load_dwordx4 v5, s[28:31], s48 offen offset:2048 lds
    buffer_load_dwordx4 v5, s[28:31], s48 offen offset:3072 lds
    s_mov_b32 m0, s52
    s_nop 0
    buffer_load_dwordx4 v6, s[28:31], s48 offen lds
    buffer_load_dwordx4 v6, s[28:31], s48 offen offset:1024 lds
    s_add_u32 s48, s48, 2048
    s_add_u32 m0, s50, 24576
    s_add_u32 s52, s50, 28672
    buffer_load_dwordx4 v5, s[28:31], s48 offen offset:2048 lds
    buffer_load_dwordx4 v5, s[28:31], s48 offen offset:3072 lds
    s_mov_b32 m0, s52
    s_nop 0
    buffer_load_dwordx4 v6, s[28:31], s48 offen lds
    buffer_load_dwordx4 v6, s[28:31], s48 offen offset:1024 lds
    s_add_u32 s48, s48, 2048
    s_add_u32 m0, s50, 49152
    s_add_u32 s52, s50, 53248
    buffer_load_dwordx4 v5, s[28:31], s48 offen offset:2048 lds
    buffer_load_dwordx4 v5, s[28:31], s48 offen offset:3072 lds
    s_mov_b32 m0, s52
    s_nop 0
    buffer_load_dwordx4 v6, s[28:31], s48 offen lds
    buffer_load_dwordx4 v6, s[28:31], s48 offen offset:1024 lds
    s_add_u32 s48, s48, 2048
    s_add_u32 m0, s50, 73728
    s_add_u32 s52, s50, 77824
    buffer_load_dwordx4 v5, s[28:31], s48 offen offset:2048 lds
    buffer_load_dwordx4 v5, s[28:31], s48 offen offset:3072 lds
    s_mov_b32 m0, s52
    s_nop 0
    buffer_load_dwordx4 v6, s[28:31], s48 offen lds
    buffer_load_dwordx4 v6, s[28:31], s48 offen offset:1024 lds
    s_add_u32 s48, s48, 2048
    s_add_u32 m0, s50, 98304
    s_add_u32 s52, s50, 102400
    buffer_load_dwordx4 v5, s[28:31], s48 offen offset:2048 lds
    buffer_load_dwordx4 v5, s[28:31], s48 offen offset:3072 lds
    s_mov_b32 m0, s52
    s_nop 0
    buffer_load_dwordx4 v6, s[28:31], s48 offen lds
    buffer_load_dwordx4 v6, s[28:31], s48 offen offset:1024 lds
    s_add_u32 s48, s48, 2048
    s_add_u32 m0, s50, 122880
    s_add_u32 s52, s50, 126976
    buffer_load_dwordx4 v5, s[28:31], s48 offen offset:2048 lds
    buffer_load_dwordx4 v5, s[28:31], s48 offen offset:3072 lds
    s_mov_b32 m0, s52
    s_nop 0
    buffer_load_dwordx4 v6, s[28:31], s48 offen lds
    buffer_load_dwordx4 v6, s[28:31], s48 offen offset:1024 lds
    s_add_u32 s48, s48, 2048
.g2_join:
    s_sub_u32 s21, s21, 10
    s_waitcnt vmcnt(20)
    s_barrier
    s_waitcnt vmcnt(16)
    s_barrier
    s_mov_b32 m0, s50
    s_add_u32 s52, s50, 4096
    buffer_load_dwordx4 v3, s[24:27], s49 offen lds
    buffer_load_dwordx4 v4, s[24:27], s49 offen offset:1024 lds
    buffer_load_dwordx4 v5, s[28:31], s48 offen offset:2048 lds
    buffer_load_dwordx4 v5, s[28:31], s48 offen offset:3072 lds
    s_mov_b32 m0, s52
    s_add_u32 s50, s50, 24576
    buffer_load_dwordx4 v6, s[28:31], s48 offen lds
    buffer_load_dwordx4 v6, s[28:31], s48 offen offset:1024 lds
    s_add_u32 s48, s48, 2048
    s_add_u32 s49, s49, 65536
    s_cmp_eq_u32 s50, s51
    s_cselect_b32 s52, 147456, 0
    s_sub_u32 s50, s50, s52
    s_waitcnt vmcnt(18)
    s_barrier
    s_mov_b32 m0, s50
    s_add_u32 s52, s50, 4096
    buffer_load_dwordx4 v3, s[24:27], s49 offen lds
    buffer_load_dwordx4 v4, s[24:27], s49 offen offset:1024 lds
    buffer_load_dwordx4 v5, s[28:31], s48 offen offset:2048 lds
    buffer_load_dwordx4 v5, s[28:31], s48 offen offset:3072 lds
    s_mov_b32 m0, s52
    s_add_u32 s50, s50, 24576
    buffer_load_dwordx4 v6, s[28:31], s48 offen lds
    buffer_load_dwordx4 v6, s[28:31], s48 offen offset:1024 lds
    s_add_u32 s48, s48, 2048
    s_add_u32 s49, s49, 65536
    s_cmp_eq_u32 s50, s51
    s_cselect_b32 s52, 147456, 0
    s_sub_u32 s50, s50, s52
    s_waitcnt vmcnt(20)
    s_barrier
    s_mov_b32 m0, s50
    s_add_u32 s52, s50, 4096
    buffer_load_dwordx4 v3, s[24:27], s49 offen lds
    buffer_load_dwordx4 v4, s[24:27], s49 offen offset:1024 lds
    buffer_load_dwordx4 v5, s[28:31], s48 offen offset:2048 lds
    buffer_load_dwordx4 v5, s[28:31], s48 offen offset:3072 lds
    s_mov_b32 m0, s52
    s_add_u32 s50, s50, 24576
    buffer_load_dwordx4 v6, s[28:31], s48 offen lds
    buffer_load_dwordx4 v6, s[28:31], s48 offen offset:1024 lds
    s_add_u32 s48, s48, 2048
    s_add_u32 s49, s49, 65536
    s_cmp_eq_u32 s50, s51
    s_cselect_b32 s52, 147456, 0
    s_sub_u32 s50, s50, s52
    s_waitcnt vmcnt(22)
    s_barrier
    s_mov_b32 m0, s50
    s_add_u32 s52, s50, 4096
    buffer_load_dwordx4 v3, s[24:27], s49 offen lds
    buffer_load_dwordx4 v4, s[24:27], s49 offen offset:1024 lds
    buffer_load_dwordx4 v5, s[28:31], s48 offen offset:2048 lds
    buffer_load_dwordx4 v5, s[28:31], s48 offen offset:3072 lds
    s_mov_b32 m0, s52
    s_add_u32 s50, s50, 24576
    buffer_load_dwordx4 v6, s[28:31], s48 offen lds
    buffer_load_dwordx4 v6, s[28:31], s48 offen offset:1024 lds
    s_add_u32 s48, s48, 2048
    s_add_u32 s49, s49, 65536
    s_cmp_eq_u32 s50, s51
    s_cselect_b32 s52, 147456, 0
    s_sub_u32 s50, s50, s52
.g2_lloop:
    s_waitcnt vmcnt(24)
    s_barrier
    s_mov_b32 m0, s50
    s_add_u32 s52, s50, 4096
    buffer_load_dwordx4 v3, s[24:27], s49 offen lds
    buffer_load_dwordx4 v4, s[24:27], s49 offen offset:1024 lds
    buffer_load_dwordx4 v5, s[28:31], s48 offen offset:2048 lds
    buffer_load_dwordx4 v5, s[28:31], s48 offen offset:3072 lds
    s_mov_b32 m0, s52
    s_add_u32 s50, s50, 24576
    buffer_load_dwordx4 v6, s[28:31], s48 offen lds
    buffer_load_dwordx4 v6, s[28:31], s48 offen offset:1024 lds
    s_add_u32 s48, s48, 2048
    s_add_u32 s49, s49, 65536
    s_cmp_eq_u32 s50, s51
    s_cselect_b32 s52, 147456, 0
    s_sub_u32 s50, s50, s52
    s_sub_u32 s21, s21, 1
    s_cmp_lg_u32 s21, 0
    s_cbranch_scc1 .g2_lloop
    s_waitcnt vmcnt(24)
    s_barrier
    s_waitcnt vmcnt(18)
    s_barrier
    s_waitcnt vmcnt(12)
    s_barrier
    s_waitcnt vmcnt(6)
    s_barrier
    s_waitcnt vmcnt(0)
    s_barrier
    s_barrier
    s_endpgm
.g2_comp:
    s_mov_b32 s36, s4
    s_mov_b32 s37, s5
    s_mov_b32 s38, 4194304
    s_mov_b32 s39, 0x20000
    s_mov_b32 s40, s12
    s_mov_b32 s41, s13
    s_mov_b32 s42, 4194304
    s_mov_b32 s43, 0x20000
    s_mov_b32 s44, s10
    s_mov_b32 s45, s11
    s_mov_b32 s46, 2048
    s_mov_b32 s47, 0x20000
    s_and_b32 s22, s16, 1
    s_lshr_b32 s23, s16, 1
    v_lshrrev_b32 v8, 5, v1
    v_bfe_u32 v9, v1, 2, 2
    v_bfe_u32 v10, v1, 4, 1
    v_lshlrev_b32 v10, 5, v10
    v_and_b32 v11, 3, v1
    v_lshl_add_u32 v10, v11, 3, v10
    s_mul_i32 s54, s22, 12288
    v_add_u32 v5, s54, v2
    v_lshl_add_u32 v11, v8, 2, v9
    v_lshl_add_u32 v10, v11, 8, v10
    s_lshl_b32 s54, s23, 1
    v_xor_b32 v11, s54, v9
    v_lshl_add_u32 v6, v11, 6, v10
    v_xor_b32 v11, 1, v11
    v_lshl_add_u32 v7, v11, 6, v10
    s_lshl_b32 s54, s19, 8
    s_lshl_b32 s55, s23, 7
    s_add_u32 s54, s54, s55
    v_lshlrev_b32 v12, 3, v8
    v_add_u32 v12, s54, v12
    s_lshl_b32 s55, s18, 19
    s_lshl_b32 s56, s22, 18
    s_add_u32 s64, s55, s56
    s_lshl_b32 s56, s17, 16
    s_add_u32 s64, s64, s56
    v_and_b32 v11, 31, v1
    v_lshl_add_u32 v13, v11, 11, v12
    v_lshl_add_u32 v14, v8, 3, v13
    v_mov_b32 v16, s76
    v_mov_b32 v17, s77
    v_mov_b32 v18, 0
    s_waitcnt vmcnt(0)
    s_barrier
    s_cmp_eq_u32 s16, 0
    s_cbranch_scc0 .g2_nofl
    s_mov_b64 exec, 1
    buffer_store_dwordx2 v[16:17], v18, s[32:35], s70 offen sc1
    s_mov_b64 exec, -1
.g2_nofl:
    buffer_load_dwordx2 v[192:193], v13, s[36:39], s64 offen offset:0
    buffer_load_dwordx2 v[194:195], v13, s[36:39], s64 offen offset:16
    buffer_load_dwordx2 v[196:197], v13, s[36:39], s64 offen offset:32
    buffer_load_dwordx2 v[198:199], v13, s[36:39], s64 offen offset:48
    buffer_load_dwordx2 v[200:201], v13, s[36:39], s64 offen offset:64
    buffer_load_dwordx2 v[202:203], v13, s[36:39], s64 offen offset:80
    buffer_load_dwordx2 v[204:205], v13, s[36:39], s64 offen offset:96
    buffer_load_dwordx2 v[206:207], v13, s[36:39], s64 offen offset:112
    buffer_load_dwordx2 v[208:209], v12, s[44:47], 0 offen offset:0
    buffer_load_dwordx2 v[210:211], v12, s[44:47], 0 offen offset:16
    buffer_load_dwordx2 v[212:213], v12, s[44:47], 0 offen offset:32
    buffer_load_dwordx2 v[214:215], v12, s[44:47], 0 offen offset:48
    buffer_load_dwordx2 v[216:217], v12, s[44:47], 0 offen offset:64
    buffer_load_dwordx2 v[218:219], v12, s[44:47], 0 offen offset:80
    buffer_load_dwordx2 v[220:221], v12, s[44:47], 0 offen offset:96
    buffer_load_dwordx2 v[222:223], v12, s[44:47], 0 offen offset:112
    v_mov_b32 v64, 0
    v_mov_b32 v65, 0
    v_mov_b32 v66, 0
    v_mov_b32 v67, 0
    v_mov_b32 v68, 0
    v_mov_b32 v69, 0
    v_mov_b32 v70, 0
    v_mov_b32 v71, 0
    v_mov_b32 v72, 0
    v_mov_b32 v73, 0
    v_mov_b32 v74, 0
    v_mov_b32 v75, 0
    v_mov_b32 v76, 0
    v_mov_b32 v77, 0
    v_mov_b32 v78, 0
    v_mov_b32 v79, 0
    v_mov_b32 v80, 0
    v_mov_b32 v81, 0
    v_mov_b32 v82, 0
    v_mov_b32 v83, 0
    v_mov_b32 v84, 0
    v_mov_b32 v85, 0
    v_mov_b32 v86, 0
    v_mov_b32 v87, 0
    v_mov_b32 v88, 0
    v_mov_b32 v89, 0
    v_mov_b32 v90, 0
    v_mov_b32 v91, 0
    v_mov_b32 v92, 0
    v_mov_b32 v93, 0
    v_mov_b32 v94, 0
    v_mov_b32 v95, 0
    v_mov_b32 v96, 0
    v_mov_b32 v97, 0
    v_mov_b32 v98, 0
    v_mov_b32 v99, 0
    v_mov_b32 v100, 0
    v_mov_b32 v101, 0
    v_mov_b32 v102, 0
    v_mov_b32 v103, 0
    v_mov_b32 v104, 0
    v_mov_b32 v105, 0
    v_mov_b32 v106, 0
    v_mov_b32 v107, 0
    v_mov_b32 v108, 0
    v_mov_b32 v109, 0
    v_mov_b32 v110, 0
    v_mov_b32 v111, 0
    v_mov_b32 v112, 0
    v_mov_b32 v113, 0
    v_mov_b32 v114, 0
    v_mov_b32 v115, 0
    v_mov_b32 v116, 0
    v_mov_b32 v117, 0
    v_mov_b32 v118, 0
    v_mov_b32 v119, 0
    v_mov_b32 v120, 0
    v_mov_b32 v121, 0
    v_mov_b32 v122, 0
    v_mov_b32 v123, 0
    v_mov_b32 v124, 0
    v_mov_b32 v125, 0
    v_mov_b32 v126, 0
    v_mov_b32 v127, 0
    v_mov_b32 v128, 0
    v_mov_b32 v129, 0
    v_mov_b32 v130, 0
    v_mov_b32 v131, 0
    v_mov_b32 v132, 0
    v_mov_b32 v133, 0
    v_mov_b32 v134, 0
    v_mov_b32 v135, 0
    v_mov_b32 v136, 0
    v_mov_b32 v137, 0
    v_mov_b32 v138, 0
    v_mov_b32 v139, 0
    v_mov_b32 v140, 0
    v_mov_b32 v141, 0
    v_mov_b32 v142, 0
    v_mov_b32 v143, 0
    v_mov_b32 v144, 0
    v_mov_b32 v145, 0
    v_mov_b32 v146, 0
    v_mov_b32 v147, 0
    v_mov_b32 v148, 0
    v_mov_b32 v149, 0
    v_mov_b32 v150, 0
    v_mov_b32 v151, 0
    v_mov_b32 v152, 0
    v_mov_b32 v153, 0
    v_mov_b32 v154, 0
    v_mov_b32 v155, 0
    v_mov_b32 v156, 0
    v_mov_b32 v157, 0
    v_mov_b32 v158, 0
    v_mov_b32 v159, 0
    v_mov_b32 v160, 0
    v_mov_b32 v161, 0
    v_mov_b32 v162, 0
    v_mov_b32 v163, 0
    v_mov_b32 v164, 0
    v_mov_b32 v165, 0
    v_mov_b32 v166, 0
    v_mov_b32 v167, 0
    v_mov_b32 v168, 0
    v_mov_b32 v169, 0
    v_mov_b32 v170, 0
    v_mov_b32 v171, 0
    v_mov_b32 v172, 0
    v_mov_b32 v173, 0
    v_mov_b32 v174, 0
    v_mov_b32 v175, 0
    v_mov_b32 v176, 0
    v_mov_b32 v177, 0
    v_mov_b32 v178, 0
    v_mov_b32 v179, 0
    v_mov_b32 v180, 0
    v_mov_b32 v181, 0
    v_mov_b32 v182, 0
    v_mov_b32 v183, 0
    v_mov_b32 v184, 0
    v_mov_b32 v185, 0
    v_mov_b32 v186, 0
    v_mov_b32 v187, 0
    v_mov_b32 v188, 0
    v_mov_b32 v189, 0
    v_mov_b32 v190, 0
    v_mov_b32 v191, 0
    s_lshl_b32 s54, s20, 18
    s_lshl_b32 s55, s16, 14
    s_add_u32 s54, s54, s55
    s_add_u32 s54, s54, 33550336
    s_lshl_b32 s55, s17, 16
    s_add_u32 s60, s54, s55
    s_cmp_eq_u32 s17, 0
    s_cselect_b32 s57, 3, s17
    s_cmp_eq_u32 s57, 3
    s_cselect_b32 s55, 0, s57
    s_add_u32 s55, s55, 1
    s_cmp_eq_u32 s55, 3
    s_cselect_b32 s56, 0, s55
    s_add_u32 s56, s56, 1
    s_xor_b32 s58, s55, s17
    s_lshl_b32 s58, s58, 16
    s_lshl_b32 s59, s55, 12
    s_add_u32 s58, s58, s59
    s_add_u32 s61, s54, s58
    s_xor_b32 s58, s56, s17
    s_lshl_b32 s58, s58, 16
    s_lshl_b32 s59, s56, 12
    s_add_u32 s58, s58, s59
    s_add_u32 s62, s54, s58
    s_xor_b32 s58, s57, s17
    s_lshl_b32 s58, s58, 16
    s_lshl_b32 s59, s57, 12
    s_add_u32 s58, s58, s59
    s_add_u32 s63, s54, s58
    s_lshl_b32 s54, s20, 8
    s_lshl_b32 s55, s16, 6
    s_add_u32 s65, s54, s55
    s_add_u32 s65, s65, 28315648
    s_lshl_b32 s54, 1, s17
    s_xor_b32 s66, s54, 15
    s_mov_b32 s67, 0
    s_mov_b32 s68, s54
    s_mov_b32 s69, 0
    v_lshlrev_b32 v15, 3, v1
    s_mov_b32 s58, 0xffff0000
    s_mov_b32 s50, 0
    s_mov_b32 s52, 24576
    s_barrier
    ds_read_b64_tr_b16 v[32:33], v6 offset:0
    ds_read_b64_tr_b16 v[34:35], v6 offset:6144
    ds_read_b128 v[16:19], v5 offset:2048
    ds_read_b128 v[20:23], v5 offset:4096
    ds_read_b128 v[24:27], v5 offset:8192
    ds_read_b128 v[28:31], v5 offset:10240
    ds_read_b64_tr_b16 v[36:37], v7 offset:0
    ds_read_b64_tr_b16 v[38:39], v7 offset:6144
.g2_loop:
    s_waitcnt lgkmcnt(0)
    v_mfma_f32_32x32x16_bf16 v[64:79], v[32:35], v[16:19], v[64:79]
    ds_read_b64_tr_b16 v[56:57], v6 offset:12288
    ds_read_b64_tr_b16 v[58:59], v6 offset:18432
    ds_read_b128 v[40:43], v5 offset:3072
    v_mfma_f32_32x32x16_bf16 v[80:95], v[32:35], v[20:23], v[80:95]
    ds_read_b128 v[44:47], v5 offset:5120
    ds_read_b128 v[48:51], v5 offset:9216
    v_mfma_f32_32x32x16_bf16 v[96:111], v[32:35], v[24:27], v[96:111]
    ds_read_b128 v[52:55], v5 offset:11264
    ds_read_b64_tr_b16 v[60:61], v7 offset:12288
    ds_read_b64_tr_b16 v[62:63], v7 offset:18432
    v_mfma_f32_32x32x16_bf16 v[112:127], v[32:35], v[28:31], v[112:127]
    s_add_u32 s50, s50, 1
    s_cmp_eq_u32 s50, 6
    s_cselect_b32 s51, -122880, s52
    s_cselect_b32 s50, 0, s50
    v_mfma_f32_32x32x16_bf16 v[128:143], v[36:39], v[16:19], v[128:143]
    v_mfma_f32_32x32x16_bf16 v[144:159], v[36:39], v[20:23], v[144:159]
    v_add_u32 v5, s51, v5
    v_add_u32 v6, s51, v6
    v_add_u32 v7, s51, v7
    v_mfma_f32_32x32x16_bf16 v[160:175], v[36:39], v[24:27], v[160:175]
    v_mfma_f32_32x32x16_bf16 v[176:191], v[36:39], v[28:31], v[176:191]
    s_waitcnt lgkmcnt(0)
    s_barrier
    v_mfma_f32_32x32x16_bf16 v[64:79], v[56:59], v[40:43], v[64:79]
    ds_read_b64_tr_b16 v[32:33], v6 offset:0
    ds_read_b64_tr_b16 v[34:35], v6 offset:6144
    ds_read_b128 v[16:19], v5 offset:2048
    v_mfma_f32_32x32x16_bf16 v[80:95], v[56:59], v[44:47], v[80:95]
    ds_read_b128 v[20:23], v5 offset:4096
    ds_read_b128 v[24:27], v5 offset:8192
    v_mfma_f32_32x32x16_bf16 v[96:111], v[56:59], v[48:51], v[96:111]
    ds_read_b128 v[28:31], v5 offset:10240
    ds_read_b64_tr_b16 v[36:37], v7 offset:0
    ds_read_b64_tr_b16 v[38:39], v7 offset:6144
    v_mfma_f32_32x32x16_bf16 v[112:127], v[56:59], v[52:55], v[112:127]
    v_mfma_f32_32x32x16_bf16 v[128:143], v[60:63], v[40:43], v[128:143]
    s_sub_u32 s21, s21, 1
    s_cmp_lg_u32 s21, 0
    v_mfma_f32_32x32x16_bf16 v[144:159], v[60:63], v[44:47], v[144:159]
    v_mfma_f32_32x32x16_bf16 v[160:175], v[60:63], v[48:51], v[160:175]
    v_mfma_f32_32x32x16_bf16 v[176:191], v[60:63], v[52:55], v[176:191]
    s_cbranch_scc1 .g2_loop
    s_waitcnt lgkmcnt(0)
    s_add_u32 s60, s60, 4096
    v_cvt_pk_bf16_f32 v16, v80, v81
    v_cvt_pk_bf16_f32 v17, v82, v83
    v_cvt_pk_bf16_f32 v18, v84, v85
    v_cvt_pk_bf16_f32 v19, v86, v87
    v_cvt_pk_bf16_f32 v20, v88, v89
    v_cvt_pk_bf16_f32 v21, v90, v91
    v_cvt_pk_bf16_f32 v22, v92, v93
    v_cvt_pk_bf16_f32 v23, v94, v95
    buffer_store_dwordx4 v[16:19], v2, s[32:35], s60 offen offset:0 sc1
    buffer_store_dwordx4 v[20:23], v2, s[32:35], s60 offen offset:1024 sc1
    v_cvt_pk_bf16_f32 v24, v144, v145
    v_cvt_pk_bf16_f32 v25, v146, v147
    v_cvt_pk_bf16_f32 v26, v148, v149
    v_cvt_pk_bf16_f32 v27, v150, v151
    v_cvt_pk_bf16_f32 v28, v152, v153
    v_cvt_pk_bf16_f32 v29, v154, v155
    v_cvt_pk_bf16_f32 v30, v156, v157
    v_cvt_pk_bf16_f32 v31, v158, v159
    buffer_store_dwordx4 v[24:27], v2, s[32:35], s60 offen offset:2048 sc1
    buffer_store_dwordx4 v[28:31], v2, s[32:35], s60 offen offset:3072 sc1
    s_add_u32 s60, s60, 4096
    v_cvt_pk_bf16_f32 v32, v96, v97
    v_cvt_pk_bf16_f32 v33, v98, v99
    v_cvt_pk_bf16_f32 v34, v100, v101
    v_cvt_pk_bf16_f32 v35, v102, v103
    v_cvt_pk_bf16_f32 v36, v104, v105
    v_cvt_pk_bf16_f32 v37, v106, v107
    v_cvt_pk_bf16_f32 v38, v108, v109
    v_cvt_pk_bf16_f32 v39, v110, v111
    buffer_store_dwordx4 v[32:35], v2, s[32:35], s60 offen offset:0 sc1
    buffer_store_dwordx4 v[36:39], v2, s[32:35], s60 offen offset:1024 sc1
    v_cvt_pk_bf16_f32 v40, v160, v161
    v_cvt_pk_bf16_f32 v41, v162, v163
    v_cvt_pk_bf16_f32 v42, v164, v165
    v_cvt_pk_bf16_f32 v43, v166, v167
    v_cvt_pk_bf16_f32 v44, v168, v169
    v_cvt_pk_bf16_f32 v45, v170, v171
    v_cvt_pk_bf16_f32 v46, v172, v173
    v_cvt_pk_bf16_f32 v47, v174, v175
    buffer_store_dwordx4 v[40:43], v2, s[32:35], s60 offen offset:2048 sc1
    buffer_store_dwordx4 v[44:47], v2, s[32:35], s60 offen offset:3072 sc1
    s_add_u32 s60, s60, 4096
    v_cvt_pk_bf16_f32 v48, v112, v113
    v_cvt_pk_bf16_f32 v49, v114, v115
    v_cvt_pk_bf16_f32 v50, v116, v117
    v_cvt_pk_bf16_f32 v51, v118, v119
    v_cvt_pk_bf16_f32 v52, v120, v121
    v_cvt_pk_bf16_f32 v53, v122, v123
    v_cvt_pk_bf16_f32 v54, v124, v125
    v_cvt_pk_bf16_f32 v55, v126, v127
    buffer_store_dwordx4 v[48:51], v2, s[32:35], s60 offen offset:0 sc1
    buffer_store_dwordx4 v[52:55], v2, s[32:35], s60 offen offset:1024 sc1
    v_cvt_pk_bf16_f32 v56, v176, v177
    v_cvt_pk_bf16_f32 v57, v178, v179
    v_cvt_pk_bf16_f32 v58, v180, v181
    v_cvt_pk_bf16_f32 v59, v182, v183
    v_cvt_pk_bf16_f32 v60, v184, v185
    v_cvt_pk_bf16_f32 v61, v186, v187
    v_cvt_pk_bf16_f32 v62, v188, v189
    v_cvt_pk_bf16_f32 v63, v190, v191
    buffer_store_dwordx4 v[56:59], v2, s[32:35], s60 offen offset:2048 sc1
    buffer_store_dwordx4 v[60:63], v2, s[32:35], s60 offen offset:3072 sc1
    s_waitcnt vmcnt(12)
    v_lshlrev_b32 v144, 16, v192
    v_and_b32 v145, s58, v192
    v_lshlrev_b32 v146, 16, v193
    v_and_b32 v147, s58, v193
    v_lshlrev_b32 v148, 16, v194
    v_and_b32 v149, s58, v194
    v_lshlrev_b32 v150, 16, v195
    v_and_b32 v151, s58, v195
    v_lshlrev_b32 v152, 16, v196
    v_and_b32 v153, s58, v196
    v_lshlrev_b32 v154, 16, v197
    v_and_b32 v155, s58, v197
    v_lshlrev_b32 v156, 16, v198
    v_and_b32 v157, s58, v198
    v_lshlrev_b32 v158, 16, v199
    v_and_b32 v159, s58, v199
    v_lshlrev_b32 v160, 16, v200
    v_and_b32 v161, s58, v200
    v_lshlrev_b32 v162, 16, v201
    v_and_b32 v163, s58, v201
    v_lshlrev_b32 v164, 16, v202
    v_and_b32 v165, s58, v202
    v_lshlrev_b32 v166, 16, v203
    v_and_b32 v167, s58, v203
    v_lshlrev_b32 v168, 16, v204
    v_and_b32 v169, s58, v204
    v_lshlrev_b32 v170, 16, v205
    v_and_b32 v171, s58, v205
    v_lshlrev_b32 v172, 16, v206
    v_and_b32 v173, s58, v206
    v_lshlrev_b32 v174, 16, v207
    v_and_b32 v175, s58, v207
    v_lshlrev_b32 v224, 16, v208
    v_and_b32 v225, s58, v208
    v_lshlrev_b32 v226, 16, v209
    v_and_b32 v227, s58, v209
    v_lshlrev_b32 v228, 16, v210
    v_and_b32 v229, s58, v210
    v_lshlrev_b32 v230, 16, v211
    v_and_b32 v231, s58, v211
    v_lshlrev_b32 v232, 16, v212
    v_and_b32 v233, s58, v212
    v_lshlrev_b32 v234, 16, v213
    v_and_b32 v235, s58, v213
    v_lshlrev_b32 v236, 16, v214
    v_and_b32 v237, s58, v214
    v_lshlrev_b32 v238, 16, v215
    v_and_b32 v239, s58, v215
    v_lshlrev_b32 v240, 16, v216
    v_and_b32 v241, s58, v216
    v_lshlrev_b32 v242, 16, v217
    v_and_b32 v243, s58, v217
    v_lshlrev_b32 v244, 16, v218
    v_and_b32 v245, s58, v218
    v_lshlrev_b32 v246, 16, v219
    v_and_b32 v247, s58, v219
    v_lshlrev_b32 v248, 16, v220
    v_and_b32 v249, s58, v220
    v_lshlrev_b32 v250, 16, v221
    v_and_b32 v251, s58, v221
    v_lshlrev_b32 v252, 16, v222
    v_and_b32 v253, s58, v222
    v_lshlrev_b32 v254, 16, v223
    v_and_b32 v255, s58, v223
    s_cmp_eq_u32 s17, 0
    s_cbranch_scc1 .g2_nob
    v_pk_add_f32 v[64:65], v[64:65], v[224:225]
    v_pk_add_f32 v[66:67], v[66:67], v[226:227]
    v_pk_add_f32 v[68:69], v[68:69], v[228:229]
    v_pk_add_f32 v[70:71], v[70:71], v[230:231]
    v_pk_add_f32 v[72:73], v[72:73], v[232:233]
    v_pk_add_f32 v[74:75], v[74:75], v[234:235]
    v_pk_add_f32 v[76:77], v[76:77], v[236:237]
    v_pk_add_f32 v[78:79], v[78:79], v[238:239]
    v_pk_add_f32 v[128:129], v[128:129], v[240:241]
    v_pk_add_f32 v[130:131], v[130:131], v[242:243]
    v_pk_add_f32 v[132:133], v[132:133], v[244:245]
    v_pk_add_f32 v[134:135], v[134:135], v[246:247]
    v_pk_add_f32 v[136:137], v[136:137], v[248:249]
    v_pk_add_f32 v[138:139], v[138:139], v[250:251]
    v_pk_add_f32 v[140:141], v[140:141], v[252:253]
    v_pk_add_f32 v[142:143], v[142:143], v[254:255]
.g2_nob:
    v_mov_b32 v8, s76
    v_mov_b32 v9, s77
    s_mov_b32 s54, 0xbfb8aa3b
    s_mov_b32 s55, s54
    s_mov_b32 s56, 1.0
    s_mov_b32 s57, 1.0
    s_mov_b32 s59, 16384
    s_waitcnt vmcnt(0)
    s_mov_b64 exec, s[68:69]
    buffer_store_dwordx2 v[8:9], v15, s[32:35], s65 offen sc1
    s_mov_b64 exec, s[66:67]
.g2_poll:
    buffer_load_dwordx2 v[10:11], v15, s[32:35], s65 offen sc1
    s_waitcnt vmcnt(0)
    v_cmp_ne_u64 vcc, s[76:77], v[10:11]
    s_sub_u32 s59, s59, 1
    s_cbranch_vccz .g2_pdone
    s_cmp_lg_u32 s59, 0
    s_cbranch_scc1 .g2_poll
.g2_pdone:
    s_mov_b64 exec, -1
    buffer_load_dwordx4 v[80:83], v2, s[32:35], s61 offen offset:0 sc1
    buffer_load_dwordx4 v[84:87], v2, s[32:35], s61 offen offset:1024 sc1
    buffer_load_dwordx4 v[88:91], v2, s[32:35], s62 offen offset:0 sc1
    buffer_load_dwordx4 v[92:95], v2, s[32:35], s62 offen offset:1024 sc1
    buffer_load_dwordx4 v[96:99], v2, s[32:35], s63 offen offset:0 sc1
    buffer_load_dwordx4 v[100:103], v2, s[32:35], s63 offen offset:1024 sc1
    buffer_load_dwordx4 v[104:107], v2, s[32:35], s61 offen offset:2048 sc1
    buffer_load_dwordx4 v[108:111], v2, s[32:35], s61 offen offset:3072 sc1
    buffer_load_dwordx4 v[112:115], v2, s[32:35], s62 offen offset:2048 sc1
    buffer_load_dwordx4 v[116:119], v2, s[32:35], s62 offen offset:3072 sc1
    buffer_load_dwordx4 v[120:123], v2, s[32:35], s63 offen offset:2048 sc1
    buffer_load_dwordx4 v[124:127], v2, s[32:35], s63 offen offset:3072 sc1
    s_cmp_eq_u32 s17, 0
    s_cbranch_scc1 .g2_epi0
    s_waitcnt vmcnt(10)
    v_lshlrev_b32 v16, 16, v80
    v_and_b32 v17, s58, v80
    v_lshlrev_b32 v18, 16, v81
    v_and_b32 v19, s58, v81
    v_lshlrev_b32 v20, 16, v82
    v_and_b32 v21, s58, v82
    v_lshlrev_b32 v22, 16, v83
    v_and_b32 v23, s58, v83
    v_lshlrev_b32 v24, 16, v84
    v_and_b32 v25, s58, v84
    v_lshlrev_b32 v26, 16, v85
    v_and_b32 v27, s58, v85
    v_lshlrev_b32 v28, 16, v86
    v_and_b32 v29, s58, v86
    v_lshlrev_b32 v30, 16, v87
    v_and_b32 v31, s58, v87
    v_pk_add_f32 v[64:65], v[64:65], v[16:17]
    v_pk_add_f32 v[66:67], v[66:67], v[18:19]
    v_pk_add_f32 v[68:69], v[68:69], v[20:21]
    v_pk_add_f32 v[70:71], v[70:71], v[22:23]
    v_pk_add_f32 v[72:73], v[72:73], v[24:25]
    v_pk_add_f32 v[74:75], v[74:75], v[26:27]
    v_pk_add_f32 v[76:77], v[76:77], v[28:29]
    v_pk_add_f32 v[78:79], v[78:79], v[30:31]
    s_waitcnt vmcnt(8)
    v_lshlrev_b32 v32, 16, v88
    v_and_b32 v33, s58, v88
    v_lshlrev_b32 v34, 16, v89
    v_and_b32 v35, s58, v89
    v_lshlrev_b32 v36, 16, v90
    v_and_b32 v37, s58, v90
    v_lshlrev_b32 v38, 16, v91
    v_and_b32 v39, s58, v91
    v_lshlrev_b32 v40, 16, v92
    v_and_b32 v41, s58, v92
    v_lshlrev_b32 v42, 16, v93
    v_and_b32 v43, s58, v93
    v_lshlrev_b32 v44, 16, v94
    v_and_b32 v45, s58, v94
    v_lshlrev_b32 v46, 16, v95
    v_and_b32 v47, s58, v95
    v_pk_add_f32 v[64:65], v[64:65], v[32:33]
    v_pk_add_f32 v[66:67], v[66:67], v[34:35]
    v_pk_add_f32 v[68:69], v[68:69], v[36:37]
    v_pk_add_f32 v[70:71], v[70:71], v[38:39]
    v_pk_add_f32 v[72:73], v[72:73], v[40:41]
    v_pk_add_f32 v[74:75], v[74:75], v[42:43]
    v_pk_add_f32 v[76:77], v[76:77], v[44:45]
    v_pk_add_f32 v[78:79], v[78:79], v[46:47]
    s_waitcnt vmcnt(6)
    v_lshlrev_b32 v224, 16, v96
    v_and_b32 v225, s58, v96
    v_lshlrev_b32 v226, 16, v97
    v_and_b32 v227, s58, v97
    v_lshlrev_b32 v228, 16, v98
    v_and_b32 v229, s58, v98
    v_lshlrev_b32 v230, 16, v99
    v_and_b32 v231, s58, v99
    v_lshlrev_b32 v232, 16, v100
    v_and_b32 v233, s58, v100
    v_lshlrev_b32 v234, 16, v101
    v_and_b32 v235, s58, v101
    v_lshlrev_b32 v236, 16, v102
    v_and_b32 v237, s58, v102
    v_lshlrev_b32 v238, 16, v103
    v_and_b32 v239, s58, v103
    v_pk_mul_f32 v[16:17], v[64:65], s[54:55]
    v_pk_mul_f32 v[18:19], v[66:67], s[54:55]
    v_pk_mul_f32 v[20:21], v[68:69], s[54:55]
    v_pk_mul_f32 v[22:23], v[70:71], s[54:55]
    v_pk_mul_f32 v[24:25], v[72:73], s[54:55]
    v_pk_mul_f32 v[26:27], v[74:75], s[54:55]
    v_pk_mul_f32 v[28:29], v[76:77], s[54:55]
    v_pk_mul_f32 v[30:31], v[78:79], s[54:55]
    v_exp_f32 v16, v16
    v_exp_f32 v17, v17
    v_exp_f32 v18, v18
    v_exp_f32 v19, v19
    v_exp_f32 v20, v20
    v_exp_f32 v21, v21
    v_exp_f32 v22, v22
    v_exp_f32 v23, v23
    v_exp_f32 v24, v24
    v_exp_f32 v25, v25
    v_exp_f32 v26, v26
    v_exp_f32 v27, v27
    v_exp_f32 v28, v28
    v_exp_f32 v29, v29
    v_exp_f32 v30, v30
    v_exp_f32 v31, v31
    v_pk_mul_f32 v[64:65], v[64:65], v[224:225]
    v_pk_mul_f32 v[66:67], v[66:67], v[226:227]
    v_pk_mul_f32 v[68:69], v[68:69], v[228:229]
    v_pk_mul_f32 v[70:71], v[70:71], v[230:231]
    v_pk_mul_f32 v[72:73], v[72:73], v[232:233]
    v_pk_mul_f32 v[74:75], v[74:75], v[234:235]
    v_pk_mul_f32 v[76:77], v[76:77], v[236:237]
    v_pk_mul_f32 v[78:79], v[78:79], v[238:239]
    v_pk_add_f32 v[16:17], v[16:17], s[56:57]
    v_pk_add_f32 v[18:19], v[18:19], s[56:57]
    v_pk_add_f32 v[20:21], v[20:21], s[56:57]
    v_pk_add_f32 v[22:23], v[22:23], s[56:57]
    v_pk_add_f32 v[24:25], v[24:25], s[56:57]
    v_pk_add_f32 v[26:27], v[26:27], s[56:57]
    v_pk_add_f32 v[28:29], v[28:29], s[56:57]
    v_pk_add_f32 v[30:31], v[30:31], s[56:57]
    v_rcp_f32 v16, v16
    v_rcp_f32 v17, v17
    v_rcp_f32 v18, v18
    v_rcp_f32 v19, v19
    v_rcp_f32 v20, v20
    v_rcp_f32 v21, v21
    v_rcp_f32 v22, v22
    v_rcp_f32 v23, v23
    v_rcp_f32 v24, v24
    v_rcp_f32 v25, v25
    v_rcp_f32 v26, v26
    v_rcp_f32 v27, v27
    v_rcp_f32 v28, v28
    v_rcp_f32 v29, v29
    v_rcp_f32 v30, v30
    v_rcp_f32 v31, v31
    v_pk_fma_f32 v[144:145], v[64:65], v[16:17], v[144:145]
    v_pk_fma_f32 v[146:147], v[66:67], v[18:19], v[146:147]
    v_pk_fma_f32 v[148:149], v[68:69], v[20:21], v[148:149]
    v_pk_fma_f32 v[150:151], v[70:71], v[22:23], v[150:151]
    v_pk_fma_f32 v[152:153], v[72:73], v[24:25], v[152:153]
    v_pk_fma_f32 v[154:155], v[74:75], v[26:27], v[154:155]
    v_pk_fma_f32 v[156:157], v[76:77], v[28:29], v[156:157]
    v_pk_fma_f32 v[158:159], v[78:79], v[30:31], v[158:159]
    v_cvt_pk_bf16_f32 v48, v144, v145
    v_cvt_pk_bf16_f32 v49, v146, v147
    v_cvt_pk_bf16_f32 v50, v148, v149
    v_cvt_pk_bf16_f32 v51, v150, v151
    v_cvt_pk_bf16_f32 v52, v152, v153
    v_cvt_pk_bf16_f32 v53, v154, v155
    v_cvt_pk_bf16_f32 v54, v156, v157
    v_cvt_pk_bf16_f32 v55, v158, v159
    v_permlane32_swap_b32 v48, v50
    v_permlane32_swap_b32 v49, v51
    v_permlane32_swap_b32 v52, v54
    v_permlane32_swap_b32 v53, v55
    buffer_store_dwordx4 v[48:51], v14, s[40:43], s64 offen offset:0
    buffer_store_dwordx4 v[52:55], v14, s[40:43], s64 offen offset:32
    s_waitcnt vmcnt(6)
    v_lshlrev_b32 v16, 16, v104
    v_and_b32 v17, s58, v104
    v_lshlrev_b32 v18, 16, v105
    v_and_b32 v19, s58, v105
    v_lshlrev_b32 v20, 16, v106
    v_and_b32 v21, s58, v106
    v_lshlrev_b32 v22, 16, v107
    v_and_b32 v23, s58, v107
    v_lshlrev_b32 v24, 16, v108
    v_and_b32 v25, s58, v108
    v_lshlrev_b32 v26, 16, v109
    v_and_b32 v27, s58, v109
    v_lshlrev_b32 v28, 16, v110
    v_and_b32 v29, s58, v110
    v_lshlrev_b32 v30, 16, v111
    v_and_b32 v31, s58, v111
    v_pk_add_f32 v[128:129], v[128:129], v[16:17]
    v_pk_add_f32 v[130:131], v[130:131], v[18:19]
    v_pk_add_f32 v[132:133], v[132:133], v[20:21]
    v_pk_add_f32 v[134:135], v[134:135], v[22:23]
    v_pk_add_f32 v[136:137], v[136:137], v[24:25]
    v_pk_add_f32 v[138:139], v[138:139], v[26:27]
    v_pk_add_f32 v[140:141], v[140:141], v[28:29]
    v_pk_add_f32 v[142:143], v[142:143], v[30:31]
    s_waitcnt vmcnt(4)
    v_lshlrev_b32 v32, 16, v112
    v_and_b32 v33, s58, v112
    v_lshlrev_b32 v34, 16, v113
    v_and_b32 v35, s58, v113
    v_lshlrev_b32 v36, 16, v114
    v_and_b32 v37, s58, v114
    v_lshlrev_b32 v38, 16, v115
    v_and_b32 v39, s58, v115
    v_lshlrev_b32 v40, 16, v116
    v_and_b32 v41, s58, v116
    v_lshlrev_b32 v42, 16, v117
    v_and_b32 v43, s58, v117
    v_lshlrev_b32 v44, 16, v118
    v_and_b32 v45, s58, v118
    v_lshlrev_b32 v46, 16, v119
    v_and_b32 v47, s58, v119
    v_pk_add_f32 v[128:129], v[128:129], v[32:33]
    v_pk_add_f32 v[130:131], v[130:131], v[34:35]
    v_pk_add_f32 v[132:133], v[132:133], v[36:37]
    v_pk_add_f32 v[134:135], v[134:135], v[38:39]
    v_pk_add_f32 v[136:137], v[136:137], v[40:41]
    v_pk_add_f32 v[138:139], v[138:139], v[42:43]
    v_pk_add_f32 v[140:141], v[140:141], v[44:45]
    v_pk_add_f32 v[142:143], v[142:143], v[46:47]
    s_waitcnt vmcnt(2)
    v_lshlrev_b32 v240, 16, v120
    v_and_b32 v241, s58, v120
    v_lshlrev_b32 v242, 16, v121
    v_and_b32 v243, s58, v121
    v_lshlrev_b32 v244, 16, v122
    v_and_b32 v245, s58, v122
    v_lshlrev_b32 v246, 16, v123
    v_and_b32 v247, s58, v123
    v_lshlrev_b32 v248, 16, v124
    v_and_b32 v249, s58, v124
    v_lshlrev_b32 v250, 16, v125
    v_and_b32 v251, s58, v125
    v_lshlrev_b32 v252, 16, v126
    v_and_b32 v253, s58, v126
    v_lshlrev_b32 v254, 16, v127
    v_and_b32 v255, s58, v127
    v_pk_mul_f32 v[16:17], v[128:129], s[54:55]
    v_pk_mul_f32 v[18:19], v[130:131], s[54:55]
    v_pk_mul_f32 v[20:21], v[132:133], s[54:55]
    v_pk_mul_f32 v[22:23], v[134:135], s[54:55]
    v_pk_mul_f32 v[24:25], v[136:137], s[54:55]
    v_pk_mul_f32 v[26:27], v[138:139], s[54:55]
    v_pk_mul_f32 v[28:29], v[140:141], s[54:55]
    v_pk_mul_f32 v[30:31], v[142:143], s[54:55]
    v_exp_f32 v16, v16
    v_exp_f32 v17, v17
    v_exp_f32 v18, v18
    v_exp_f32 v19, v19
    v_exp_f32 v20, v20
    v_exp_f32 v21, v21
    v_exp_f32 v22, v22
    v_exp_f32 v23, v23
    v_exp_f32 v24, v24
    v_exp_f32 v25, v25
    v_exp_f32 v26, v26
    v_exp_f32 v27, v27
    v_exp_f32 v28, v28
    v_exp_f32 v29, v29
    v_exp_f32 v30, v30
    v_exp_f32 v31, v31
    v_pk_mul_f32 v[128:129], v[128:129], v[240:241]
    v_pk_mul_f32 v[130:131], v[130:131], v[242:243]
    v_pk_mul_f32 v[132:133], v[132:133], v[244:245]
    v_pk_mul_f32 v[134:135], v[134:135], v[246:247]
    v_pk_mul_f32 v[136:137], v[136:137], v[248:249]
    v_pk_mul_f32 v[138:139], v[138:139], v[250:251]
    v_pk_mul_f32 v[140:141], v[140:141], v[252:253]
    v_pk_mul_f32 v[142:143], v[142:143], v[254:255]
    v_pk_add_f32 v[16:17], v[16:17], s[56:57]
    v_pk_add_f32 v[18:19], v[18:19], s[56:57]
    v_pk_add_f32 v[20:21], v[20:21], s[56:57]
    v_pk_add_f32 v[22:23], v[22:23], s[56:57]
    v_pk_add_f32 v[24:25], v[24:25], s[56:57]
    v_pk_add_f32 v[26:27], v[26:27], s[56:57]
    v_pk_add_f32 v[28:29], v[28:29], s[56:57]
    v_pk_add_f32 v[30:31], v[30:31], s[56:57]
    v_rcp_f32 v16, v16
    v_rcp_f32 v17, v17
    v_rcp_f32 v18, v18
    v_rcp_f32 v19, v19
    v_rcp_f32 v20, v20
    v_rcp_f32 v21, v21
    v_rcp_f32 v22, v22
    v_rcp_f32 v23, v23
    v_rcp_f32 v24, v24
    v_rcp_f32 v25, v25
    v_rcp_f32 v26, v26
    v_rcp_f32 v27, v27
    v_rcp_f32 v28, v28
    v_rcp_f32 v29, v29
    v_rcp_f32 v30, v30
    v_rcp_f32 v31, v31
    v_pk_fma_f32 v[160:161], v[128:129], v[16:17], v[160:161]
    v_pk_fma_f32 v[162:163], v[130:131], v[18:19], v[162:163]
    v_pk_fma_f32 v[164:165], v[132:133], v[20:21], v[164:165]
    v_pk_fma_f32 v[166:167], v[134:135], v[22:23], v[166:167]
    v_pk_fma_f32 v[168:169], v[136:137], v[24:25], v[168:169]
    v_pk_fma_f32 v[170:171], v[138:139], v[26:27], v[170:171]
    v_pk_fma_f32 v[172:173], v[140:141], v[28:29], v[172:173]
    v_pk_fma_f32 v[174:175], v[142:143], v[30:31], v[174:175]
    v_cvt_pk_bf16_f32 v56, v160, v161
    v_cvt_pk_bf16_f32 v57, v162, v163
    v_cvt_pk_bf16_f32 v58, v164, v165
    v_cvt_pk_bf16_f32 v59, v166, v167
    v_cvt_pk_bf16_f32 v60, v168, v169
    v_cvt_pk_bf16_f32 v61, v170, v171
    v_cvt_pk_bf16_f32 v62, v172, v173
    v_cvt_pk_bf16_f32 v63, v174, v175
    v_permlane32_swap_b32 v56, v58
    v_permlane32_swap_b32 v57, v59
    v_permlane32_swap_b32 v60, v62
    v_permlane32_swap_b32 v61, v63
    buffer_store_dwordx4 v[56:59], v14, s[40:43], s64 offen offset:64
    buffer_store_dwordx4 v[60:63], v14, s[40:43], s64 offen offset:96
    s_endpgm
.g2_epi0:
    s_waitcnt vmcnt(10)
    v_lshlrev_b32 v16, 16, v80
    v_and_b32 v17, s58, v80
    v_lshlrev_b32 v18, 16, v81
    v_and_b32 v19, s58, v81
    v_lshlrev_b32 v20, 16, v82
    v_and_b32 v21, s58, v82
    v_lshlrev_b32 v22, 16, v83
    v_and_b32 v23, s58, v83
    v_lshlrev_b32 v24, 16, v84
    v_and_b32 v25, s58, v84
    v_lshlrev_b32 v26, 16, v85
    v_and_b32 v27, s58, v85
    v_lshlrev_b32 v28, 16, v86
    v_and_b32 v29, s58, v86
    v_lshlrev_b32 v30, 16, v87
    v_and_b32 v31, s58, v87
    v_pk_add_f32 v[224:225], v[224:225], v[16:17]
    v_pk_add_f32 v[226:227], v[226:227], v[18:19]
    v_pk_add_f32 v[228:229], v[228:229], v[20:21]
    v_pk_add_f32 v[230:231], v[230:231], v[22:23]
    v_pk_add_f32 v[232:233], v[232:233], v[24:25]
    v_pk_add_f32 v[234:235], v[234:235], v[26:27]
    v_pk_add_f32 v[236:237], v[236:237], v[28:29]
    v_pk_add_f32 v[238:239], v[238:239], v[30:31]
    s_waitcnt vmcnt(8)
    v_lshlrev_b32 v32, 16, v88
    v_and_b32 v33, s58, v88
    v_lshlrev_b32 v34, 16, v89
    v_and_b32 v35, s58, v89
    v_lshlrev_b32 v36, 16, v90
    v_and_b32 v37, s58, v90
    v_lshlrev_b32 v38, 16, v91
    v_and_b32 v39, s58, v91
    v_lshlrev_b32 v40, 16, v92
    v_and_b32 v41, s58, v92
    v_lshlrev_b32 v42, 16, v93
    v_and_b32 v43, s58, v93
    v_lshlrev_b32 v44, 16, v94
    v_and_b32 v45, s58, v94
    v_lshlrev_b32 v46, 16, v95
    v_and_b32 v47, s58, v95
    v_pk_add_f32 v[224:225], v[224:225], v[32:33]
    v_pk_add_f32 v[226:227], v[226:227], v[34:35]
    v_pk_add_f32 v[228:229], v[228:229], v[36:37]
    v_pk_add_f32 v[230:231], v[230:231], v[38:39]
    v_pk_add_f32 v[232:233], v[232:233], v[40:41]
    v_pk_add_f32 v[234:235], v[234:235], v[42:43]
    v_pk_add_f32 v[236:237], v[236:237], v[44:45]
    v_pk_add_f32 v[238:239], v[238:239], v[46:47]
    s_waitcnt vmcnt(6)
    v_lshlrev_b32 v16, 16, v96
    v_and_b32 v17, s58, v96
    v_lshlrev_b32 v18, 16, v97
    v_and_b32 v19, s58, v97
    v_lshlrev_b32 v20, 16, v98
    v_and_b32 v21, s58, v98
    v_lshlrev_b32 v22, 16, v99
    v_and_b32 v23, s58, v99
    v_lshlrev_b32 v24, 16, v100
    v_and_b32 v25, s58, v100
    v_lshlrev_b32 v26, 16, v101
    v_and_b32 v27, s58, v101
    v_lshlrev_b32 v28, 16, v102
    v_and_b32 v29, s58, v102
    v_lshlrev_b32 v30, 16, v103
    v_and_b32 v31, s58, v103
    v_pk_add_f32 v[224:225], v[224:225], v[16:17]
    v_pk_add_f32 v[226:227], v[226:227], v[18:19]
    v_pk_add_f32 v[228:229], v[228:229], v[20:21]
    v_pk_add_f32 v[230:231], v[230:231], v[22:23]
    v_pk_add_f32 v[232:233], v[232:233], v[24:25]
    v_pk_add_f32 v[234:235], v[234:235], v[26:27]
    v_pk_add_f32 v[236:237], v[236:237], v[28:29]
    v_pk_add_f32 v[238:239], v[238:239], v[30:31]
    v_pk_mul_f32 v[16:17], v[224:225], s[54:55]
    v_pk_mul_f32 v[18:19], v[226:227], s[54:55]
    v_pk_mul_f32 v[20:21], v[228:229], s[54:55]
    v_pk_mul_f32 v[22:23], v[230:231], s[54:55]
    v_pk_mul_f32 v[24:25], v[232:233], s[54:55]
    v_pk_mul_f32 v[26:27], v[234:235], s[54:55]
    v_pk_mul_f32 v[28:29], v[236:237], s[54:55]
    v_pk_mul_f32 v[30:31], v[238:239], s[54:55]
    v_exp_f32 v16, v16
    v_exp_f32 v17, v17
    v_exp_f32 v18, v18
    v_exp_f32 v19, v19
    v_exp_f32 v20, v20
    v_exp_f32 v21, v21
    v_exp_f32 v22, v22
    v_exp_f32 v23, v23
    v_exp_f32 v24, v24
    v_exp_f32 v25, v25
    v_exp_f32 v26, v26
    v_exp_f32 v27, v27
    v_exp_f32 v28, v28
    v_exp_f32 v29, v29
    v_exp_f32 v30, v30
    v_exp_f32 v31, v31
    v_pk_mul_f32 v[224:225], v[224:225], v[64:65]
    v_pk_mul_f32 v[226:227], v[226:227], v[66:67]
    v_pk_mul_f32 v[228:229], v[228:229], v[68:69]
    v_pk_mul_f32 v[230:231], v[230:231], v[70:71]
    v_pk_mul_f32 v[232:233], v[232:233], v[72:73]
    v_pk_mul_f32 v[234:235], v[234:235], v[74:75]
    v_pk_mul_f32 v[236:237], v[236:237], v[76:77]
    v_pk_mul_f32 v[238:239], v[238:239], v[78:79]
    v_pk_add_f32 v[16:17], v[16:17], s[56:57]
    v_pk_add_f32 v[18:19], v[18:19], s[56:57]
    v_pk_add_f32 v[20:21], v[20:21], s[56:57]
    v_pk_add_f32 v[22:23], v[22:23], s[56:57]
    v_pk_add_f32 v[24:25], v[24:25], s[56:57]
    v_pk_add_f32 v[26:27], v[26:27], s[56:57]
    v_pk_add_f32 v[28:29], v[28:29], s[56:57]
    v_pk_add_f32 v[30:31], v[30:31], s[56:57]
    v_rcp_f32 v16, v16
    v_rcp_f32 v17, v17
    v_rcp_f32 v18, v18
    v_rcp_f32 v19, v19
    v_rcp_f32 v20, v20
    v_rcp_f32 v21, v21
    v_rcp_f32 v22, v22
    v_rcp_f32 v23, v23
    v_rcp_f32 v24, v24
    v_rcp_f32 v25, v25
    v_rcp_f32 v26, v26
    v_rcp_f32 v27, v27
    v_rcp_f32 v28, v28
    v_rcp_f32 v29, v29
    v_rcp_f32 v30, v30
    v_rcp_f32 v31, v31
    v_pk_fma_f32 v[144:145], v[224:225], v[16:17], v[144:145]
    v_pk_fma_f32 v[146:147], v[226:227], v[18:19], v[146:147]
    v_pk_fma_f32 v[148:149], v[228:229], v[20:21], v[148:149]
    v_pk_fma_f32 v[150:151], v[230:231], v[22:23], v[150:151]
    v_pk_fma_f32 v[152:153], v[232:233], v[24:25], v[152:153]
    v_pk_fma_f32 v[154:155], v[234:235], v[26:27], v[154:155]
    v_pk_fma_f32 v[156:157], v[236:237], v[28:29], v[156:157]
    v_pk_fma_f32 v[158:159], v[238:239], v[30:31], v[158:159]
    v_cvt_pk_bf16_f32 v48, v144, v145
    v_cvt_pk_bf16_f32 v49, v146, v147
    v_cvt_pk_bf16_f32 v50, v148, v149
    v_cvt_pk_bf16_f32 v51, v150, v151
    v_cvt_pk_bf16_f32 v52, v152, v153
    v_cvt_pk_bf16_f32 v53, v154, v155
    v_cvt_pk_bf16_f32 v54, v156, v157
    v_cvt_pk_bf16_f32 v55, v158, v159
    v_permlane32_swap_b32 v48, v50
    v_permlane32_swap_b32 v49, v51
    v_permlane32_swap_b32 v52, v54
    v_permlane32_swap_b32 v53, v55
    buffer_store_dwordx4 v[48:51], v14, s[40:43], s64 offen offset:0
    buffer_store_dwordx4 v[52:55], v14, s[40:43], s64 offen offset:32
    s_waitcnt vmcnt(6)
    v_lshlrev_b32 v16, 16, v104
    v_and_b32 v17, s58, v104
    v_lshlrev_b32 v18, 16, v105
    v_and_b32 v19, s58, v105
    v_lshlrev_b32 v20, 16, v106
    v_and_b32 v21, s58, v106
    v_lshlrev_b32 v22, 16, v107
    v_and_b32 v23, s58, v107
    v_lshlrev_b32 v24, 16, v108
    v_and_b32 v25, s58, v108
    v_lshlrev_b32 v26, 16, v109
    v_and_b32 v27, s58, v109
    v_lshlrev_b32 v28, 16, v110
    v_and_b32 v29, s58, v110
    v_lshlrev_b32 v30, 16, v111
    v_and_b32 v31, s58, v111
    v_pk_add_f32 v[240:241], v[240:241], v[16:17]
    v_pk_add_f32 v[242:243], v[242:243], v[18:19]
    v_pk_add_f32 v[244:245], v[244:245], v[20:21]
    v_pk_add_f32 v[246:247], v[246:247], v[22:23]
    v_pk_add_f32 v[248:249], v[248:249], v[24:25]
    v_pk_add_f32 v[250:251], v[250:251], v[26:27]
    v_pk_add_f32 v[252:253], v[252:253], v[28:29]
    v_pk_add_f32 v[254:255], v[254:255], v[30:31]
    s_waitcnt vmcnt(4)
    v_lshlrev_b32 v32, 16, v112
    v_and_b32 v33, s58, v112
    v_lshlrev_b32 v34, 16, v113
    v_and_b32 v35, s58, v113
    v_lshlrev_b32 v36, 16, v114
    v_and_b32 v37, s58, v114
    v_lshlrev_b32 v38, 16, v115
    v_and_b32 v39, s58, v115
    v_lshlrev_b32 v40, 16, v116
    v_and_b32 v41, s58, v116
    v_lshlrev_b32 v42, 16, v117
    v_and_b32 v43, s58, v117
    v_lshlrev_b32 v44, 16, v118
    v_and_b32 v45, s58, v118
    v_lshlrev_b32 v46, 16, v119
    v_and_b32 v47, s58, v119
    v_pk_add_f32 v[240:241], v[240:241], v[32:33]
    v_pk_add_f32 v[242:243], v[242:243], v[34:35]
    v_pk_add_f32 v[244:245], v[244:245], v[36:37]
    v_pk_add_f32 v[246:247], v[246:247], v[38:39]
    v_pk_add_f32 v[248:249], v[248:249], v[40:41]
    v_pk_add_f32 v[250:251], v[250:251], v[42:43]
    v_pk_add_f32 v[252:253], v[252:253], v[44:45]
    v_pk_add_f32 v[254:255], v[254:255], v[46:47]
    s_waitcnt vmcnt(2)
    v_lshlrev_b32 v16, 16, v120
    v_and_b32 v17, s58, v120
    v_lshlrev_b32 v18, 16, v121
    v_and_b32 v19, s58, v121
    v_lshlrev_b32 v20, 16, v122
    v_and_b32 v21, s58, v122
    v_lshlrev_b32 v22, 16, v123
    v_and_b32 v23, s58, v123
    v_lshlrev_b32 v24, 16, v124
    v_and_b32 v25, s58, v124
    v_lshlrev_b32 v26, 16, v125
    v_and_b32 v27, s58, v125
    v_lshlrev_b32 v28, 16, v126
    v_and_b32 v29, s58, v126
    v_lshlrev_b32 v30, 16, v127
    v_and_b32 v31, s58, v127
    v_pk_add_f32 v[240:241], v[240:241], v[16:17]
    v_pk_add_f32 v[242:243], v[242:243], v[18:19]
    v_pk_add_f32 v[244:245], v[244:245], v[20:21]
    v_pk_add_f32 v[246:247], v[246:247], v[22:23]
    v_pk_add_f32 v[248:249], v[248:249], v[24:25]
    v_pk_add_f32 v[250:251], v[250:251], v[26:27]
    v_pk_add_f32 v[252:253], v[252:253], v[28:29]
    v_pk_add_f32 v[254:255], v[254:255], v[30:31]
    v_pk_mul_f32 v[16:17], v[240:241], s[54:55]
    v_pk_mul_f32 v[18:19], v[242:243], s[54:55]
    v_pk_mul_f32 v[20:21], v[244:245], s[54:55]
    v_pk_mul_f32 v[22:23], v[246:247], s[54:55]
    v_pk_mul_f32 v[24:25], v[248:249], s[54:55]
    v_pk_mul_f32 v[26:27], v[250:251], s[54:55]
    v_pk_mul_f32 v[28:29], v[252:253], s[54:55]
    v_pk_mul_f32 v[30:31], v[254:255], s[54:55]
    v_exp_f32 v16, v16
    v_exp_f32 v17, v17
    v_exp_f32 v18, v18
    v_exp_f32 v19, v19
    v_exp_f32 v20, v20
    v_exp_f32 v21, v21
    v_exp_f32 v22, v22
    v_exp_f32 v23, v23
    v_exp_f32 v24, v24
    v_exp_f32 v25, v25
    v_exp_f32 v26, v26
    v_exp_f32 v27, v27
    v_exp_f32 v28, v28
    v_exp_f32 v29, v29
    v_exp_f32 v30, v30
    v_exp_f32 v31, v31
    v_pk_mul_f32 v[240:241], v[240:241], v[128:129]
    v_pk_mul_f32 v[242:243], v[242:243], v[130:131]
    v_pk_mul_f32 v[244:245], v[244:245], v[132:133]
    v_pk_mul_f32 v[246:247], v[246:247], v[134:135]
    v_pk_mul_f32 v[248:249], v[248:249], v[136:137]
    v_pk_mul_f32 v[250:251], v[250:251], v[138:139]
    v_pk_mul_f32 v[252:253], v[252:253], v[140:141]
    v_pk_mul_f32 v[254:255], v[254:255], v[142:143]
    v_pk_add_f32 v[16:17], v[16:17], s[56:57]
    v_pk_add_f32 v[18:19], v[18:19], s[56:57]
    v_pk_add_f32 v[20:21], v[20:21], s[56:57]
    v_pk_add_f32 v[22:23], v[22:23], s[56:57]
    v_pk_add_f32 v[24:25], v[24:25], s[56:57]
    v_pk_add_f32 v[26:27], v[26:27], s[56:57]
    v_pk_add_f32 v[28:29], v[28:29], s[56:57]
    v_pk_add_f32 v[30:31], v[30:31], s[56:57]
    v_rcp_f32 v16, v16
    v_rcp_f32 v17, v17
    v_rcp_f32 v18, v18
    v_rcp_f32 v19, v19
    v_rcp_f32 v20, v20
    v_rcp_f32 v21, v21
    v_rcp_f32 v22, v22
    v_rcp_f32 v23, v23
    v_rcp_f32 v24, v24
    v_rcp_f32 v25, v25
    v_rcp_f32 v26, v26
    v_rcp_f32 v27, v27
    v_rcp_f32 v28, v28
    v_rcp_f32 v29, v29
    v_rcp_f32 v30, v30
    v_rcp_f32 v31, v31
    v_pk_fma_f32 v[160:161], v[240:241], v[16:17], v[160:161]
    v_pk_fma_f32 v[162:163], v[242:243], v[18:19], v[162:163]
    v_pk_fma_f32 v[164:165], v[244:245], v[20:21], v[164:165]
    v_pk_fma_f32 v[166:167], v[246:247], v[22:23], v[166:167]
    v_pk_fma_f32 v[168:169], v[248:249], v[24:25], v[168:169]
    v_pk_fma_f32 v[170:171], v[250:251], v[26:27], v[170:171]
    v_pk_fma_f32 v[172:173], v[252:253], v[28:29], v[172:173]
    v_pk_fma_f32 v[174:175], v[254:255], v[30:31], v[174:175]
    v_cvt_pk_bf16_f32 v56, v160, v161
    v_cvt_pk_bf16_f32 v57, v162, v163
    v_cvt_pk_bf16_f32 v58, v164, v165
    v_cvt_pk_bf16_f32 v59, v166, v167
    v_cvt_pk_bf16_f32 v60, v168, v169
    v_cvt_pk_bf16_f32 v61, v170, v171
    v_cvt_pk_bf16_f32 v62, v172, v173
    v_cvt_pk_bf16_f32 v63, v174, v175
    v_permlane32_swap_b32 v56, v58
    v_permlane32_swap_b32 v57, v59
    v_permlane32_swap_b32 v60, v62
    v_permlane32_swap_b32 v61, v63
    buffer_store_dwordx4 v[56:59], v14, s[40:43], s64 offen offset:64
    buffer_store_dwordx4 v[60:63], v14, s[40:43], s64 offen offset:96
.g1_end:
    s_endpgm
.section .rodata,"a"
.p2align 6
.amdhsa_kernel g1_kernel
  .amdhsa_next_free_vgpr 256
  .amdhsa_next_free_sgpr 80
  .amdhsa_accum_offset 256
  .amdhsa_group_segment_fixed_size 0
  .amdhsa_kernarg_size 96
  .amdhsa_user_sgpr_count 2
  .amdhsa_user_sgpr_kernarg_segment_ptr 1
  .amdhsa_system_sgpr_workgroup_id_x 1
.end_amdhsa_kernel
```
